```python
import torch

def _softmax(x, axis=-1):
    return torch.softmax(x, dim=axis)
def _gelu(x):
    return torch.nn.functional.gelu(x, approximate="tanh")
def _silu(x):
    return torch.nn.functional.silu(x)
def _sigmoid(x):
    return torch.sigmoid(x)
def _layernorm(x, axis=-1, eps=1e-5):
    m = x.mean(dim=axis, keepdim=True)
    v = x.var(dim=axis, keepdim=True, unbiased=False)
    return (x - m) / torch.sqrt(v + eps)
def _scatter_add(tgt, idx, src, axis=0):
    return tgt.clone().index_add_(axis, idx, src)
def _segment_sum(src, seg, n):
    out = torch.zeros((n,) + src.shape[1:], dtype=src.dtype)
    return out.index_add_(0, seg, src)
def _pad(x, pw):
    flat = tuple(v for pair in reversed(pw) for v in pair)
    return torch.nn.functional.pad(x, flat)

kernel_name = 'interleave_layers__softmax_full_mha__mixer_channel_mlp__prompt'

def setup_inputs():

    _w = (lambda a: (lambda t: t.to(torch.bfloat16) if t.is_floating_point() else t)(torch.as_tensor(a)))
    def _A_setup():
        B, S, D = 1, 2048, 512
        return {
            "x": _w((lambda *s: torch.randn(*s, dtype=torch.bfloat16) * 0.05)(B, S, D)),
            "wqkv": _w((lambda *s: torch.randn(*s, dtype=torch.bfloat16) * 0.05)(D, 3 * D)),
            "wo": _w((lambda *s: torch.randn(*s, dtype=torch.bfloat16) * 0.05)(D, D)),
        }
    _A_in = _A_setup()

    def _B_setup():
        B, S, D, F = 1, 2048, 512, 1376
        return {
            "x": _w((lambda *s: torch.randn(*s, dtype=torch.bfloat16) * 0.05)(B, S, D)),
            "w1": _w((lambda *s: torch.randn(*s, dtype=torch.bfloat16) * 1.6)(D, F) * (D ** -0.5)),
            "b1": _w((lambda *s: torch.randn(*s, dtype=torch.bfloat16) * 0.4)(F)),
            "w2": _w((lambda *s: torch.randn(*s, dtype=torch.bfloat16) * 0.2)(F, D) * (F ** -0.5)),
            "b2": _w((lambda *s: torch.randn(*s, dtype=torch.bfloat16) * 0.2)(D)),
        }
    _B_in = _B_setup()

    return {
        "A_x": _A_in["x"],
        "A_wqkv": _A_in["wqkv"],
        "A_wo": _A_in["wo"],
        "B_x": _B_in["x"],
        "B_w1": _B_in["w1"],
        "B_b1": _B_in["b1"],
        "B_w2": _B_in["w2"],
        "B_b2": _B_in["b2"],
    }

def reference(A_x, A_wqkv, A_wo, B_x, B_w1, B_b1, B_w2, B_b2):
    def _A_ref(x, wqkv, wo):
        B, S, D = x.shape
        H = 32; Dh = D // H
        qkv = (lambda x, *d: x.permute(*d))((x @ wqkv).reshape(B, S, 3, H, Dh), 2, 0, 3, 1, 4)
        q, k, v = qkv[0], qkv[1], qkv[2]
        scale = Dh ** -0.5
        scores = torch.einsum("bhqd,bhkd->bhqk", q, k) * scale
        p = _softmax(scores, axis=-1)
        o = torch.einsum("bhqk,bhkd->bhqd", p, v)
        return (lambda x, *d: x.permute(*d))(o, 0, 2, 1, 3).reshape(B, S, D) @ wo

    def _B_ref(x, w1, b1, w2, b2):
        y = _layernorm(x, axis=-1)
        h = _gelu(torch.einsum("bsd,df->bsf", y, w1) + b1)
        return torch.einsum("bsf,fd->bsd", h, w2) + b2

    x = A_x
    x = x + _A_ref(_layernorm(x, axis=-1), A_wqkv, A_wo)
    x = x + _B_ref(_layernorm(x, axis=-1), B_w1, B_b1, B_w2, B_b2)
    x = x + _A_ref(_layernorm(x, axis=-1), A_wqkv, A_wo)
    x = x + _B_ref(_layernorm(x, axis=-1), B_w1, B_b1, B_w2, B_b2)
    return x
```

```asm
; @launch grid=(256,1,1) block=(256,1,1) lds=156416
.amdgcn_target "amdgcn-amd-amdhsa--gfx950"
.text
.globl interleave_layers__softmax_full_mha__mixer_channel_mlp__prompt_kernel
.p2align 8
.type interleave_layers__softmax_full_mha__mixer_channel_mlp__prompt_kernel,@function
interleave_layers__softmax_full_mha__mixer_channel_mlp__prompt_kernel:
    s_cmp_ge_u32 s2, 256
    s_cbranch_scc1 L_end
    s_load_dwordx2 s[68:69], s[0:1], 0
    s_load_dwordx2 s[72:73], s[0:1], 8
    s_load_dwordx2 s[4:5], s[0:1], 80
    s_load_dwordx2 s[40:41], s[0:1], 40
    s_load_dwordx2 s[44:45], s[0:1], 56
    s_load_dwordx2 s[48:49], s[0:1], 64
    s_load_dwordx2 s[96:97], s[0:1], 72
    s_load_dwordx2 s[76:77], s[0:1], 32
    s_load_dwordx2 s[80:81], s[0:1], 16
    s_load_dwordx2 s[82:83], s[0:1], 48
    s_getpc_b64 s[92:93]
L_pc:
    s_mov_b32 s94, L_codeend-L_pc
    s_mov_b32 s95, 0x20000
    v_lshlrev_b32 v3, 6, v0
    s_lshr_b32 s20, s2, 3
    s_and_b32 s20, s20, 3
    s_lshl_b32 s20, s20, 14
    buffer_load_dword v255, v3, s[92:95], s20 offen
    v_lshrrev_b32 v2, 6, v0
    v_and_b32 v0, 63, v0
    v_readfirstlane_b32 s8, v2
    v_lshlrev_b32 v1, 4, v0
    s_and_b32 s20, s2, 7
    s_lshr_b32 s21, s2, 3
    s_lshr_b32 s22, s20, 1
    s_lshl_b32 s22, s22, 3
    s_lshr_b32 s23, s21, 2
    s_add_u32 s9, s22, s23
    s_and_b32 s20, s20, 1
    s_and_b32 s21, s21, 3
    s_lshl_b32 s21, s21, 1
    s_add_u32 s10, s20, s21
    s_lshl_b32 s52, s10, 2
    s_add_u32 s52, s52, s8
    s_mov_b32 s13, 6291456
    s_mov_b32 s11, 0
    s_mov_b32 s36, 1
    s_mov_b32 s59, 0
    s_lshr_b32 s54, s8, 1
    s_mov_b32 s6, 268435456
    s_mov_b32 s7, 0x20000
    s_mov_b32 s42, 2752
    s_mov_b32 s43, 0x20000
    s_mov_b32 s46, 1024
    s_mov_b32 s47, 0x20000
    s_mov_b32 s50, 2097152
    s_mov_b32 s51, 0x20000
    s_mov_b32 s70, 2097152
    s_mov_b32 s71, 0x20000
    s_mov_b32 s74, 1572864
    s_mov_b32 s75, 0x20000
    v_lshrrev_b32 v146, 3, v0
    v_and_b32 v148, 7, v0
    v_bfe_u32 v147, v0, 4, 1
    s_and_b32 s20, s8, 1
    s_lshl_b32 s20, s20, 1
    v_or_b32 v147, s20, v147
    v_lshlrev_b32 v147, 1, v147
    v_xor_b32 v147, v147, v148
    s_lshl_b32 s20, s8, 3
    v_add_u32 v105, s20, v146
    v_mul_u32_u24 v105, 3072, v105
    v_lshl_add_u32 v105, v147, 4, v105
    v_and_b32 v147, 6, v146
    v_xor_b32 v147, v147, v148
    v_lshlrev_b32 v104, 10, v146
    v_lshl_add_u32 v104, v147, 4, v104
    s_lshl_b32 s33, s10, 7
    s_mul_i32 s34, s8, 3072
    s_add_u32 s34, s34, 65536
    s_lshl_b32 s35, s9, 16
    s_lshl_b32 s37, s8, 14
    s_add_u32 s35, s35, s37
    s_add_u32 s31, s35, 8192
    v_mov_b32 v149, 0
    v_min_u32 v150, 24, v0
    v_lshlrev_b32 v150, 7, v150
    s_lshl_b32 s20, s2, 12
    s_lshl_b32 s21, s8, 5
    s_add_u32 s21, s21, s2
    s_cmp_lt_u32 s21, 32
    s_cselect_b32 s20, s20, 0x10000000
    s_cselect_b32 s100, 0, 0x1000
    s_mov_b32 s98, 256
    s_mov_b32 s99, 0x20000
    s_waitcnt lgkmcnt(0)
    buffer_store_dword v149, v150, s[4:7], s20 offen sc1
    s_add_u32 m0, s34, 0
    s_nop 0
    buffer_load_dwordx4 v105, s[72:75], s33 offen offset:0 lds
    buffer_load_dwordx4 v105, s[72:75], s33 offen offset:1024 lds
    buffer_load_dwordx4 v105, s[72:75], s33 offen offset:2048 lds
    s_add_u32 m0, s34, 12288
    s_add_u32 s33, s33, 98304
    buffer_load_dwordx4 v105, s[72:75], s33 offen offset:0 lds
    buffer_load_dwordx4 v105, s[72:75], s33 offen offset:1024 lds
    buffer_load_dwordx4 v105, s[72:75], s33 offen offset:2048 lds
    s_add_u32 m0, s37, 0
    s_nop 0
    buffer_load_dwordx4 v104, s[68:71], s35 offen lds
    s_add_u32 m0, s37, 1024
    s_nop 0
    buffer_load_dwordx4 v104, s[68:71], s31 offen lds
    s_add_u32 m0, s34, 24576
    s_add_u32 s33, s33, 98304
    buffer_load_dwordx4 v105, s[72:75], s33 offen offset:0 lds
    buffer_load_dwordx4 v105, s[72:75], s33 offen offset:1024 lds
    buffer_load_dwordx4 v105, s[72:75], s33 offen offset:2048 lds
    s_add_u32 m0, s34, 36864
    s_add_u32 s33, s33, 98304
    buffer_load_dwordx4 v105, s[72:75], s33 offen offset:0 lds
    buffer_load_dwordx4 v105, s[72:75], s33 offen offset:1024 lds
    buffer_load_dwordx4 v105, s[72:75], s33 offen offset:2048 lds
    s_add_u32 m0, s37, 2048
    s_add_u32 s35, s35, 128
    buffer_load_dwordx4 v104, s[68:71], s35 offen lds
    s_add_u32 m0, s37, 3072
    s_add_u32 s31, s31, 128
    buffer_load_dwordx4 v104, s[68:71], s31 offen lds
    v_lshlrev_b32 v152, 7, v0
    s_mov_b64 s[16:17], s[68:69]
    s_mov_b32 s18, 2097152
    s_mov_b32 s19, 0x20000
    s_mov_b32 s22, 8192
    s_cmp_eq_u32 s8, 1
    s_cselect_b64 s[16:17], s[72:73], s[16:17]
    s_cselect_b32 s18, 1572864, s18
    s_cselect_b32 s22, 6144, s22
    s_cmp_eq_u32 s8, 2
    s_cselect_b64 s[16:17], s[76:77], s[16:17]
    s_cselect_b32 s18, 0, s18
    s_cselect_b32 s22, 0, s22
    s_cmp_eq_u32 s8, 3
    s_cselect_b64 s[16:17], s[82:83], s[16:17]
    s_cselect_b32 s18, 0, s18
    s_cselect_b32 s22, 0, s22
    s_mul_i32 s22, s22, s2
    buffer_load_dword v153, v152, s[16:19], s22 offen
    v_lshrrev_b32 v2, 4, v0
    v_and_b32 v3, 15, v0
    v_and_b32 v6, 1, v2
    v_lshlrev_b32 v6, 9, v6
    v_lshrrev_b32 v7, 5, v0
    v_lshl_add_u32 v10, v7, 4, v3
    v_lshl_add_u32 v10, v10, 4, v6
    v_lshrrev_b32 v8, 2, v3
    v_lshlrev_b32 v8, 3, v8
    v_lshl_add_u32 v8, v7, 2, v8
    v_and_b32 v9, 3, v0
    v_add_u32 v8, v8, v9
    v_lshl_add_u32 v11, v8, 4, v6
    v_lshlrev_b32 v13, 4, v2
    v_add_u32 v13, 155648, v13
    v_lshlrev_b32 v12, 2, v3
    v_add_u32 v12, 155648, v12
    v_lshlrev_b32 v8, 12, v2
    v_lshl_add_u32 v8, v3, 3, v8
    s_lshl_b32 s25, s8, 6
    v_add_u32 v9, s25, v12
    s_lshl_b32 s24, s9, 14
    s_lshl_b32 s25, s8, 7
    s_add_u32 s24, s24, s25
    s_add_u32 s24, s24, s13
    s_add_u32 s24, s24, 18874368
    s_lshl_b32 s26, s9, 16
    s_lshl_b32 s27, s8, 14
    s_add_u32 s26, s26, s27
    s_add_u32 s26, s26, s13
    s_add_u32 s26, s26, 0
    s_lshl_b32 s28, s52, 16
    s_lshl_b32 s29, s9, 11
    s_add_u32 s28, s28, s29
    s_add_u32 s28, s28, s13
    s_add_u32 s29, s28, 6291456
    s_add_u32 s30, s28, 8388608
    s_add_u32 s28, s28, 4194304
    v_mov_b32 v4, 0x3eb8aa3b
    v_mov_b32 v145, v2
    v_bfe_u32 v149, v0, 2, 2
    v_bfe_u32 v150, v0, 3, 2
    v_xor_b32 v150, s8, v150
    v_mul_u32_u24 v106, 3072, v145
    v_lshl_add_u32 v106, v149, 7, v106
    v_lshl_add_u32 v106, v150, 5, v106
    v_and_b32 v150, 3, v0
    v_lshl_add_u32 v106, v150, 3, v106
    v_add_u32 v106, 65536, v106
    v_and_b32 v152, 6, v0
    v_xor_b32 v152, v152, v145
    v_lshlrev_b32 v110, 7, v3
    v_lshl_add_u32 v110, v152, 4, v110
    v_xor_b32 v111, 64, v110
    v_add_u32 v142, s37, v110
    v_add_u32 v143, s37, v111
    v_mov_b32 v92, 0x3f803f80
    v_mov_b32 v93, 0x3f803f80
    v_mov_b32 v94, 0x3f803f80
    v_mov_b32 v95, 0x3f803f80
    v_and_b32 v152, 1, v0
    v_cmp_eq_u32 s[92:93], 1, v152
    v_and_b32 v152, 2, v0
    v_cmp_eq_u32 s[94:95], 2, v152
    v_cmp_eq_u32 s[18:19], v149, v145
    s_lshl_b32 s20, s2, 2
    s_add_u32 s20, s20, s8
    v_mul_u32_u24 v107, 3072, v146
    v_lshl_add_u32 v107, v148, 4, v107
    v_lshl_add_u32 v128, v145, 3, v149
    v_lshlrev_b32 v128, 7, v128
    s_and_b32 s22, s20, 15
    s_lshr_b32 s23, s20, 4
    s_mul_i32 s90, s22, 98304
    s_lshl_b32 s91, s23, 7
    s_add_u32 s90, s90, s91
    s_and_b32 s91, s23, 7
    s_mul_i32 s91, s91, 196608
    s_lshr_b32 s23, s23, 3
    s_lshl_b32 s23, s23, 14
    s_lshl_b32 s22, s22, 10
    s_add_u32 s91, s91, s23
    s_add_u32 s91, s91, s22
    s_add_u32 s91, s91, 131072
    s_cmp_lt_u32 s20, 216
    s_cselect_b32 s90, s90, 0x10000000
    s_cselect_b32 s91, s91, 0x10000000
    s_mov_b32 s3, 0
    s_cmp_lt_u32 s20, 384
    s_cbranch_scc1 L_rp_w1
    s_cmp_ge_u32 s20, 856
    s_cbranch_scc1 L_rp_wq
    s_cmp_lt_u32 s20, 512
    s_cselect_b64 s[76:77], s[80:81], s[82:83]
    s_mov_b32 s65, 512
    s_mov_b32 s23, 3801088
    s_mov_b32 s78, 1409024
    s_cselect_b32 s65, 384, s65
    s_cselect_b32 s22, 32, 86
    s_cselect_b32 s23, 3276800, s23
    s_cselect_b32 s78, 524288, s78
    s_sub_u32 s20, s20, s65
    s_and_b32 s21, s20, 7
    s_lshr_b32 s20, s20, 3
    s_lshl_b32 s74, s20, 2
    s_cmp_ge_u32 s74, s22
    s_cselect_b32 s75, 32, 0
    s_add_u32 s74, s74, 2
    s_cmp_ge_u32 s74, s22
    s_cselect_b32 s74, 32, 0
    s_lshl_b32 s74, s74, 8
    s_or_b32 s3, s74, s75
    s_cmp_eq_u32 s22, 32
    s_cselect_b32 s3, 0, s3
    s_mov_b32 s74, 1572864
    s_mov_b32 s75, 0x20000
    s_lshl_b32 s80, s20, 15
    s_lshl_b32 s81, s21, 7
    s_add_u32 s80, s80, s81
    s_mov_b32 s81, 8192
    s_lshl_b32 s21, s21, 1
    s_mul_i32 s21, s21, s22
    s_lshl_b32 s20, s20, 1
    s_add_u32 s21, s21, s20
    s_lshl_b32 s21, s21, 10
    s_add_u32 s82, s21, s23
    s_add_u32 s83, s82, 1024
    s_lshl_b32 s22, s22, 10
    s_add_u32 s84, s82, s22
    s_add_u32 s85, s83, s22
    v_lshlrev_b32 v108, 10, v146
    v_lshl_add_u32 v108, v148, 4, v108
    s_branch L_rp_32
L_rp_wq:
    s_mov_b64 s[76:77], s[72:73]
    s_mov_b32 s78, 1572864
    s_sub_u32 s21, s20, 640
    s_and_b32 s22, s21, 15
    s_lshr_b32 s23, s21, 4
    s_mul_i32 s80, s22, 98304
    s_lshl_b32 s82, s23, 7
    s_add_u32 s80, s80, s82
    s_and_b32 s82, s23, 7
    s_mul_i32 s82, s82, 196608
    s_lshr_b32 s23, s23, 3
    s_lshl_b32 s23, s23, 14
    s_lshl_b32 s22, s22, 10
    s_add_u32 s82, s82, s23
    s_add_u32 s82, s82, s22
    s_add_u32 s82, s82, 131072
    s_add_u32 s83, s82, 49152
    s_add_u32 s84, s83, 49152
    s_add_u32 s85, s84, 49152
    s_mov_b32 s81, 24576
    v_mov_b32 v108, v107
    v_mov_b32 v109, v128
    s_mov_b32 s86, 512
    s_mov_b32 s87, 32
    s_mov_b32 s88, 64
    s_branch L_rp_go
L_rp_w1:
    s_mov_b32 s78, 1409024
    s_and_b32 s21, s20, 15
    s_lshr_b32 s20, s20, 4
    s_mul_i32 s80, s21, 88064
    s_lshl_b32 s81, s20, 7
    s_add_u32 s80, s80, s81
    s_lshl_b32 s22, s20, 16
    s_lshl_b32 s23, s21, 11
    s_add_u32 s22, s22, s23
    s_add_u32 s82, s22, 1703936
    s_add_u32 s83, s82, 1024
    s_add_u32 s84, s82, 32768
    s_add_u32 s85, s83, 32768
    s_mul_i32 s22, s20, 43
    s_lshr_b32 s22, s22, 7
    s_mul_i32 s22, s22, 3
    s_sub_u32 s22, s20, s22
    s_lshr_b32 s23, s21, 3
    s_lshr_b32 s22, s22, 1
    s_and_b32 s22, s22, s23
    s_mul_i32 s3, s22, 0x2020
    v_mul_u32_u24 v108, 2752, v146
    v_lshl_add_u32 v108, v148, 4, v108
    v_lshl_add_u32 v152, v148, 4, s81
    v_cmp_gt_u32 vcc, 2752, v152
    v_mov_b32 v152, 0x7fffffff
    s_mov_b32 s81, 22016
    v_cndmask_b32 v108, v152, v108, vcc
L_rp_32:
    v_lshrrev_b32 v109, 5, v0
    v_lshl_add_u32 v109, v109, 2, v149
    v_lshlrev_b32 v109, 7, v109
    v_bfe_u32 v152, v0, 4, 1
    v_lshl_add_u32 v109, v152, 5, v109
    s_mov_b32 s86, 1024
    s_mov_b32 s87, 2048
    s_mov_b32 s88, 64
L_rp_go:
    v_lshl_add_u32 v109, v150, 3, v109
    s_lshl_b32 s89, s8, 12
    s_add_u32 s89, s89, 139264
    v_add_u32 v109, s89, v109
    v_lshl_add_u32 v128, v150, 3, v128
    s_lshl_b32 s79, s8, 12
    s_add_u32 s65, s79, 65536
    v_add_u32 v128, s65, v128
    s_mov_b32 s79, 0x20000
    s_waitcnt vmcnt(9)
    s_mov_b64 exec, 1
    v_mov_b32 v151, 1
    buffer_atomic_add v151, v1, s[96:99], s100 offen sc1
    s_mov_b64 exec, -1
    s_barrier
    ds_read_b64_tr_b16 a[0:1], v106 offset:0
    ds_read_b64_tr_b16 a[2:3], v106 offset:512
    ds_read_b64_tr_b16 a[64:65], v106 offset:1024
    ds_read_b64_tr_b16 a[66:67], v106 offset:1536
    ds_read_b64_tr_b16 a[128:129], v106 offset:2048
    ds_read_b64_tr_b16 a[130:131], v106 offset:2560
    ds_read_b64_tr_b16 a[4:5], v106 offset:12288
    ds_read_b64_tr_b16 a[6:7], v106 offset:12800
    ds_read_b64_tr_b16 a[68:69], v106 offset:13312
    ds_read_b64_tr_b16 a[70:71], v106 offset:13824
    ds_read_b64_tr_b16 a[132:133], v106 offset:14336
    ds_read_b64_tr_b16 a[134:135], v106 offset:14848
    ds_read_b128 a[192:195], v110 offset:0
    ds_read_b128 a[196:199], v110 offset:16384
    ds_read_b128 a[200:203], v110 offset:32768
    ds_read_b128 a[204:207], v110 offset:49152
    ds_read_b128 a[208:211], v111 offset:0
    s_waitcnt lgkmcnt(5)
    s_waitcnt lgkmcnt(4)
    v_mfma_f32_16x16x32_bf16 v[36:39], a[64:67], a[192:195], 0
    ds_read_b128 a[212:215], v111 offset:16384
    v_mfma_f32_16x16x32_bf16 v[40:43], a[192:195], a[128:131], 0
    s_waitcnt lgkmcnt(4)
    s_add_u32 m0, s34, 49152
    s_add_u32 s33, s33, 98304
    buffer_load_dwordx4 v105, s[72:75], s33 offen offset:0 lds
    v_mfma_f32_16x16x32_bf16 v[48:51], a[64:67], a[196:199], 0
    ds_read_b128 a[216:219], v111 offset:32768
    v_mfma_f32_16x16x32_bf16 v[52:55], a[196:199], a[128:131], 0
    s_waitcnt lgkmcnt(4)
    buffer_load_dwordx4 v105, s[72:75], s33 offen offset:1024 lds
    s_waitcnt vmcnt(4) lgkmcnt(7)
    s_barrier
    v_mfma_f32_16x16x32_bf16 v[60:63], a[64:67], a[200:203], 0
    ds_read_b128 a[220:223], v111 offset:49152
    ds_read_b64_tr_b16 a[8:9], v106 offset:24576
    ds_read_b64_tr_b16 a[10:11], v106 offset:25088
    v_mfma_f32_16x16x32_bf16 v[64:67], a[200:203], a[128:131], 0
    s_waitcnt lgkmcnt(6)
    ds_read_b64_tr_b16 a[72:73], v106 offset:25600
    ds_read_b64_tr_b16 a[74:75], v106 offset:26112
    buffer_load_dwordx4 v105, s[72:75], s33 offen offset:2048 lds
    v_mfma_f32_16x16x32_bf16 v[72:75], a[64:67], a[204:207], 0
    ds_read_b128 a[224:227], v110 offset:2048
    ds_read_b64_tr_b16 a[136:137], v106 offset:26624
    ds_read_b64_tr_b16 a[138:139], v106 offset:27136
    v_mfma_f32_16x16x32_bf16 v[76:79], a[204:207], a[128:131], 0
    s_waitcnt lgkmcnt(10)
    ds_read_b64_tr_b16 a[12:13], v106 offset:36864
    ds_read_b64_tr_b16 a[14:15], v106 offset:37376
    s_add_u32 m0, s34, 61440
    s_add_u32 s33, s33, 98304
    buffer_load_dwordx4 v105, s[72:75], s33 offen offset:0 lds
    ds_read_b128 v[112:115], v142 offset:0
    ds_read_b128 v[116:119], v143 offset:0
    v_mfma_f32_16x16x32_bf16 v[80:83], a[0:3], v[92:95], 0
    v_mfma_f32_16x16x32_bf16 v[84:87], a[64:67], v[92:95], 0
    v_mfma_f32_16x16x32_bf16 v[88:91], v[92:95], a[128:131], 0
    v_mfma_f32_16x16x32_bf16 v[36:39], a[68:71], a[208:211], v[36:39]
    ds_read_b128 a[228:231], v110 offset:18432
    ds_read_b64_tr_b16 a[76:77], v106 offset:37888
    ds_read_b64_tr_b16 a[78:79], v106 offset:38400
    v_mfma_f32_16x16x32_bf16 v[40:43], a[208:211], a[132:135], v[40:43]
    s_waitcnt lgkmcnt(15)
    ds_read_b64_tr_b16 a[140:141], v106 offset:38912
    ds_read_b64_tr_b16 a[142:143], v106 offset:39424
    buffer_load_dwordx4 v105, s[72:75], s33 offen offset:1024 lds
    v_mfma_f32_16x16x32_bf16 v[48:51], a[68:71], a[212:215], v[48:51]
    ds_read_b128 a[232:235], v110 offset:34816
    v_mfma_f32_16x16x32_bf16 v[52:55], a[212:215], a[132:135], v[52:55]
    s_waitcnt lgkmcnt(15)
    buffer_load_dwordx4 v105, s[72:75], s33 offen offset:2048 lds
    v_mfma_f32_16x16x32_bf16 v[60:63], a[68:71], a[216:219], v[60:63]
    ds_read_b128 a[236:239], v110 offset:51200
    v_mfma_f32_16x16x32_bf16 v[64:67], a[216:219], a[132:135], v[64:67]
    s_waitcnt lgkmcnt(15)
    s_add_u32 m0, s37, 4096
    s_add_u32 s35, s35, 128
    buffer_load_dwordx4 v104, s[68:71], s35 offen lds
    v_mfma_f32_16x16x32_bf16 v[72:75], a[68:71], a[220:223], v[72:75]
    ds_read_b128 a[240:243], v111 offset:2048
    v_mfma_f32_16x16x32_bf16 v[76:79], a[220:223], a[132:135], v[76:79]
    s_waitcnt lgkmcnt(14)
    s_add_u32 m0, s37, 5120
    s_add_u32 s31, s31, 128
    buffer_load_dwordx4 v104, s[68:71], s31 offen lds
    s_waitcnt lgkmcnt(8)
    v_mfma_f32_16x16x32_bf16 v[120:123], v[92:95], v[112:115], 0
    v_mfma_f32_16x16x32_bf16 v[124:127], v[112:115], v[112:115], 0
    v_mfma_f32_16x16x32_bf16 v[120:123], v[92:95], v[116:119], v[120:123]
    v_mfma_f32_16x16x32_bf16 v[124:127], v[116:119], v[116:119], v[124:127]
    ds_read_b128 v[112:115], v142 offset:2048
    ds_read_b128 v[116:119], v143 offset:2048
    v_mfma_f32_16x16x32_bf16 v[80:83], a[4:7], v[92:95], v[80:83]
    v_mfma_f32_16x16x32_bf16 v[84:87], a[68:71], v[92:95], v[84:87]
    v_mfma_f32_16x16x32_bf16 v[88:91], v[92:95], a[132:135], v[88:91]
    s_waitcnt lgkmcnt(5)
    v_mfma_f32_16x16x32_bf16 v[36:39], a[72:75], a[224:227], v[36:39]
    ds_read_b128 a[244:247], v111 offset:18432
    v_mfma_f32_16x16x32_bf16 v[40:43], a[224:227], a[136:139], v[40:43]
    s_waitcnt lgkmcnt(10)
    s_add_u32 m0, s37, 6144
    s_add_u32 s35, s35, 128
    buffer_load_dwordx4 v104, s[68:71], s35 offen lds
    v_mfma_f32_16x16x32_bf16 v[48:51], a[72:75], a[228:231], v[48:51]
    ds_read_b128 a[248:251], v111 offset:34816
    v_mfma_f32_16x16x32_bf16 v[52:55], a[228:231], a[136:139], v[52:55]
    s_waitcnt lgkmcnt(6)
    s_add_u32 m0, s37, 7168
    s_add_u32 s31, s31, 128
    buffer_load_dwordx4 v104, s[68:71], s31 offen lds
    s_add_u32 m0, s37, 8192
    s_add_u32 s35, s35, 128
    buffer_load_dwordx4 v104, s[68:71], s35 offen lds
    s_add_u32 m0, s37, 9216
    s_add_u32 s31, s31, 128
    buffer_load_dwordx4 v104, s[68:71], s31 offen lds
    s_add_u32 m0, s34, 0
    s_add_u32 s33, s33, 98304
    buffer_load_dwordx4 v105, s[72:75], s33 offen offset:0 lds
    buffer_load_dwordx4 v105, s[72:75], s33 offen offset:1024 lds
    buffer_load_dwordx4 v105, s[72:75], s33 offen offset:2048 lds
    s_add_u32 m0, s34, 12288
    s_add_u32 s33, s33, 98304
    buffer_load_dwordx4 v105, s[72:75], s33 offen offset:0 lds
    buffer_load_dwordx4 v105, s[72:75], s33 offen offset:1024 lds
    buffer_load_dwordx4 v105, s[72:75], s33 offen offset:2048 lds
    s_add_u32 m0, s37, 10240
    s_add_u32 s35, s35, 128
    buffer_load_dwordx4 v104, s[68:71], s35 offen lds
    s_add_u32 m0, s37, 11264
    s_add_u32 s31, s31, 128
    buffer_load_dwordx4 v104, s[68:71], s31 offen lds
    s_waitcnt vmcnt(12) lgkmcnt(7)
    s_barrier
    v_mfma_f32_16x16x32_bf16 v[60:63], a[72:75], a[232:235], v[60:63]
    ds_read_b128 a[252:255], v111 offset:51200
    ds_read_b64_tr_b16 a[16:17], v106 offset:49152
    ds_read_b64_tr_b16 a[18:19], v106 offset:49664
    v_mfma_f32_16x16x32_bf16 v[64:67], a[232:235], a[136:139], v[64:67]
    s_waitcnt lgkmcnt(8)
    ds_read_b64_tr_b16 a[80:81], v106 offset:50176
    ds_read_b64_tr_b16 a[82:83], v106 offset:50688
    s_add_u32 m0, s34, 24576
    s_add_u32 s33, s33, 98304
    buffer_load_dwordx4 v105, s[72:75], s33 offen offset:0 lds
    v_mfma_f32_16x16x32_bf16 v[72:75], a[72:75], a[236:239], v[72:75]
    ds_read_b128 a[192:195], v110 offset:4096
    ds_read_b64_tr_b16 a[144:145], v106 offset:51200
    ds_read_b64_tr_b16 a[146:147], v106 offset:51712
    v_mfma_f32_16x16x32_bf16 v[76:79], a[236:239], a[136:139], v[76:79]
    s_waitcnt lgkmcnt(12)
    ds_read_b64_tr_b16 a[20:21], v106 offset:61440
    ds_read_b64_tr_b16 a[22:23], v106 offset:61952
    buffer_load_dwordx4 v105, s[72:75], s33 offen offset:1024 lds
    s_waitcnt lgkmcnt(12)
    v_mfma_f32_16x16x32_bf16 v[120:123], v[92:95], v[112:115], v[120:123]
    v_mfma_f32_16x16x32_bf16 v[124:127], v[112:115], v[112:115], v[124:127]
    v_mfma_f32_16x16x32_bf16 v[120:123], v[92:95], v[116:119], v[120:123]
    v_mfma_f32_16x16x32_bf16 v[124:127], v[116:119], v[116:119], v[124:127]
    v_mfma_f32_16x16x32_bf16 v[80:83], a[8:11], v[92:95], v[80:83]
    v_mfma_f32_16x16x32_bf16 v[84:87], a[72:75], v[92:95], v[84:87]
    v_mfma_f32_16x16x32_bf16 v[88:91], v[92:95], a[136:139], v[88:91]
    v_mfma_f32_16x16x32_bf16 v[36:39], a[76:79], a[240:243], v[36:39]
    ds_read_b128 a[196:199], v110 offset:20480
    ds_read_b64_tr_b16 a[84:85], v106 offset:62464
    ds_read_b64_tr_b16 a[86:87], v106 offset:62976
    v_mfma_f32_16x16x32_bf16 v[40:43], a[240:243], a[140:143], v[40:43]
    s_waitcnt lgkmcnt(14)
    ds_read_b64_tr_b16 a[148:149], v106 offset:63488
    ds_read_b64_tr_b16 a[150:151], v106 offset:64000
    buffer_load_dwordx4 v105, s[72:75], s33 offen offset:2048 lds
    v_mfma_f32_16x16x32_bf16 v[48:51], a[76:79], a[244:247], v[48:51]
    ds_read_b128 a[200:203], v110 offset:36864
    v_mfma_f32_16x16x32_bf16 v[52:55], a[244:247], a[140:143], v[52:55]
    s_waitcnt lgkmcnt(15)
    s_add_u32 m0, s34, 36864
    s_add_u32 s33, s33, 98304
    buffer_load_dwordx4 v105, s[72:75], s33 offen offset:0 lds
    v_mfma_f32_16x16x32_bf16 v[60:63], a[76:79], a[248:251], v[60:63]
    ds_read_b128 a[204:207], v110 offset:53248
    v_mfma_f32_16x16x32_bf16 v[64:67], a[248:251], a[140:143], v[64:67]
    s_waitcnt lgkmcnt(15)
    buffer_load_dwordx4 v105, s[72:75], s33 offen offset:1024 lds
    v_mfma_f32_16x16x32_bf16 v[72:75], a[76:79], a[252:255], v[72:75]
    ds_read_b128 a[208:211], v111 offset:4096
    v_mfma_f32_16x16x32_bf16 v[76:79], a[252:255], a[140:143], v[76:79]
    s_waitcnt lgkmcnt(12)
    buffer_load_dwordx4 v105, s[72:75], s33 offen offset:2048 lds
    ds_read_b128 v[112:115], v142 offset:4096
    ds_read_b128 v[116:119], v143 offset:4096
    v_mfma_f32_16x16x32_bf16 v[80:83], a[12:15], v[92:95], v[80:83]
    v_mfma_f32_16x16x32_bf16 v[84:87], a[76:79], v[92:95], v[84:87]
    v_mfma_f32_16x16x32_bf16 v[88:91], v[92:95], a[140:143], v[88:91]
    s_waitcnt lgkmcnt(5)
    v_mfma_f32_16x16x32_bf16 v[36:39], a[80:83], a[192:195], v[36:39]
    ds_read_b128 a[212:215], v111 offset:20480
    v_mfma_f32_16x16x32_bf16 v[40:43], a[192:195], a[144:147], v[40:43]
    s_waitcnt lgkmcnt(10)
    s_add_u32 m0, s37, 12288
    s_add_u32 s35, s35, 128
    buffer_load_dwordx4 v104, s[68:71], s35 offen lds
    v_mfma_f32_16x16x32_bf16 v[48:51], a[80:83], a[196:199], v[48:51]
    ds_read_b128 a[216:219], v111 offset:36864
    v_mfma_f32_16x16x32_bf16 v[52:55], a[196:199], a[144:147], v[52:55]
    s_waitcnt lgkmcnt(6)
    s_add_u32 m0, s37, 13312
    s_add_u32 s31, s31, 128
    buffer_load_dwordx4 v104, s[68:71], s31 offen lds
    s_waitcnt vmcnt(10) lgkmcnt(7)
    s_barrier
    v_mfma_f32_16x16x32_bf16 v[60:63], a[80:83], a[200:203], v[60:63]
    ds_read_b128 a[220:223], v111 offset:53248
    ds_read_b64_tr_b16 a[24:25], v106 offset:0
    ds_read_b64_tr_b16 a[26:27], v106 offset:512
    v_mfma_f32_16x16x32_bf16 v[64:67], a[200:203], a[144:147], v[64:67]
    s_waitcnt lgkmcnt(8)
    ds_read_b64_tr_b16 a[88:89], v106 offset:1024
    ds_read_b64_tr_b16 a[90:91], v106 offset:1536
    s_add_u32 m0, s34, 49152
    s_add_u32 s33, s33, 98304
    buffer_load_dwordx4 v105, s[72:75], s33 offen offset:0 lds
    v_mfma_f32_16x16x32_bf16 v[72:75], a[80:83], a[204:207], v[72:75]
    ds_read_b128 a[224:227], v110 offset:6144
    ds_read_b64_tr_b16 a[152:153], v106 offset:2048
    ds_read_b64_tr_b16 a[154:155], v106 offset:2560
    v_mfma_f32_16x16x32_bf16 v[76:79], a[204:207], a[144:147], v[76:79]
    s_waitcnt lgkmcnt(12)
    ds_read_b64_tr_b16 a[28:29], v106 offset:12288
    ds_read_b64_tr_b16 a[30:31], v106 offset:12800
    buffer_load_dwordx4 v105, s[72:75], s33 offen offset:1024 lds
    s_waitcnt lgkmcnt(12)
    v_mfma_f32_16x16x32_bf16 v[120:123], v[92:95], v[112:115], v[120:123]
    v_mfma_f32_16x16x32_bf16 v[124:127], v[112:115], v[112:115], v[124:127]
    v_mfma_f32_16x16x32_bf16 v[120:123], v[92:95], v[116:119], v[120:123]
    v_mfma_f32_16x16x32_bf16 v[124:127], v[116:119], v[116:119], v[124:127]
    v_mfma_f32_16x16x32_bf16 v[80:83], a[16:19], v[92:95], v[80:83]
    v_mfma_f32_16x16x32_bf16 v[84:87], a[80:83], v[92:95], v[84:87]
    v_mfma_f32_16x16x32_bf16 v[88:91], v[92:95], a[144:147], v[88:91]
    v_mfma_f32_16x16x32_bf16 v[36:39], a[84:87], a[208:211], v[36:39]
    ds_read_b128 a[228:231], v110 offset:22528
    ds_read_b64_tr_b16 a[92:93], v106 offset:13312
    ds_read_b64_tr_b16 a[94:95], v106 offset:13824
    v_mfma_f32_16x16x32_bf16 v[40:43], a[208:211], a[148:151], v[40:43]
    s_waitcnt lgkmcnt(14)
    ds_read_b64_tr_b16 a[156:157], v106 offset:14336
    ds_read_b64_tr_b16 a[158:159], v106 offset:14848
    buffer_load_dwordx4 v105, s[72:75], s33 offen offset:2048 lds
    v_mfma_f32_16x16x32_bf16 v[48:51], a[84:87], a[212:215], v[48:51]
    ds_read_b128 a[232:235], v110 offset:38912
    v_mfma_f32_16x16x32_bf16 v[52:55], a[212:215], a[148:151], v[52:55]
    s_waitcnt lgkmcnt(15)
    s_add_u32 m0, s34, 61440
    s_add_u32 s33, s33, 98304
    buffer_load_dwordx4 v105, s[72:75], s33 offen offset:0 lds
    v_mfma_f32_16x16x32_bf16 v[60:63], a[84:87], a[216:219], v[60:63]
    ds_read_b128 a[236:239], v110 offset:55296
    v_mfma_f32_16x16x32_bf16 v[64:67], a[216:219], a[148:151], v[64:67]
    s_waitcnt lgkmcnt(15)
    buffer_load_dwordx4 v105, s[72:75], s33 offen offset:1024 lds
    v_mfma_f32_16x16x32_bf16 v[72:75], a[84:87], a[220:223], v[72:75]
    ds_read_b128 a[240:243], v111 offset:6144
    v_mfma_f32_16x16x32_bf16 v[76:79], a[220:223], a[148:151], v[76:79]
    s_waitcnt lgkmcnt(12)
    buffer_load_dwordx4 v105, s[72:75], s33 offen offset:2048 lds
    ds_read_b128 v[112:115], v142 offset:6144
    ds_read_b128 v[116:119], v143 offset:6144
    v_mfma_f32_16x16x32_bf16 v[80:83], a[20:23], v[92:95], v[80:83]
    v_mfma_f32_16x16x32_bf16 v[84:87], a[84:87], v[92:95], v[84:87]
    v_mfma_f32_16x16x32_bf16 v[88:91], v[92:95], a[148:151], v[88:91]
    s_waitcnt lgkmcnt(5)
    v_mfma_f32_16x16x32_bf16 v[36:39], a[88:91], a[224:227], v[36:39]
    ds_read_b128 a[244:247], v111 offset:22528
    v_mfma_f32_16x16x32_bf16 v[40:43], a[224:227], a[152:155], v[40:43]
    s_waitcnt lgkmcnt(10)
    s_add_u32 m0, s37, 14336
    s_add_u32 s35, s35, 128
    buffer_load_dwordx4 v104, s[68:71], s35 offen lds
    v_mfma_f32_16x16x32_bf16 v[48:51], a[88:91], a[228:231], v[48:51]
    ds_read_b128 a[248:251], v111 offset:38912
    v_mfma_f32_16x16x32_bf16 v[52:55], a[228:231], a[152:155], v[52:55]
    s_waitcnt lgkmcnt(6)
    s_add_u32 m0, s37, 15360
    s_add_u32 s31, s31, 128
    buffer_load_dwordx4 v104, s[68:71], s31 offen lds
    s_waitcnt vmcnt(10) lgkmcnt(7)
    s_barrier
    v_mfma_f32_16x16x32_bf16 v[60:63], a[88:91], a[232:235], v[60:63]
    ds_read_b128 a[252:255], v111 offset:55296
    ds_read_b64_tr_b16 a[32:33], v106 offset:24576
    ds_read_b64_tr_b16 a[34:35], v106 offset:25088
    v_mfma_f32_16x16x32_bf16 v[64:67], a[232:235], a[152:155], v[64:67]
    s_waitcnt lgkmcnt(8)
    ds_read_b64_tr_b16 a[96:97], v106 offset:25600
    ds_read_b64_tr_b16 a[98:99], v106 offset:26112
    s_add_u32 m0, s34, 0
    s_add_u32 s33, s33, 98304
    buffer_load_dwordx4 v105, s[72:75], s33 offen offset:0 lds
    v_mfma_f32_16x16x32_bf16 v[72:75], a[88:91], a[236:239], v[72:75]
    ds_read_b128 a[192:195], v110 offset:8192
    ds_read_b64_tr_b16 a[160:161], v106 offset:26624
    ds_read_b64_tr_b16 a[162:163], v106 offset:27136
    v_mfma_f32_16x16x32_bf16 v[76:79], a[236:239], a[152:155], v[76:79]
    s_waitcnt lgkmcnt(12)
    ds_read_b64_tr_b16 a[36:37], v106 offset:36864
    ds_read_b64_tr_b16 a[38:39], v106 offset:37376
    buffer_load_dwordx4 v105, s[72:75], s33 offen offset:1024 lds
    s_waitcnt lgkmcnt(12)
    v_mfma_f32_16x16x32_bf16 v[120:123], v[92:95], v[112:115], v[120:123]
    v_mfma_f32_16x16x32_bf16 v[124:127], v[112:115], v[112:115], v[124:127]
    v_mfma_f32_16x16x32_bf16 v[120:123], v[92:95], v[116:119], v[120:123]
    v_mfma_f32_16x16x32_bf16 v[124:127], v[116:119], v[116:119], v[124:127]
    ds_read_b128 v[112:115], v142 offset:8192
    ds_read_b128 v[116:119], v143 offset:8192
    v_mfma_f32_16x16x32_bf16 v[80:83], a[24:27], v[92:95], v[80:83]
    v_mfma_f32_16x16x32_bf16 v[84:87], a[88:91], v[92:95], v[84:87]
    v_mfma_f32_16x16x32_bf16 v[88:91], v[92:95], a[152:155], v[88:91]
    v_mfma_f32_16x16x32_bf16 v[36:39], a[92:95], a[240:243], v[36:39]
    ds_read_b128 a[196:199], v110 offset:24576
    ds_read_b64_tr_b16 a[100:101], v106 offset:37888
    ds_read_b64_tr_b16 a[102:103], v106 offset:38400
    v_mfma_f32_16x16x32_bf16 v[40:43], a[240:243], a[156:159], v[40:43]
    s_waitcnt lgkmcnt(15)
    ds_read_b64_tr_b16 a[164:165], v106 offset:38912
    ds_read_b64_tr_b16 a[166:167], v106 offset:39424
    buffer_load_dwordx4 v105, s[72:75], s33 offen offset:2048 lds
    v_mfma_f32_16x16x32_bf16 v[48:51], a[92:95], a[244:247], v[48:51]
    ds_read_b128 a[200:203], v110 offset:40960
    v_mfma_f32_16x16x32_bf16 v[52:55], a[244:247], a[156:159], v[52:55]
    s_waitcnt lgkmcnt(15)
    s_add_u32 m0, s34, 12288
    s_add_u32 s33, s33, 98304
    buffer_load_dwordx4 v105, s[72:75], s33 offen offset:0 lds
    v_mfma_f32_16x16x32_bf16 v[60:63], a[92:95], a[248:251], v[60:63]
    ds_read_b128 a[204:207], v110 offset:57344
    v_mfma_f32_16x16x32_bf16 v[64:67], a[248:251], a[156:159], v[64:67]
    s_waitcnt lgkmcnt(15)
    buffer_load_dwordx4 v105, s[72:75], s33 offen offset:1024 lds
    v_mfma_f32_16x16x32_bf16 v[72:75], a[92:95], a[252:255], v[72:75]
    ds_read_b128 a[208:211], v111 offset:8192
    v_mfma_f32_16x16x32_bf16 v[76:79], a[252:255], a[156:159], v[76:79]
    s_waitcnt lgkmcnt(14)
    buffer_load_dwordx4 v105, s[72:75], s33 offen offset:2048 lds
    s_waitcnt lgkmcnt(8)
    v_mfma_f32_16x16x32_bf16 v[120:123], v[92:95], v[112:115], v[120:123]
    v_mfma_f32_16x16x32_bf16 v[124:127], v[112:115], v[112:115], v[124:127]
    v_mfma_f32_16x16x32_bf16 v[120:123], v[92:95], v[116:119], v[120:123]
    v_mfma_f32_16x16x32_bf16 v[124:127], v[116:119], v[116:119], v[124:127]
    ds_read_b128 v[112:115], v142 offset:10240
    ds_read_b128 v[116:119], v143 offset:10240
    v_mfma_f32_16x16x32_bf16 v[80:83], a[28:31], v[92:95], v[80:83]
    v_mfma_f32_16x16x32_bf16 v[84:87], a[92:95], v[92:95], v[84:87]
    v_mfma_f32_16x16x32_bf16 v[88:91], v[92:95], a[156:159], v[88:91]
    s_waitcnt lgkmcnt(5)
    v_mfma_f32_16x16x32_bf16 v[36:39], a[96:99], a[192:195], v[36:39]
    ds_read_b128 a[212:215], v111 offset:24576
    v_mfma_f32_16x16x32_bf16 v[40:43], a[192:195], a[160:163], v[40:43]
    s_waitcnt lgkmcnt(10)
    s_waitcnt lgkmcnt(1)
    v_mfma_f32_16x16x32_bf16 v[48:51], a[96:99], a[196:199], v[48:51]
    ds_read_b128 a[216:219], v111 offset:40960
    v_mfma_f32_16x16x32_bf16 v[52:55], a[196:199], a[160:163], v[52:55]
    s_waitcnt lgkmcnt(6)
    v_mfma_f32_16x16x32_bf16 v[120:123], v[92:95], v[112:115], v[120:123]
    s_waitcnt vmcnt(8) lgkmcnt(7)
    s_barrier
    v_mfma_f32_16x16x32_bf16 v[60:63], a[96:99], a[200:203], v[60:63]
    ds_read_b128 a[220:223], v111 offset:57344
    ds_read_b64_tr_b16 a[40:41], v106 offset:49152
    ds_read_b64_tr_b16 a[42:43], v106 offset:49664
    v_mfma_f32_16x16x32_bf16 v[64:67], a[200:203], a[160:163], v[64:67]
    s_waitcnt lgkmcnt(8)
    ds_read_b64_tr_b16 a[104:105], v106 offset:50176
    ds_read_b64_tr_b16 a[106:107], v106 offset:50688
    s_add_u32 m0, s34, 24576
    s_add_u32 s33, s33, 98304
    buffer_load_dwordx4 v105, s[72:75], s33 offen offset:0 lds
    v_mfma_f32_16x16x32_bf16 v[72:75], a[96:99], a[204:207], v[72:75]
    ds_read_b128 a[224:227], v110 offset:10240
    ds_read_b64_tr_b16 a[168:169], v106 offset:51200
    ds_read_b64_tr_b16 a[170:171], v106 offset:51712
    v_mfma_f32_16x16x32_bf16 v[76:79], a[204:207], a[160:163], v[76:79]
    s_waitcnt lgkmcnt(12)
    ds_read_b64_tr_b16 a[44:45], v106 offset:61440
    ds_read_b64_tr_b16 a[46:47], v106 offset:61952
    buffer_load_dwordx4 v105, s[72:75], s33 offen offset:1024 lds
    v_mfma_f32_16x16x32_bf16 v[124:127], v[112:115], v[112:115], v[124:127]
    v_mfma_f32_16x16x32_bf16 v[120:123], v[92:95], v[116:119], v[120:123]
    v_mfma_f32_16x16x32_bf16 v[124:127], v[116:119], v[116:119], v[124:127]
    v_mfma_f32_16x16x32_bf16 v[80:83], a[32:35], v[92:95], v[80:83]
    v_mfma_f32_16x16x32_bf16 v[84:87], a[96:99], v[92:95], v[84:87]
    v_mfma_f32_16x16x32_bf16 v[88:91], v[92:95], a[160:163], v[88:91]
    v_mfma_f32_16x16x32_bf16 v[36:39], a[100:103], a[208:211], v[36:39]
    ds_read_b128 a[228:231], v110 offset:26624
    ds_read_b64_tr_b16 a[108:109], v106 offset:62464
    ds_read_b64_tr_b16 a[110:111], v106 offset:62976
    v_mfma_f32_16x16x32_bf16 v[40:43], a[208:211], a[164:167], v[40:43]
    s_waitcnt lgkmcnt(14)
    ds_read_b64_tr_b16 a[172:173], v106 offset:63488
    ds_read_b64_tr_b16 a[174:175], v106 offset:64000
    buffer_load_dwordx4 v105, s[72:75], s33 offen offset:2048 lds
    v_mfma_f32_16x16x32_bf16 v[48:51], a[100:103], a[212:215], v[48:51]
    ds_read_b128 a[232:235], v110 offset:43008
    v_mfma_f32_16x16x32_bf16 v[52:55], a[212:215], a[164:167], v[52:55]
    s_waitcnt lgkmcnt(15)
    s_add_u32 m0, s34, 36864
    s_add_u32 s33, s33, 98304
    buffer_load_dwordx4 v105, s[72:75], s33 offen offset:0 lds
    v_mfma_f32_16x16x32_bf16 v[60:63], a[100:103], a[216:219], v[60:63]
    ds_read_b128 a[236:239], v110 offset:59392
    v_mfma_f32_16x16x32_bf16 v[64:67], a[216:219], a[164:167], v[64:67]
    s_waitcnt lgkmcnt(15)
    buffer_load_dwordx4 v105, s[72:75], s33 offen offset:1024 lds
    v_mfma_f32_16x16x32_bf16 v[72:75], a[100:103], a[220:223], v[72:75]
    ds_read_b128 a[240:243], v111 offset:10240
    v_mfma_f32_16x16x32_bf16 v[76:79], a[220:223], a[164:167], v[76:79]
    s_waitcnt lgkmcnt(12)
    buffer_load_dwordx4 v105, s[72:75], s33 offen offset:2048 lds
    ds_read_b128 v[112:115], v142 offset:12288
    ds_read_b128 v[116:119], v143 offset:12288
    v_mfma_f32_16x16x32_bf16 v[80:83], a[36:39], v[92:95], v[80:83]
    v_mfma_f32_16x16x32_bf16 v[84:87], a[100:103], v[92:95], v[84:87]
    v_mfma_f32_16x16x32_bf16 v[88:91], v[92:95], a[164:167], v[88:91]
    s_waitcnt lgkmcnt(5)
    v_mfma_f32_16x16x32_bf16 v[36:39], a[104:107], a[224:227], v[36:39]
    ds_read_b128 a[244:247], v111 offset:26624
    v_mfma_f32_16x16x32_bf16 v[40:43], a[224:227], a[168:171], v[40:43]
    s_waitcnt lgkmcnt(10)
    s_waitcnt lgkmcnt(1)
    v_mfma_f32_16x16x32_bf16 v[48:51], a[104:107], a[228:231], v[48:51]
    ds_read_b128 a[248:251], v111 offset:43008
    v_mfma_f32_16x16x32_bf16 v[52:55], a[228:231], a[168:171], v[52:55]
    s_waitcnt lgkmcnt(6)
    v_mfma_f32_16x16x32_bf16 v[120:123], v[92:95], v[112:115], v[120:123]
    s_waitcnt vmcnt(6) lgkmcnt(7)
    s_barrier
    v_mfma_f32_16x16x32_bf16 v[60:63], a[104:107], a[232:235], v[60:63]
    ds_read_b128 a[252:255], v111 offset:59392
    ds_read_b64_tr_b16 a[48:49], v106 offset:0
    ds_read_b64_tr_b16 a[50:51], v106 offset:512
    v_mfma_f32_16x16x32_bf16 v[64:67], a[232:235], a[168:171], v[64:67]
    s_waitcnt lgkmcnt(8)
    ds_read_b64_tr_b16 a[112:113], v106 offset:1024
    ds_read_b64_tr_b16 a[114:115], v106 offset:1536
    s_add_u32 m0, s89, 0
    s_nop 0
    buffer_load_dwordx4 v108, s[76:79], s80 offen lds
    v_mfma_f32_16x16x32_bf16 v[72:75], a[104:107], a[236:239], v[72:75]
    ds_read_b128 a[192:195], v110 offset:12288
    ds_read_b64_tr_b16 a[176:177], v106 offset:2048
    ds_read_b64_tr_b16 a[178:179], v106 offset:2560
    v_mfma_f32_16x16x32_bf16 v[76:79], a[236:239], a[168:171], v[76:79]
    s_waitcnt lgkmcnt(12)
    ds_read_b64_tr_b16 a[52:53], v106 offset:12288
    ds_read_b64_tr_b16 a[54:55], v106 offset:12800
    s_add_u32 m0, s89, 1024
    s_add_u32 s80, s80, s81
    buffer_load_dwordx4 v108, s[76:79], s80 offen lds
    v_mfma_f32_16x16x32_bf16 v[124:127], v[112:115], v[112:115], v[124:127]
    v_mfma_f32_16x16x32_bf16 v[120:123], v[92:95], v[116:119], v[120:123]
    v_mfma_f32_16x16x32_bf16 v[124:127], v[116:119], v[116:119], v[124:127]
    v_mfma_f32_16x16x32_bf16 v[80:83], a[40:43], v[92:95], v[80:83]
    v_mfma_f32_16x16x32_bf16 v[84:87], a[104:107], v[92:95], v[84:87]
    v_mfma_f32_16x16x32_bf16 v[88:91], v[92:95], a[168:171], v[88:91]
    v_mfma_f32_16x16x32_bf16 v[36:39], a[108:111], a[240:243], v[36:39]
    ds_read_b128 a[196:199], v110 offset:28672
    ds_read_b64_tr_b16 a[116:117], v106 offset:13312
    ds_read_b64_tr_b16 a[118:119], v106 offset:13824
    v_mfma_f32_16x16x32_bf16 v[40:43], a[240:243], a[172:175], v[40:43]
    s_waitcnt lgkmcnt(14)
    ds_read_b64_tr_b16 a[180:181], v106 offset:14336
    ds_read_b64_tr_b16 a[182:183], v106 offset:14848
    s_add_u32 m0, s89, 2048
    s_add_u32 s80, s80, s81
    buffer_load_dwordx4 v108, s[76:79], s80 offen lds
    v_mfma_f32_16x16x32_bf16 v[48:51], a[108:111], a[244:247], v[48:51]
    ds_read_b128 a[200:203], v110 offset:45056
    v_mfma_f32_16x16x32_bf16 v[52:55], a[244:247], a[172:175], v[52:55]
    s_waitcnt lgkmcnt(15)
    s_add_u32 m0, s89, 3072
    s_add_u32 s80, s80, s81
    buffer_load_dwordx4 v108, s[76:79], s80 offen lds
    v_mfma_f32_16x16x32_bf16 v[60:63], a[108:111], a[248:251], v[60:63]
    ds_read_b128 a[204:207], v110 offset:61440
    v_mfma_f32_16x16x32_bf16 v[64:67], a[248:251], a[172:175], v[64:67]
    s_waitcnt lgkmcnt(15)
    v_mfma_f32_16x16x32_bf16 v[72:75], a[108:111], a[252:255], v[72:75]
    ds_read_b128 a[208:211], v111 offset:12288
    v_mfma_f32_16x16x32_bf16 v[76:79], a[252:255], a[172:175], v[76:79]
    s_waitcnt lgkmcnt(12)
    ds_read_b128 v[112:115], v142 offset:14336
    ds_read_b128 v[116:119], v143 offset:14336
    v_mfma_f32_16x16x32_bf16 v[80:83], a[44:47], v[92:95], v[80:83]
    v_mfma_f32_16x16x32_bf16 v[84:87], a[108:111], v[92:95], v[84:87]
    v_mfma_f32_16x16x32_bf16 v[88:91], v[92:95], a[172:175], v[88:91]
    s_waitcnt lgkmcnt(5)
    v_mfma_f32_16x16x32_bf16 v[36:39], a[112:115], a[192:195], v[36:39]
    ds_read_b128 a[212:215], v111 offset:28672
    v_mfma_f32_16x16x32_bf16 v[40:43], a[192:195], a[176:179], v[40:43]
    s_waitcnt lgkmcnt(10)
    s_waitcnt lgkmcnt(1)
    v_mfma_f32_16x16x32_bf16 v[48:51], a[112:115], a[196:199], v[48:51]
    ds_read_b128 a[216:219], v111 offset:45056
    v_mfma_f32_16x16x32_bf16 v[52:55], a[196:199], a[176:179], v[52:55]
    s_waitcnt lgkmcnt(6)
    v_mfma_f32_16x16x32_bf16 v[120:123], v[92:95], v[112:115], v[120:123]
    s_waitcnt vmcnt(4) lgkmcnt(7)
    s_barrier
    v_mfma_f32_16x16x32_bf16 v[60:63], a[112:115], a[200:203], v[60:63]
    ds_read_b128 a[220:223], v111 offset:61440
    ds_read_b64_tr_b16 a[56:57], v106 offset:24576
    ds_read_b64_tr_b16 a[58:59], v106 offset:25088
    v_mfma_f32_16x16x32_bf16 v[64:67], a[200:203], a[176:179], v[64:67]
    s_waitcnt lgkmcnt(8)
    ds_read_b64_tr_b16 a[120:121], v106 offset:25600
    ds_read_b64_tr_b16 a[122:123], v106 offset:26112
    s_add_u32 m0, s65, 0
    s_nop 0
    buffer_load_dwordx4 v107, s[72:75], s90 offen lds
    v_mfma_f32_16x16x32_bf16 v[72:75], a[112:115], a[204:207], v[72:75]
    ds_read_b128 a[224:227], v110 offset:14336
    ds_read_b64_tr_b16 a[184:185], v106 offset:26624
    ds_read_b64_tr_b16 a[186:187], v106 offset:27136
    v_mfma_f32_16x16x32_bf16 v[76:79], a[204:207], a[176:179], v[76:79]
    s_waitcnt lgkmcnt(12)
    ds_read_b64_tr_b16 a[60:61], v106 offset:36864
    ds_read_b64_tr_b16 a[62:63], v106 offset:37376
    s_add_u32 m0, s65, 1024
    s_add_u32 s90, s90, 24576
    buffer_load_dwordx4 v107, s[72:75], s90 offen lds
    v_mfma_f32_16x16x32_bf16 v[124:127], v[112:115], v[112:115], v[124:127]
    v_mfma_f32_16x16x32_bf16 v[120:123], v[92:95], v[116:119], v[120:123]
    v_mfma_f32_16x16x32_bf16 v[124:127], v[116:119], v[116:119], v[124:127]
    v_mfma_f32_16x16x32_bf16 v[80:83], a[48:51], v[92:95], v[80:83]
    v_mfma_f32_16x16x32_bf16 v[84:87], a[112:115], v[92:95], v[84:87]
    v_mfma_f32_16x16x32_bf16 v[88:91], v[92:95], a[176:179], v[88:91]
    v_mfma_f32_16x16x32_bf16 v[36:39], a[116:119], a[208:211], v[36:39]
    ds_read_b128 a[228:231], v110 offset:30720
    ds_read_b64_tr_b16 a[124:125], v106 offset:37888
    ds_read_b64_tr_b16 a[126:127], v106 offset:38400
    v_mfma_f32_16x16x32_bf16 v[40:43], a[208:211], a[180:183], v[40:43]
    s_waitcnt lgkmcnt(14)
    ds_read_b64_tr_b16 a[188:189], v106 offset:38912
    ds_read_b64_tr_b16 a[190:191], v106 offset:39424
    s_add_u32 m0, s65, 2048
    s_add_u32 s90, s90, 24576
    buffer_load_dwordx4 v107, s[72:75], s90 offen lds
    v_mfma_f32_16x16x32_bf16 v[48:51], a[116:119], a[212:215], v[48:51]
    ds_read_b128 a[232:235], v110 offset:47104
    v_cndmask_b32 v124, v124, v125, s[92:93]
    v_mfma_f32_16x16x32_bf16 v[52:55], a[212:215], a[180:183], v[52:55]
    s_waitcnt lgkmcnt(15)
    s_add_u32 m0, s65, 3072
    s_add_u32 s90, s90, 24576
    buffer_load_dwordx4 v107, s[72:75], s90 offen lds
    v_cndmask_b32 v126, v126, v127, s[92:93]
    v_cndmask_b32 v124, v124, v126, s[94:95]
    v_mfma_f32_16x16x32_bf16 v[60:63], a[116:119], a[216:219], v[60:63]
    ds_read_b128 a[236:239], v110 offset:63488
    v_cndmask_b32 v121, 0, v124, s[18:19]
    v_mul_f32 v120, 0x3e800000, v120
    s_nop 1
    v_permlane32_swap_b32 v120, v121
    v_mfma_f32_16x16x32_bf16 v[64:67], a[216:219], a[180:183], v[64:67]
    s_waitcnt lgkmcnt(15)
    v_add_f32 v120, v120, v121
    v_mov_b32 v121, v120
    s_nop 1
    v_permlane16_swap_b32 v120, v121
    v_mfma_f32_16x16x32_bf16 v[72:75], a[116:119], a[220:223], v[72:75]
    ds_read_b128 a[240:243], v111 offset:14336
    v_add_f32 v120, v120, v121
    v_mov_b32 v121, v120
    s_nop 1
    v_permlane32_swap_b32 v120, v121
    v_mfma_f32_16x16x32_bf16 v[76:79], a[220:223], a[180:183], v[76:79]
    s_waitcnt lgkmcnt(12)
    v_mul_f32 v120, 0x3b000000, v120
    v_mul_f32 v121, 0x3b000000, v121
    v_fma_f32 v121, -v120, v120, v121
    v_max_f32 v121, 0, v121
    v_add_f32 v122, 0x3727c5ac, v121
    v_rsq_f32 v122, v122
    s_nop 0
    v_mul_f32_e64 v123, -v120, v122
    ds_write2_b32 v9, v122, v123 offset0:0 offset1:64
    v_mfma_f32_16x16x32_bf16 v[80:83], a[52:55], v[92:95], v[80:83]
    v_mfma_f32_16x16x32_bf16 v[84:87], a[116:119], v[92:95], v[84:87]
    v_mfma_f32_16x16x32_bf16 v[88:91], v[92:95], a[180:183], v[88:91]
    s_waitcnt lgkmcnt(4)
    v_mfma_f32_16x16x32_bf16 v[36:39], a[120:123], a[224:227], v[36:39]
    ds_read_b128 a[244:247], v111 offset:30720
    v_mfma_f32_16x16x32_bf16 v[40:43], a[224:227], a[184:187], v[40:43]
    s_waitcnt lgkmcnt(9)
    v_mfma_f32_16x16x32_bf16 v[48:51], a[120:123], a[228:231], v[48:51]
    ds_read_b128 a[248:251], v111 offset:47104
    v_mfma_f32_16x16x32_bf16 v[52:55], a[228:231], a[184:187], v[52:55]
    s_waitcnt lgkmcnt(5)
    v_mov_b32 v144, 0
    global_load_dword v145, v144, s[96:97] sc1
    s_lshl_b32 s20, s10, 12
    s_add_u32 s76, s4, s20
    s_addc_u32 s77, s5, 0
    v_mfma_f32_16x16x32_bf16 v[60:63], a[120:123], a[232:235], v[60:63]
    ds_read_b128 a[252:255], v111 offset:63488
    v_mfma_f32_16x16x32_bf16 v[64:67], a[232:235], a[184:187], v[64:67]
    s_waitcnt lgkmcnt(5)
    ds_read_b128 a[192:195], v110 offset:0
    v_mfma_f32_16x16x32_bf16 v[72:75], a[120:123], a[236:239], v[72:75]
    ds_read_b128 a[196:199], v110 offset:16384
    v_mfma_f32_16x16x32_bf16 v[76:79], a[236:239], a[184:187], v[76:79]
    s_waitcnt lgkmcnt(6)
    ds_read_b128 a[200:203], v110 offset:32768
    v_mfma_f32_16x16x32_bf16 v[80:83], a[56:59], v[92:95], v[80:83]
    v_mfma_f32_16x16x32_bf16 v[84:87], a[120:123], v[92:95], v[84:87]
    v_mfma_f32_16x16x32_bf16 v[88:91], v[92:95], a[184:187], v[88:91]
    v_mfma_f32_16x16x32_bf16 v[36:39], a[124:127], a[240:243], v[36:39]
    ds_read_b128 a[204:207], v110 offset:49152
    v_mfma_f32_16x16x32_bf16 v[40:43], a[240:243], a[188:191], v[40:43]
    s_waitcnt lgkmcnt(6)
    ds_read_b128 a[208:211], v111 offset:0
    s_waitcnt lgkmcnt(8)
    s_barrier
    ds_read2_b32 v[28:29], v12 offset0:0 offset1:64
    ds_read_b128 v[96:99], v13 offset:0
    ds_read_b128 v[100:103], v13 offset:256
    v_mfma_f32_16x16x32_bf16 v[48:51], a[124:127], a[244:247], v[48:51]
    ds_read_b128 a[212:215], v111 offset:16384
    v_mfma_f32_16x16x32_bf16 v[52:55], a[244:247], a[188:191], v[52:55]
    s_waitcnt lgkmcnt(10)
    ds_read_b128 a[216:219], v111 offset:32768
    v_mfma_f32_16x16x32_bf16 v[60:63], a[124:127], a[248:251], v[60:63]
    ds_read_b128 a[220:223], v111 offset:49152
    v_mfma_f32_16x16x32_bf16 v[64:67], a[248:251], a[188:191], v[64:67]
    s_waitcnt lgkmcnt(11)
    ds_read_b128 a[224:227], v110 offset:2048
    v_mfma_f32_16x16x32_bf16 v[72:75], a[124:127], a[252:255], v[72:75]
    ds_read_b128 a[228:231], v110 offset:18432
    v_mfma_f32_16x16x32_bf16 v[76:79], a[252:255], a[188:191], v[76:79]
    s_waitcnt lgkmcnt(12)
    v_mfma_f32_16x16x32_bf16 v[80:83], a[60:63], v[92:95], v[80:83]
    v_mfma_f32_16x16x32_bf16 v[84:87], a[124:127], v[92:95], v[84:87]
    v_mfma_f32_16x16x32_bf16 v[88:91], v[92:95], a[188:191], v[88:91]
    ds_read2_b32 v[30:31], v12 offset0:16 offset1:80
    ds_read_b128 v[16:19], v13 offset:64
    ds_read_b128 v[92:95], v13 offset:320
    s_waitcnt lgkmcnt(8)
    v_pk_mul_f32 v[40:41], v[40:41], v[96:97]
    v_pk_mul_f32 v[42:43], v[42:43], v[98:99]
    s_nop 1
    v_pk_fma_f32 v[40:41], v[100:101], v[88:89], v[40:41] op_sel_hi:[1,0,1]
    v_pk_fma_f32 v[42:43], v[102:103], v[88:89], v[42:43] op_sel_hi:[1,0,1]
    v_pk_mul_f32 v[36:37], v[36:37], v[28:29] op_sel_hi:[1,0]
    v_pk_mul_f32 v[38:39], v[38:39], v[28:29] op_sel_hi:[1,0]
    v_pk_fma_f32 v[36:37], v[84:85], v[28:29], v[36:37] op_sel:[0,1,0] op_sel_hi:[1,1,1]
    v_pk_fma_f32 v[38:39], v[86:87], v[28:29], v[38:39] op_sel:[0,1,0] op_sel_hi:[1,1,1]
    v_cvt_pk_bf16_f32 v24, v40, v41
    v_cvt_pk_bf16_f32 v25, v42, v43
    v_cvt_pk_bf16_f32 v20, v36, v37
    v_cvt_pk_bf16_f32 v21, v38, v39
    v_pk_mul_f32 v[36:37], v[28:29], v[4:5] op_sel_hi:[1,0]
    ds_read2_b32 v[28:29], v12 offset0:32 offset1:96
    ds_read_b128 v[96:99], v13 offset:128
    ds_read_b128 v[100:103], v13 offset:384
    s_waitcnt lgkmcnt(3)
    v_pk_mul_f32 v[52:53], v[52:53], v[16:17]
    v_pk_mul_f32 v[54:55], v[54:55], v[18:19]
    v_pk_fma_f32 v[52:53], v[92:93], v[88:89], v[52:53] op_sel_hi:[1,0,1]
    v_pk_fma_f32 v[54:55], v[94:95], v[88:89], v[54:55] op_sel_hi:[1,0,1]
    v_pk_mul_f32 v[48:49], v[48:49], v[30:31] op_sel_hi:[1,0]
    v_pk_mul_f32 v[50:51], v[50:51], v[30:31] op_sel_hi:[1,0]
    v_pk_fma_f32 v[48:49], v[84:85], v[30:31], v[48:49] op_sel:[0,1,0] op_sel_hi:[1,1,1]
    v_pk_fma_f32 v[50:51], v[86:87], v[30:31], v[50:51] op_sel:[0,1,0] op_sel_hi:[1,1,1]
    v_cvt_pk_bf16_f32 v26, v52, v53
    v_cvt_pk_bf16_f32 v27, v54, v55
    v_cvt_pk_bf16_f32 v22, v48, v49
    v_cvt_pk_bf16_f32 v23, v50, v51
    v_pk_mul_f32 v[48:49], v[30:31], v[4:5] op_sel_hi:[1,0]
    buffer_store_dwordx4 v[24:27], v1, s[4:7], s30 offen offset:0 sc1
    v_permlane32_swap_b32 v20, v22
    v_permlane32_swap_b32 v21, v23
    buffer_store_dwordx4 v[20:23], v11, s[4:7], s29 offen offset:0 sc1
    ds_read2_b32 v[30:31], v12 offset0:48 offset1:112
    ds_read_b128 v[16:19], v13 offset:192
    ds_read_b128 v[92:95], v13 offset:448
    s_waitcnt lgkmcnt(3)
    v_pk_mul_f32 v[64:65], v[64:65], v[96:97]
    v_pk_mul_f32 v[66:67], v[66:67], v[98:99]
    v_pk_fma_f32 v[64:65], v[100:101], v[88:89], v[64:65] op_sel_hi:[1,0,1]
    v_pk_fma_f32 v[66:67], v[102:103], v[88:89], v[66:67] op_sel_hi:[1,0,1]
    v_pk_mul_f32 v[60:61], v[60:61], v[28:29] op_sel_hi:[1,0]
    v_pk_mul_f32 v[62:63], v[62:63], v[28:29] op_sel_hi:[1,0]
    v_pk_fma_f32 v[60:61], v[84:85], v[28:29], v[60:61] op_sel:[0,1,0] op_sel_hi:[1,1,1]
    v_pk_fma_f32 v[62:63], v[86:87], v[28:29], v[62:63] op_sel:[0,1,0] op_sel_hi:[1,1,1]
    v_cvt_pk_bf16_f32 v24, v64, v65
    v_cvt_pk_bf16_f32 v25, v66, v67
    v_cvt_pk_bf16_f32 v20, v60, v61
    v_cvt_pk_bf16_f32 v21, v62, v63
    v_pk_mul_f32 v[60:61], v[28:29], v[4:5] op_sel_hi:[1,0]
    s_waitcnt lgkmcnt(0)
    v_pk_mul_f32 v[76:77], v[76:77], v[16:17]
    v_pk_mul_f32 v[78:79], v[78:79], v[18:19]
    v_pk_fma_f32 v[76:77], v[92:93], v[88:89], v[76:77] op_sel_hi:[1,0,1]
    v_pk_fma_f32 v[78:79], v[94:95], v[88:89], v[78:79] op_sel_hi:[1,0,1]
    v_pk_mul_f32 v[72:73], v[72:73], v[30:31] op_sel_hi:[1,0]
    v_pk_mul_f32 v[74:75], v[74:75], v[30:31] op_sel_hi:[1,0]
    v_pk_fma_f32 v[72:73], v[84:85], v[30:31], v[72:73] op_sel:[0,1,0] op_sel_hi:[1,1,1]
    v_pk_fma_f32 v[74:75], v[86:87], v[30:31], v[74:75] op_sel:[0,1,0] op_sel_hi:[1,1,1]
    v_cvt_pk_bf16_f32 v26, v76, v77
    v_cvt_pk_bf16_f32 v27, v78, v79
    v_cvt_pk_bf16_f32 v22, v72, v73
    v_cvt_pk_bf16_f32 v23, v74, v75
    v_pk_mul_f32 v[72:73], v[30:31], v[4:5] op_sel_hi:[1,0]
    buffer_store_dwordx4 v[24:27], v1, s[4:7], s30 offen offset:1024 sc1
    v_permlane32_swap_b32 v20, v22
    v_permlane32_swap_b32 v21, v23
    buffer_store_dwordx4 v[20:23], v11, s[4:7], s29 offen offset:1024 sc1
    v_mfma_f32_16x16x32_bf16 v[32:35], a[0:3], a[192:195], 0
    s_waitcnt lgkmcnt(15)
    ds_read_b128 a[232:235], v110 offset:34816
    v_mfma_f32_16x16x32_bf16 v[44:47], a[0:3], a[196:199], 0
    s_waitcnt lgkmcnt(15)
    ds_read_b128 a[236:239], v110 offset:51200
    v_mfma_f32_16x16x32_bf16 v[56:59], a[0:3], a[200:203], 0
    s_waitcnt lgkmcnt(15)
    ds_read_b128 a[240:243], v111 offset:2048
    v_mfma_f32_16x16x32_bf16 v[68:71], a[0:3], a[204:207], 0
    s_waitcnt lgkmcnt(15)
    ds_read_b128 a[244:247], v111 offset:18432
    v_mfma_f32_16x16x32_bf16 v[32:35], a[4:7], a[208:211], v[32:35]
    s_waitcnt lgkmcnt(15)
    ds_read_b128 a[248:251], v111 offset:34816
    v_mfma_f32_16x16x32_bf16 v[44:47], a[4:7], a[212:215], v[44:47]
    s_waitcnt lgkmcnt(15)
    ds_read_b128 a[252:255], v111 offset:51200
    v_mfma_f32_16x16x32_bf16 v[56:59], a[4:7], a[216:219], v[56:59]
    s_waitcnt lgkmcnt(15)
    ds_read_b128 a[192:195], v110 offset:4096
    v_mfma_f32_16x16x32_bf16 v[68:71], a[4:7], a[220:223], v[68:71]
    s_waitcnt lgkmcnt(15)
    ds_read_b128 a[196:199], v110 offset:20480
    v_mfma_f32_16x16x32_bf16 v[32:35], a[8:11], a[224:227], v[32:35]
    s_waitcnt lgkmcnt(15)
    ds_read_b128 a[200:203], v110 offset:36864
    v_mfma_f32_16x16x32_bf16 v[44:47], a[8:11], a[228:231], v[44:47]
    s_waitcnt lgkmcnt(8)
    ds_read_b128 a[204:207], v110 offset:53248
    v_mfma_f32_16x16x32_bf16 v[56:59], a[8:11], a[232:235], v[56:59]
    s_waitcnt lgkmcnt(8)
    ds_read_b128 a[208:211], v111 offset:4096
    v_mfma_f32_16x16x32_bf16 v[68:71], a[8:11], a[236:239], v[68:71]
    s_waitcnt lgkmcnt(8)
    ds_read_b128 a[212:215], v111 offset:20480
    v_mfma_f32_16x16x32_bf16 v[32:35], a[12:15], a[240:243], v[32:35]
    s_waitcnt lgkmcnt(8)
    ds_read_b128 a[216:219], v111 offset:36864
    v_mfma_f32_16x16x32_bf16 v[44:47], a[12:15], a[244:247], v[44:47]
    s_waitcnt lgkmcnt(8)
    ds_read_b128 a[220:223], v111 offset:53248
    v_mfma_f32_16x16x32_bf16 v[56:59], a[12:15], a[248:251], v[56:59]
    s_waitcnt lgkmcnt(8)
    ds_read_b128 a[224:227], v110 offset:6144
    v_mfma_f32_16x16x32_bf16 v[68:71], a[12:15], a[252:255], v[68:71]
    s_waitcnt lgkmcnt(8)
    ds_read_b128 a[228:231], v110 offset:22528
    v_mfma_f32_16x16x32_bf16 v[32:35], a[16:19], a[192:195], v[32:35]
    s_waitcnt lgkmcnt(8)
    ds_read_b128 a[232:235], v110 offset:38912
    v_mfma_f32_16x16x32_bf16 v[44:47], a[16:19], a[196:199], v[44:47]
    s_waitcnt lgkmcnt(8)
    ds_read_b128 a[236:239], v110 offset:55296
    v_mfma_f32_16x16x32_bf16 v[56:59], a[16:19], a[200:203], v[56:59]
    s_waitcnt lgkmcnt(8)
    ds_read_b128 a[240:243], v111 offset:6144
    v_mfma_f32_16x16x32_bf16 v[68:71], a[16:19], a[204:207], v[68:71]
    s_waitcnt lgkmcnt(8)
    ds_read_b128 a[244:247], v111 offset:22528
    v_mfma_f32_16x16x32_bf16 v[32:35], a[20:23], a[208:211], v[32:35]
    s_waitcnt lgkmcnt(8)
    ds_read_b128 a[248:251], v111 offset:38912
    v_mfma_f32_16x16x32_bf16 v[44:47], a[20:23], a[212:215], v[44:47]
    s_waitcnt lgkmcnt(8)
    ds_read_b128 a[252:255], v111 offset:55296
    v_mfma_f32_16x16x32_bf16 v[56:59], a[20:23], a[216:219], v[56:59]
    s_waitcnt lgkmcnt(8)
    ds_read_b128 a[192:195], v110 offset:8192
    v_mfma_f32_16x16x32_bf16 v[68:71], a[20:23], a[220:223], v[68:71]
    s_waitcnt lgkmcnt(8)
    ds_read_b128 a[196:199], v110 offset:24576
    v_mfma_f32_16x16x32_bf16 v[32:35], a[24:27], a[224:227], v[32:35]
    s_waitcnt lgkmcnt(8)
    ds_read_b128 a[200:203], v110 offset:40960
    v_mfma_f32_16x16x32_bf16 v[44:47], a[24:27], a[228:231], v[44:47]
    s_waitcnt lgkmcnt(8)
    ds_read_b128 a[204:207], v110 offset:57344
    v_mfma_f32_16x16x32_bf16 v[56:59], a[24:27], a[232:235], v[56:59]
    s_waitcnt lgkmcnt(8)
    ds_read_b128 a[208:211], v111 offset:8192
    v_mfma_f32_16x16x32_bf16 v[68:71], a[24:27], a[236:239], v[68:71]
    s_waitcnt lgkmcnt(8)
    ds_read_b128 a[212:215], v111 offset:24576
    v_mfma_f32_16x16x32_bf16 v[32:35], a[28:31], a[240:243], v[32:35]
    s_waitcnt lgkmcnt(8)
    ds_read_b128 a[216:219], v111 offset:40960
    v_mfma_f32_16x16x32_bf16 v[44:47], a[28:31], a[244:247], v[44:47]
    s_waitcnt lgkmcnt(8)
    ds_read_b128 a[220:223], v111 offset:57344
    v_mfma_f32_16x16x32_bf16 v[56:59], a[28:31], a[248:251], v[56:59]
    s_waitcnt lgkmcnt(8)
    ds_read_b128 a[224:227], v110 offset:10240
    v_mfma_f32_16x16x32_bf16 v[68:71], a[28:31], a[252:255], v[68:71]
    s_waitcnt lgkmcnt(8)
    ds_read_b128 a[228:231], v110 offset:26624
    v_mfma_f32_16x16x32_bf16 v[32:35], a[32:35], a[192:195], v[32:35]
    s_waitcnt lgkmcnt(8)
    ds_read_b128 a[232:235], v110 offset:43008
    v_mfma_f32_16x16x32_bf16 v[44:47], a[32:35], a[196:199], v[44:47]
    s_waitcnt lgkmcnt(8)
    ds_read_b128 a[236:239], v110 offset:59392
    v_mfma_f32_16x16x32_bf16 v[56:59], a[32:35], a[200:203], v[56:59]
    s_waitcnt lgkmcnt(8)
    ds_read_b128 a[240:243], v111 offset:10240
    v_mfma_f32_16x16x32_bf16 v[68:71], a[32:35], a[204:207], v[68:71]
    s_waitcnt lgkmcnt(8)
    ds_read_b128 a[244:247], v111 offset:26624
    v_mfma_f32_16x16x32_bf16 v[32:35], a[36:39], a[208:211], v[32:35]
    s_waitcnt lgkmcnt(8)
    ds_read_b128 a[248:251], v111 offset:43008
    v_mfma_f32_16x16x32_bf16 v[44:47], a[36:39], a[212:215], v[44:47]
    s_waitcnt lgkmcnt(8)
    ds_read_b128 a[252:255], v111 offset:59392
    v_mfma_f32_16x16x32_bf16 v[56:59], a[36:39], a[216:219], v[56:59]
    s_waitcnt lgkmcnt(8)
    ds_read_b128 a[192:195], v110 offset:12288
    v_mfma_f32_16x16x32_bf16 v[68:71], a[36:39], a[220:223], v[68:71]
    s_waitcnt lgkmcnt(8)
    ds_read_b128 a[196:199], v110 offset:28672
    v_mfma_f32_16x16x32_bf16 v[32:35], a[40:43], a[224:227], v[32:35]
    s_waitcnt lgkmcnt(8)
    ds_read_b128 a[200:203], v110 offset:45056
    v_mfma_f32_16x16x32_bf16 v[44:47], a[40:43], a[228:231], v[44:47]
    s_waitcnt lgkmcnt(8)
    ds_read_b128 a[204:207], v110 offset:61440
    v_mfma_f32_16x16x32_bf16 v[56:59], a[40:43], a[232:235], v[56:59]
    s_waitcnt lgkmcnt(8)
    ds_read_b128 a[208:211], v111 offset:12288
    v_mfma_f32_16x16x32_bf16 v[68:71], a[40:43], a[236:239], v[68:71]
    s_waitcnt lgkmcnt(8)
    ds_read_b128 a[212:215], v111 offset:28672
    v_mfma_f32_16x16x32_bf16 v[32:35], a[44:47], a[240:243], v[32:35]
    s_waitcnt lgkmcnt(8)
    ds_read_b128 a[216:219], v111 offset:45056
    v_mfma_f32_16x16x32_bf16 v[44:47], a[44:47], a[244:247], v[44:47]
    s_waitcnt lgkmcnt(8)
    ds_read_b128 a[220:223], v111 offset:61440
    v_mfma_f32_16x16x32_bf16 v[56:59], a[44:47], a[248:251], v[56:59]
    s_waitcnt lgkmcnt(8)
    ds_read_b128 a[224:227], v110 offset:14336
    v_mfma_f32_16x16x32_bf16 v[68:71], a[44:47], a[252:255], v[68:71]
    s_waitcnt lgkmcnt(8)
    ds_read_b128 a[228:231], v110 offset:30720
    v_mfma_f32_16x16x32_bf16 v[32:35], a[48:51], a[192:195], v[32:35]
    s_waitcnt lgkmcnt(8)
    ds_read_b128 a[232:235], v110 offset:47104
    v_mfma_f32_16x16x32_bf16 v[44:47], a[48:51], a[196:199], v[44:47]
    s_waitcnt lgkmcnt(8)
    ds_read_b128 a[236:239], v110 offset:63488
    v_mfma_f32_16x16x32_bf16 v[56:59], a[48:51], a[200:203], v[56:59]
    s_waitcnt lgkmcnt(8)
    ds_read_b128 a[240:243], v111 offset:14336
    v_mfma_f32_16x16x32_bf16 v[68:71], a[48:51], a[204:207], v[68:71]
    s_waitcnt lgkmcnt(8)
    ds_read_b128 a[244:247], v111 offset:30720
    v_mfma_f32_16x16x32_bf16 v[32:35], a[52:55], a[208:211], v[32:35]
    s_waitcnt lgkmcnt(8)
    ds_read_b128 a[248:251], v111 offset:47104
    v_mfma_f32_16x16x32_bf16 v[44:47], a[52:55], a[212:215], v[44:47]
    s_waitcnt lgkmcnt(8)
    ds_read_b128 a[252:255], v111 offset:63488
    v_mfma_f32_16x16x32_bf16 v[56:59], a[52:55], a[216:219], v[56:59]
    s_waitcnt lgkmcnt(8)
    v_mfma_f32_16x16x32_bf16 v[68:71], a[52:55], a[220:223], v[68:71]
    s_waitcnt lgkmcnt(7)
    s_waitcnt vmcnt(0)
    s_mov_b32 s58, 0x40000
L_rdy1:
    v_cmp_gt_u32 vcc, 32, v145
    s_sub_u32 s58, s58, 1
    s_cbranch_vccz L_rdy1_x
    s_cbranch_scc1 L_rdy1_x
    global_load_dword v145, v144, s[96:97] sc1
    s_waitcnt vmcnt(0)
    s_branch L_rdy1
L_rdy1_x:
    s_barrier
    s_cmp_lg_u32 s8, 0
    s_cbranch_scc1 L_arr2
    s_atomic_add s36, s[76:77], 0
    s_atomic_add s36, s[76:77], 128
    s_atomic_add s36, s[76:77], 256
    s_atomic_add s36, s[76:77], 384
L_arr2:
    v_mfma_f32_16x16x32_bf16 v[32:35], a[56:59], a[224:227], v[32:35]
    s_waitcnt lgkmcnt(6)
    v_mfma_f32_16x16x32_bf16 v[44:47], a[56:59], a[228:231], v[44:47]
    s_waitcnt lgkmcnt(5)
    v_mfma_f32_16x16x32_bf16 v[56:59], a[56:59], a[232:235], v[56:59]
    s_waitcnt lgkmcnt(4)
    v_mfma_f32_16x16x32_bf16 v[68:71], a[56:59], a[236:239], v[68:71]
    s_waitcnt lgkmcnt(3)
    v_mfma_f32_16x16x32_bf16 v[32:35], a[60:63], a[240:243], v[32:35]
    s_waitcnt lgkmcnt(2)
    v_mfma_f32_16x16x32_bf16 v[44:47], a[60:63], a[244:247], v[44:47]
    s_waitcnt lgkmcnt(1)
    v_mfma_f32_16x16x32_bf16 v[56:59], a[60:63], a[248:251], v[56:59]
    s_waitcnt lgkmcnt(0)
    v_mfma_f32_16x16x32_bf16 v[68:71], a[60:63], a[252:255], v[68:71]
    s_nop 1
    v_pk_mul_f32 v[32:33], v[32:33], v[36:37] op_sel_hi:[1,0]
    v_pk_mul_f32 v[34:35], v[34:35], v[36:37] op_sel_hi:[1,0]
    v_pk_fma_f32 v[32:33], v[80:81], v[36:37], v[32:33] op_sel:[0,1,0] op_sel_hi:[1,1,1]
    v_pk_fma_f32 v[34:35], v[82:83], v[36:37], v[34:35] op_sel:[0,1,0] op_sel_hi:[1,1,1]
    v_cvt_pk_bf16_f32 v16, v32, v33
    v_cvt_pk_bf16_f32 v17, v34, v35
    v_pk_mul_f32 v[44:45], v[44:45], v[48:49] op_sel_hi:[1,0]
    v_pk_mul_f32 v[46:47], v[46:47], v[48:49] op_sel_hi:[1,0]
    v_pk_fma_f32 v[44:45], v[80:81], v[48:49], v[44:45] op_sel:[0,1,0] op_sel_hi:[1,1,1]
    v_pk_fma_f32 v[46:47], v[82:83], v[48:49], v[46:47] op_sel:[0,1,0] op_sel_hi:[1,1,1]
    v_cvt_pk_bf16_f32 v18, v44, v45
    v_cvt_pk_bf16_f32 v19, v46, v47
    s_nop 0
    v_permlane32_swap_b32 v16, v18
    v_permlane32_swap_b32 v17, v19
    buffer_store_dwordx4 v[16:19], v10, s[4:7], s28 offen offset:0 sc1
    v_pk_mul_f32 v[56:57], v[56:57], v[60:61] op_sel_hi:[1,0]
    v_pk_mul_f32 v[58:59], v[58:59], v[60:61] op_sel_hi:[1,0]
    v_pk_fma_f32 v[56:57], v[80:81], v[60:61], v[56:57] op_sel:[0,1,0] op_sel_hi:[1,1,1]
    v_pk_fma_f32 v[58:59], v[82:83], v[60:61], v[58:59] op_sel:[0,1,0] op_sel_hi:[1,1,1]
    v_cvt_pk_bf16_f32 v20, v56, v57
    v_cvt_pk_bf16_f32 v21, v58, v59
    v_pk_mul_f32 v[68:69], v[68:69], v[72:73] op_sel_hi:[1,0]
    v_pk_mul_f32 v[70:71], v[70:71], v[72:73] op_sel_hi:[1,0]
    v_pk_fma_f32 v[68:69], v[80:81], v[72:73], v[68:69] op_sel:[0,1,0] op_sel_hi:[1,1,1]
    v_pk_fma_f32 v[70:71], v[82:83], v[72:73], v[70:71] op_sel:[0,1,0] op_sel_hi:[1,1,1]
    v_cvt_pk_bf16_f32 v22, v68, v69
    v_cvt_pk_bf16_f32 v23, v70, v71
    s_nop 0
    v_permlane32_swap_b32 v20, v22
    v_permlane32_swap_b32 v21, v23
    buffer_store_dwordx4 v[20:23], v10, s[4:7], s28 offen offset:1024 sc1
    s_lshl_b32 s20, s52, 8
    s_add_u32 s20, s20, 5210112
    v_lshlrev_b32 v148, 5, v2
    v_lshlrev_b32 v149, 2, v3
    s_cmp_eq_u32 s9, 16
    s_cselect_b32 s78, s20, 0x10000000
    v_mov_b32 v152, v80
    v_mov_b32 v153, v81
    v_mov_b32 v154, v82
    v_mov_b32 v155, v83
    v_mov_b32 v156, v84
    v_mov_b32 v157, v85
    v_mov_b32 v158, v86
    v_mov_b32 v159, v87
    v_mov_b32 v160, v88
    s_lshr_b32 s21, s9, 2
    s_lshl_b32 s22, s10, 1
    s_lshr_b32 s20, s21, 2
    s_add_u32 s22, s22, s20
    s_add_u32 s22, s22, 8
    s_lshl_b32 s22, s22, 5
    s_and_b32 s20, s21, 3
    s_add_u32 s22, s22, s20
    s_lshl_b32 s22, s22, 7
    s_add_u32 s76, s4, s22
    s_addc_u32 s77, s5, 0
    s_and_b32 s20, s2, 7
    s_lshr_b32 s21, s2, 3
    s_lshl_b32 s20, s20, 2
    s_lshr_b32 s22, s21, 3
    s_add_u32 s9, s20, s22
    s_and_b32 s10, s21, 7
    s_and_b32 s20, s8, 1
    s_lshl_b32 s53, s10, 1
    s_add_u32 s53, s53, s20
    s_lshl_b32 s52, s10, 2
    s_add_u32 s52, s52, s8
    s_lshl_b32 s20, s9, 12
    s_add_u32 s14, s4, s20
    s_addc_u32 s15, s5, 0
    s_lshl_b32 s20, s10, 12
    s_add_u32 s38, s4, s20
    s_addc_u32 s39, s5, 0
    s_lshr_b32 s20, s9, 2
    s_lshl_b32 s20, s20, 5
    s_and_b32 s21, s10, 3
    s_add_u32 s20, s20, s21
    s_lshl_b32 s20, s20, 7
    s_add_u32 s60, s4, s20
    s_addc_u32 s61, s5, 0
    s_lshr_b32 s21, s9, 2
    s_lshl_b32 s22, s10, 1
    s_lshr_b32 s20, s21, 2
    s_add_u32 s22, s22, s20
    s_add_u32 s22, s22, 8
    s_lshl_b32 s22, s22, 5
    s_and_b32 s20, s21, 3
    s_add_u32 s22, s22, s20
    s_lshl_b32 s22, s22, 7
    s_add_u32 s66, s4, s22
    s_addc_u32 s67, s5, 0
    s_lshl_b32 s20, s9, 16
    s_add_u32 s20, s20, s13
    s_lshl_b32 s21, s10, 13
    s_lshl_b32 s22, s8, 11
    s_add_u32 s21, s21, s22
    s_add_u32 s21, s21, s20
    s_add_u32 s21, s21, 4194304
    s_and_b32 s22, s8, 1
    s_lshl_b32 s22, s22, 12
    s_lshl_b32 s24, s54, 16
    s_add_u32 s24, s24, s22
    s_mul_i32 s23, s54, 2097152
    s_add_u32 s23, s23, s22
    s_add_u32 s23, s23, s20
    s_add_u32 s23, s23, 6291456
    v_mov_b32 v8, 0xdddddddd
    v_and_b32 v9, 7, v0
    v_lshlrev_b32 v9, 12, v9
    v_mov_b32 v44, 0x3f803f80
    v_mov_b32 v45, 0x3f803f80
    v_mov_b32 v46, 0x3f803f80
    v_mov_b32 v47, 0x3f803f80
    s_lshl_b32 s25, s8, 10
    s_add_u32 s25, s25, 131072
    v_add_u32 v43, s25, v1
    v_and_b32 v40, 15, v0
    v_lshrrev_b32 v41, 5, v0
    v_lshlrev_b32 v41, 8, v41
    v_lshl_add_u32 v40, v40, 4, v41
    v_add_u32 v40, 65536, v40
    v_and_b32 v41, 4, v0
    v_lshlrev_b32 v41, 4, v41
    v_add_u32 v41, 131072, v41
    v_and_b32 v42, 11, v0
    v_cmp_eq_u32 vcc, 0, v42
    v_mov_b32 v42, 0x30000
    s_nop 0
    v_cndmask_b32 v41, v42, v41, vcc
    v_and_b32 v42, 16, v0
    v_cmp_eq_u32 vcc, 0, v42
    v_mov_b32 v42, 4096
    s_nop 0
    v_cndmask_b32 v3, v41, v40, vcc
    v_cndmask_b32 v2, 0, v42, vcc
    v_mov_b32 v64, 0
    v_mov_b32 v65, 0
    v_mov_b32 v66, 0
    v_mov_b32 v67, 0
    v_mov_b32 v68, 0
    v_mov_b32 v69, 0
    v_mov_b32 v70, 0
    v_mov_b32 v71, 0
    v_mov_b32 v72, 0
    v_mov_b32 v73, 0
    v_mov_b32 v74, 0
    v_mov_b32 v75, 0
    v_mov_b32 v76, 0
    v_mov_b32 v77, 0
    v_mov_b32 v78, 0
    v_mov_b32 v79, 0
    v_mov_b32 v80, 0
    v_mov_b32 v81, 0
    v_mov_b32 v82, 0
    v_mov_b32 v83, 0
    v_mov_b32 v84, 0
    v_mov_b32 v85, 0
    v_mov_b32 v86, 0
    v_mov_b32 v87, 0
    v_mov_b32 v88, 0
    v_mov_b32 v89, 0
    v_mov_b32 v90, 0
    v_mov_b32 v91, 0
    v_mov_b32 v92, 0
    v_mov_b32 v93, 0
    v_mov_b32 v94, 0
    v_mov_b32 v95, 0
    s_lshl_b32 s25, s10, 18
    s_lshl_b32 s22, s8, 16
    s_add_u32 s25, s25, s22
    s_lshl_b32 s22, s9, 10
    s_add_u32 s25, s25, s22
    s_add_u32 s25, s25, s13
    s_add_u32 s25, s25, 10485760
    s_waitcnt vmcnt(0) lgkmcnt(0)
    s_barrier
    s_cmp_lg_u32 s8, 0
    s_cbranch_scc1 L_arr3
    s_atomic_add s36, s[76:77], 0
L_arr3:
    v_add_u32 v146, s86, v109
    s_bfe_u32 s22, s3, 524288
    v_xor_b32 v147, s22, v109
    v_xor_b32 v150, s22, v146
    ds_read_b64_tr_b16 v[164:165], v147
    ds_read_b64_tr_b16 v[166:167], v150
    s_mov_b32 s20, s87
    v_add_u32 v109, s20, v109
    v_add_u32 v146, s20, v146
    s_bfe_u32 s22, s3, 524296
    v_xor_b32 v147, s22, v109
    v_xor_b32 v150, s22, v146
    ds_read_b64_tr_b16 v[168:169], v147
    ds_read_b64_tr_b16 v[170:171], v150
    s_sub_u32 s20, s88, s87
    v_add_u32 v109, s20, v109
    v_add_u32 v146, s20, v146
    s_bfe_u32 s22, s3, 524288
    v_xor_b32 v147, s22, v109
    v_xor_b32 v150, s22, v146
    ds_read_b64_tr_b16 v[172:173], v147
    ds_read_b64_tr_b16 v[174:175], v150
    s_mov_b32 s20, s87
    v_add_u32 v109, s20, v109
    v_add_u32 v146, s20, v146
    s_bfe_u32 s22, s3, 524296
    v_xor_b32 v147, s22, v109
    v_xor_b32 v150, s22, v146
    ds_read_b64_tr_b16 v[176:177], v147
    ds_read_b64_tr_b16 v[178:179], v150
    ds_read_b64_tr_b16 v[180:181], v128 offset:0
    ds_read_b64_tr_b16 v[182:183], v128 offset:512
    ds_read_b64_tr_b16 v[184:185], v128 offset:32
    ds_read_b64_tr_b16 v[186:187], v128 offset:544
    ds_read_b64_tr_b16 v[188:189], v128 offset:64
    ds_read_b64_tr_b16 v[190:191], v128 offset:576
    ds_read_b64_tr_b16 v[192:193], v128 offset:96
    ds_read_b64_tr_b16 v[194:195], v128 offset:608
    s_waitcnt lgkmcnt(0)
    s_lshr_b32 s65, s9, 2
    s_lshl_b32 s22, s65, 1
    s_lshr_b32 s20, s10, 2
    s_add_u32 s22, s22, s20
    s_add_u32 s22, s22, 8
    s_lshl_b32 s22, s22, 5
    s_and_b32 s20, s10, 3
    s_add_u32 s22, s22, s20
    s_lshl_b32 s22, s22, 7
    s_add_u32 s86, s4, s22
    s_addc_u32 s87, s5, 0
L_att:
    s_cmp_lg_u32 s8, 1
    s_cbranch_scc1 L_pw4
    s_mov_b32 s58, 0x40000
L_poll5:
    s_mov_b32 s101, 0
    s_atomic_add s101, s[60:61], 0 glc
    s_mov_b32 s65, 0
    s_atomic_add s65, s[86:87], 0 glc
    s_sub_u32 s58, s58, 1
    s_waitcnt lgkmcnt(0)
    s_cbranch_scc1 L_poll5_x
    s_lshl_b32 s65, s65, 3
    s_min_u32 s101, s101, s65
    s_cmp_lt_u32 s101, 32
    s_sleep 1
    s_cbranch_scc1 L_poll5
L_poll5_x:
L_pw4:
    s_barrier
    buffer_load_dwordx4 v[16:19], v1, s[4:7], s21 offen offset:0 sc1
    buffer_load_dwordx4 v[20:23], v1, s[4:7], s21 offen offset:1024 sc1
    s_and_b32 s28, s8, 1
    s_lshl_b32 s28, s28, 11
    s_sub_u32 s29, s23, s28
    s_sub_u32 s30, s24, s28
    s_mov_b32 m0, s30
    s_nop 0
    buffer_load_dwordx4 v1, s[4:7], s29 offen offset:0 sc1 lds
    buffer_load_dwordx4 v1, s[4:7], s29 offen offset:1024 sc1 lds
    s_add_u32 m0, s30, 4096
    s_add_u32 s29, s29, 4096
    buffer_load_dwordx4 v1, s[4:7], s29 offen offset:0 sc1 lds
    buffer_load_dwordx4 v1, s[4:7], s29 offen offset:1024 sc1 lds
    s_add_u32 m0, s24, 8192
    s_add_u32 s23, s23, 8192
    buffer_load_dwordx4 v1, s[4:7], s23 offen offset:0 sc1 lds
    buffer_load_dwordx4 v1, s[4:7], s23 offen offset:1024 sc1 lds
    buffer_load_dwordx4 v1, s[4:7], s23 offen offset:2048 sc1 lds
    buffer_load_dwordx4 v1, s[4:7], s23 offen offset:3072 sc1 lds
    ds_write_b128 v43, v[44:47]
    s_mov_b32 s37, 3072
    s_and_b32 s35, s2, 7
    s_lshl_b32 s35, s35, 12
    s_add_u32 s35, s35, s37
    s_or_b32 s20, s8, s11
    s_cmp_lg_u32 s20, 0
    s_cselect_b32 s35, 0x10000000, s35
    v_mov_b32 v254, 1
    s_mov_b32 s26, 0x2b800000
    s_mov_b32 s27, 0x53800000
    s_waitcnt vmcnt(6)
    s_waitcnt lgkmcnt(0)
    s_barrier
    ds_read_b128 v[24:27], v1 offset:0
    ds_read_b128 v[28:31], v3 offset:0
    ds_read_b128 v[4:7], v3 offset:512
    s_waitcnt lgkmcnt(2)
    v_mfma_f32_32x32x16_bf16 v[32:47], v[24:27], v[16:19], 0
    s_nop 11
    v_exp_f32 v32, v32
    v_exp_f32 v33, v33
    ds_read_b128 v[96:99], v1 offset:1024
    v_exp_f32 v34, v34
    v_exp_f32 v35, v35
    v_exp_f32 v36, v36
    v_exp_f32 v37, v37
    v_mfma_f32_32x32x16_bf16 v[48:63], v[24:27], v[20:23], 0
    s_waitcnt lgkmcnt(2)
    ds_read_b128 v[10:13], v3 offset:1024
    v_exp_f32 v38, v38
    v_exp_f32 v39, v39
    v_exp_f32 v40, v40
    v_exp_f32 v41, v41
    v_smfmac_f32_32x32x32_bf16 v[64:79], v[28:31], v[32:39], v8
    s_waitcnt lgkmcnt(2)
    ds_read_b128 v[100:103], v3 offset:1536
    v_exp_f32 v42, v42
    v_exp_f32 v43, v43
    v_exp_f32 v44, v44
    v_exp_f32 v45, v45
    v_exp_f32 v46, v46
    v_exp_f32 v47, v47
    v_exp_f32 v48, v48
    v_exp_f32 v49, v49
    v_smfmac_f32_32x32x32_bf16 v[64:79], v[4:7], v[40:47], v8
    s_waitcnt lgkmcnt(2)
    buffer_store_dwordx4 v[164:167], v1, s[4:7], s82 offen sc1
    v_exp_f32 v50, v50
    v_exp_f32 v51, v51
    v_exp_f32 v52, v52
    v_exp_f32 v53, v53
    v_mfma_f32_32x32x16_bf16 v[32:47], v[96:99], v[16:19], 0
    buffer_store_dwordx4 v[168:171], v1, s[4:7], s83 offen sc1
    v_exp_f32 v54, v54
    v_exp_f32 v55, v55
    v_exp_f32 v56, v56
    v_exp_f32 v57, v57
    v_smfmac_f32_32x32x32_bf16 v[80:95], v[28:31], v[48:55], v8
    s_waitcnt lgkmcnt(0)
    buffer_store_dwordx4 v[172:175], v1, s[4:7], s84 offen sc1
    v_exp_f32 v58, v58
    v_exp_f32 v59, v59
    v_exp_f32 v60, v60
    v_exp_f32 v61, v61
    v_exp_f32 v62, v62
    v_exp_f32 v63, v63
    v_exp_f32 v32, v32
    v_exp_f32 v33, v33
    v_smfmac_f32_32x32x32_bf16 v[80:95], v[4:7], v[56:63], v8
    ds_read_b128 v[24:27], v1 offset:2048
    v_exp_f32 v34, v34
    v_exp_f32 v35, v35
    v_exp_f32 v36, v36
    v_exp_f32 v37, v37
    v_mfma_f32_32x32x16_bf16 v[48:63], v[96:99], v[20:23], 0
    ds_read_b128 v[28:31], v3 offset:2048
    v_exp_f32 v38, v38
    v_exp_f32 v39, v39
    v_exp_f32 v40, v40
    v_exp_f32 v41, v41
    v_smfmac_f32_32x32x32_bf16 v[64:79], v[10:13], v[32:39], v8
    ds_read_b128 v[4:7], v3 offset:2560
    v_exp_f32 v42, v42
    v_exp_f32 v43, v43
    v_exp_f32 v44, v44
    v_exp_f32 v45, v45
    v_exp_f32 v46, v46
    v_exp_f32 v47, v47
    v_exp_f32 v48, v48
    v_exp_f32 v49, v49
    v_smfmac_f32_32x32x32_bf16 v[64:79], v[100:103], v[40:47], v8
    s_waitcnt lgkmcnt(2)
    buffer_store_dwordx4 v[176:179], v1, s[4:7], s85 offen sc1
    v_exp_f32 v50, v50
    v_exp_f32 v51, v51
    v_exp_f32 v52, v52
    v_exp_f32 v53, v53
    v_mfma_f32_32x32x16_bf16 v[32:47], v[24:27], v[16:19], 0
    buffer_store_dwordx4 v[180:183], v1, s[4:7], s91 offen sc1
    v_exp_f32 v54, v54
    v_exp_f32 v55, v55
    v_exp_f32 v56, v56
    v_exp_f32 v57, v57
    v_smfmac_f32_32x32x32_bf16 v[80:95], v[10:13], v[48:55], v8
    s_waitcnt lgkmcnt(0)
    s_add_u32 s91, s91, 49152
    buffer_store_dwordx4 v[184:187], v1, s[4:7], s91 offen sc1
    v_exp_f32 v58, v58
    v_exp_f32 v59, v59
    v_exp_f32 v60, v60
    v_exp_f32 v61, v61
    v_exp_f32 v62, v62
    v_exp_f32 v63, v63
    v_exp_f32 v32, v32
    v_exp_f32 v33, v33
    v_smfmac_f32_32x32x32_bf16 v[80:95], v[100:103], v[56:63], v8
    ds_read_b128 v[96:99], v1 offset:3072
    v_exp_f32 v34, v34
    v_exp_f32 v35, v35
    v_exp_f32 v36, v36
    v_exp_f32 v37, v37
    v_mfma_f32_32x32x16_bf16 v[48:63], v[24:27], v[20:23], 0
    ds_read_b128 v[10:13], v3 offset:3072
    v_exp_f32 v38, v38
    v_exp_f32 v39, v39
    v_exp_f32 v40, v40
    v_exp_f32 v41, v41
    v_smfmac_f32_32x32x32_bf16 v[64:79], v[28:31], v[32:39], v8
    ds_read_b128 v[100:103], v3 offset:3584
    v_exp_f32 v42, v42
    v_exp_f32 v43, v43
    v_exp_f32 v44, v44
    v_exp_f32 v45, v45
    v_exp_f32 v46, v46
    v_exp_f32 v47, v47
    v_exp_f32 v48, v48
    v_exp_f32 v49, v49
    v_smfmac_f32_32x32x32_bf16 v[64:79], v[4:7], v[40:47], v8
    s_waitcnt lgkmcnt(2)
    s_add_u32 s91, s91, 49152
    buffer_store_dwordx4 v[188:191], v1, s[4:7], s91 offen sc1
    v_exp_f32 v50, v50
    v_exp_f32 v51, v51
    v_exp_f32 v52, v52
    v_exp_f32 v53, v53
    v_mfma_f32_32x32x16_bf16 v[32:47], v[96:99], v[16:19], 0
    s_add_u32 s91, s91, 49152
    buffer_store_dwordx4 v[192:195], v1, s[4:7], s91 offen sc1
    v_exp_f32 v54, v54
    v_exp_f32 v55, v55
    v_exp_f32 v56, v56
    v_exp_f32 v57, v57
    v_smfmac_f32_32x32x32_bf16 v[80:95], v[28:31], v[48:55], v8
    s_waitcnt lgkmcnt(0)
    buffer_store_dwordx4 v[152:155], v148, s[4:7], s78 offen offset:0 sc1
    v_exp_f32 v58, v58
    v_exp_f32 v59, v59
    v_exp_f32 v60, v60
    v_exp_f32 v61, v61
    v_exp_f32 v62, v62
    v_exp_f32 v63, v63
    v_exp_f32 v32, v32
    v_exp_f32 v33, v33
    v_smfmac_f32_32x32x32_bf16 v[80:95], v[4:7], v[56:63], v8
    s_waitcnt vmcnt(13)
    s_barrier
    ds_read_b128 v[24:27], v1 offset:4096
    v_exp_f32 v34, v34
    v_exp_f32 v35, v35
    v_exp_f32 v36, v36
    v_exp_f32 v37, v37
    v_mfma_f32_32x32x16_bf16 v[48:63], v[96:99], v[20:23], 0
    v_add_u32 v3, v2, v3
    ds_read_b128 v[28:31], v3 offset:0
    v_exp_f32 v38, v38
    v_exp_f32 v39, v39
    v_exp_f32 v40, v40
    v_exp_f32 v41, v41
    v_smfmac_f32_32x32x32_bf16 v[64:79], v[10:13], v[32:39], v8
    ds_read_b128 v[4:7], v3 offset:512
    v_exp_f32 v42, v42
    v_exp_f32 v43, v43
    v_exp_f32 v44, v44
    v_exp_f32 v45, v45
    v_exp_f32 v46, v46
    v_exp_f32 v47, v47
    v_exp_f32 v48, v48
    v_exp_f32 v49, v49
    v_smfmac_f32_32x32x32_bf16 v[64:79], v[100:103], v[40:47], v8
    s_waitcnt lgkmcnt(2)
    buffer_store_dwordx4 v[156:159], v148, s[4:7], s78 offen offset:16 sc1
    v_exp_f32 v50, v50
    v_exp_f32 v51, v51
    v_exp_f32 v52, v52
    v_exp_f32 v53, v53
    v_mfma_f32_32x32x16_bf16 v[32:47], v[24:27], v[16:19], 0
    buffer_store_dword v160, v149, s[4:7], s78 offen offset:128 sc1
    v_exp_f32 v54, v54
    v_exp_f32 v55, v55
    v_exp_f32 v56, v56
    v_exp_f32 v57, v57
    v_smfmac_f32_32x32x32_bf16 v[80:95], v[10:13], v[48:55], v8
    s_waitcnt lgkmcnt(0)
    s_add_u32 m0, s24, 16384
    s_add_u32 s23, s23, 8192
    buffer_load_dwordx4 v1, s[4:7], s23 offen offset:0 sc1 lds
    v_exp_f32 v58, v58
    v_exp_f32 v59, v59
    v_exp_f32 v60, v60
    v_exp_f32 v61, v61
    v_exp_f32 v62, v62
    v_exp_f32 v63, v63
    v_exp_f32 v32, v32
    v_exp_f32 v33, v33
    v_smfmac_f32_32x32x32_bf16 v[80:95], v[100:103], v[56:63], v8
    ds_read_b128 v[96:99], v1 offset:5120
    v_exp_f32 v34, v34
    v_exp_f32 v35, v35
    v_exp_f32 v36, v36
    v_exp_f32 v37, v37
    v_mfma_f32_32x32x16_bf16 v[48:63], v[24:27], v[20:23], 0
    ds_read_b128 v[10:13], v3 offset:1024
    v_exp_f32 v38, v38
    v_exp_f32 v39, v39
    v_exp_f32 v40, v40
    v_exp_f32 v41, v41
    v_smfmac_f32_32x32x32_bf16 v[64:79], v[28:31], v[32:39], v8
    ds_read_b128 v[100:103], v3 offset:1536
    v_exp_f32 v42, v42
    v_exp_f32 v43, v43
    v_exp_f32 v44, v44
    v_exp_f32 v45, v45
    v_exp_f32 v46, v46
    v_exp_f32 v47, v47
    v_exp_f32 v48, v48
    v_exp_f32 v49, v49
    v_smfmac_f32_32x32x32_bf16 v[64:79], v[4:7], v[40:47], v8
    s_waitcnt lgkmcnt(2)
    buffer_load_dwordx4 v1, s[4:7], s23 offen offset:1024 sc1 lds
    v_exp_f32 v50, v50
    v_exp_f32 v51, v51
    v_exp_f32 v52, v52
    v_exp_f32 v53, v53
    v_mfma_f32_32x32x16_bf16 v[32:47], v[96:99], v[16:19], 0
    buffer_load_dwordx4 v1, s[4:7], s23 offen offset:2048 sc1 lds
    v_exp_f32 v54, v54
    v_exp_f32 v55, v55
    v_exp_f32 v56, v56
    v_exp_f32 v57, v57
    v_smfmac_f32_32x32x32_bf16 v[80:95], v[28:31], v[48:55], v8
    s_waitcnt lgkmcnt(0)
    buffer_load_dwordx4 v1, s[4:7], s23 offen offset:3072 sc1 lds
    v_exp_f32 v58, v58
    v_exp_f32 v59, v59
    v_exp_f32 v60, v60
    v_exp_f32 v61, v61
    v_exp_f32 v62, v62
    v_exp_f32 v63, v63
    v_exp_f32 v32, v32
    v_exp_f32 v33, v33
    v_smfmac_f32_32x32x32_bf16 v[80:95], v[4:7], v[56:63], v8
    ds_read_b128 v[24:27], v1 offset:6144
    v_exp_f32 v34, v34
    v_exp_f32 v35, v35
    v_exp_f32 v36, v36
    v_exp_f32 v37, v37
    v_mfma_f32_32x32x16_bf16 v[48:63], v[96:99], v[20:23], 0
    ds_read_b128 v[28:31], v3 offset:2048
    v_exp_f32 v38, v38
    v_exp_f32 v39, v39
    v_exp_f32 v40, v40
    v_exp_f32 v41, v41
    v_smfmac_f32_32x32x32_bf16 v[64:79], v[10:13], v[32:39], v8
    ds_read_b128 v[4:7], v3 offset:2560
    v_exp_f32 v42, v42
    v_exp_f32 v43, v43
    v_exp_f32 v44, v44
    v_exp_f32 v45, v45
    v_exp_f32 v46, v46
    v_exp_f32 v47, v47
    v_exp_f32 v48, v48
    v_exp_f32 v49, v49
    v_smfmac_f32_32x32x32_bf16 v[64:79], v[100:103], v[40:47], v8
    s_waitcnt lgkmcnt(2)
    s_add_u32 m0, s24, 24576
    s_add_u32 s23, s23, 8192
    buffer_load_dwordx4 v1, s[4:7], s23 offen offset:0 sc1 lds
    v_exp_f32 v50, v50
    v_exp_f32 v51, v51
    v_exp_f32 v52, v52
    v_exp_f32 v53, v53
    v_mfma_f32_32x32x16_bf16 v[32:47], v[24:27], v[16:19], 0
    buffer_load_dwordx4 v1, s[4:7], s23 offen offset:1024 sc1 lds
    v_exp_f32 v54, v54
    v_exp_f32 v55, v55
    v_exp_f32 v56, v56
    v_exp_f32 v57, v57
    v_smfmac_f32_32x32x32_bf16 v[80:95], v[10:13], v[48:55], v8
    s_waitcnt lgkmcnt(0)
    buffer_load_dwordx4 v1, s[4:7], s23 offen offset:2048 sc1 lds
    v_exp_f32 v58, v58
    v_exp_f32 v59, v59
    v_exp_f32 v60, v60
    v_exp_f32 v61, v61
    v_exp_f32 v62, v62
    v_exp_f32 v63, v63
    v_exp_f32 v32, v32
    v_exp_f32 v33, v33
    v_smfmac_f32_32x32x32_bf16 v[80:95], v[100:103], v[56:63], v8
    ds_read_b128 v[96:99], v1 offset:7168
    v_exp_f32 v34, v34
    v_exp_f32 v35, v35
    v_exp_f32 v36, v36
    v_exp_f32 v37, v37
    v_mfma_f32_32x32x16_bf16 v[48:63], v[24:27], v[20:23], 0
    ds_read_b128 v[10:13], v3 offset:3072
    v_exp_f32 v38, v38
    v_exp_f32 v39, v39
    v_exp_f32 v40, v40
    v_exp_f32 v41, v41
    v_smfmac_f32_32x32x32_bf16 v[64:79], v[28:31], v[32:39], v8
    ds_read_b128 v[100:103], v3 offset:3584
    v_exp_f32 v42, v42
    v_exp_f32 v43, v43
    v_exp_f32 v44, v44
    v_exp_f32 v45, v45
    v_exp_f32 v46, v46
    v_exp_f32 v47, v47
    v_exp_f32 v48, v48
    v_exp_f32 v49, v49
    v_smfmac_f32_32x32x32_bf16 v[64:79], v[4:7], v[40:47], v8
    s_waitcnt lgkmcnt(2)
    buffer_load_dwordx4 v1, s[4:7], s23 offen offset:3072 sc1 lds
    v_exp_f32 v50, v50
    v_exp_f32 v51, v51
    v_exp_f32 v52, v52
    v_exp_f32 v53, v53
    v_mfma_f32_32x32x16_bf16 v[32:47], v[96:99], v[16:19], 0
    s_add_u32 m0, s24, 32768
    s_add_u32 s23, s23, 8192
    buffer_load_dwordx4 v1, s[4:7], s23 offen offset:0 sc1 lds
    v_exp_f32 v54, v54
    v_exp_f32 v55, v55
    v_exp_f32 v56, v56
    v_exp_f32 v57, v57
    v_smfmac_f32_32x32x32_bf16 v[80:95], v[28:31], v[48:55], v8
    s_waitcnt lgkmcnt(0)
    buffer_load_dwordx4 v1, s[4:7], s23 offen offset:1024 sc1 lds
    v_exp_f32 v58, v58
    v_exp_f32 v59, v59
    v_exp_f32 v60, v60
    v_exp_f32 v61, v61
    v_exp_f32 v62, v62
    v_exp_f32 v63, v63
    v_exp_f32 v32, v32
    v_exp_f32 v33, v33
    v_smfmac_f32_32x32x32_bf16 v[80:95], v[4:7], v[56:63], v8
    s_waitcnt vmcnt(21)
    s_barrier
    ds_read_b128 v[24:27], v1 offset:8192
    v_exp_f32 v34, v34
    v_exp_f32 v35, v35
    v_exp_f32 v36, v36
    v_exp_f32 v37, v37
    v_mfma_f32_32x32x16_bf16 v[48:63], v[96:99], v[20:23], 0
    v_add_u32 v3, v2, v3
    ds_read_b128 v[28:31], v3 offset:0
    v_exp_f32 v38, v38
    v_exp_f32 v39, v39
    v_exp_f32 v40, v40
    v_exp_f32 v41, v41
    v_smfmac_f32_32x32x32_bf16 v[64:79], v[10:13], v[32:39], v8
    ds_read_b128 v[4:7], v3 offset:512
    v_exp_f32 v42, v42
    v_exp_f32 v43, v43
    v_exp_f32 v44, v44
    v_exp_f32 v45, v45
    v_exp_f32 v46, v46
    v_exp_f32 v47, v47
    v_exp_f32 v48, v48
    v_exp_f32 v49, v49
    v_smfmac_f32_32x32x32_bf16 v[64:79], v[100:103], v[40:47], v8
    s_waitcnt lgkmcnt(2)
    buffer_load_dwordx4 v1, s[4:7], s23 offen offset:2048 sc1 lds
    v_exp_f32 v50, v50
    v_exp_f32 v51, v51
    v_exp_f32 v52, v52
    v_exp_f32 v53, v53
    v_mfma_f32_32x32x16_bf16 v[32:47], v[24:27], v[16:19], 0
    buffer_load_dwordx4 v1, s[4:7], s23 offen offset:3072 sc1 lds
    v_exp_f32 v54, v54
    v_exp_f32 v55, v55
    v_exp_f32 v56, v56
    v_exp_f32 v57, v57
    v_smfmac_f32_32x32x32_bf16 v[80:95], v[10:13], v[48:55], v8
    s_waitcnt lgkmcnt(0)
    s_add_u32 m0, s24, 40960
    s_add_u32 s23, s23, 8192
    buffer_load_dwordx4 v1, s[4:7], s23 offen offset:0 sc1 lds
    v_exp_f32 v58, v58
    v_exp_f32 v59, v59
    v_exp_f32 v60, v60
    v_exp_f32 v61, v61
    v_exp_f32 v62, v62
    v_exp_f32 v63, v63
    v_exp_f32 v32, v32
    v_exp_f32 v33, v33
    v_smfmac_f32_32x32x32_bf16 v[80:95], v[100:103], v[56:63], v8
    s_waitcnt vmcnt(9)
    s_barrier
    s_mov_b64 exec, 1
    buffer_atomic_add v254, v1, s[4:7], s35 offen sc1
    s_mov_b64 exec, -1
    ds_read_b128 v[96:99], v1 offset:9216
    v_exp_f32 v34, v34
    v_exp_f32 v35, v35
    v_exp_f32 v36, v36
    v_exp_f32 v37, v37
    v_mfma_f32_32x32x16_bf16 v[48:63], v[24:27], v[20:23], 0
    ds_read_b128 v[10:13], v3 offset:1024
    v_exp_f32 v38, v38
    v_exp_f32 v39, v39
    v_exp_f32 v40, v40
    v_exp_f32 v41, v41
    v_smfmac_f32_32x32x32_bf16 v[64:79], v[28:31], v[32:39], v8
    ds_read_b128 v[100:103], v3 offset:1536
    v_exp_f32 v42, v42
    v_exp_f32 v43, v43
    v_exp_f32 v44, v44
    v_exp_f32 v45, v45
    v_exp_f32 v46, v46
    v_exp_f32 v47, v47
    v_exp_f32 v48, v48
    v_exp_f32 v49, v49
    v_smfmac_f32_32x32x32_bf16 v[64:79], v[4:7], v[40:47], v8
    s_waitcnt lgkmcnt(2)
    buffer_load_dwordx4 v1, s[4:7], s23 offen offset:1024 sc1 lds
    v_exp_f32 v50, v50
    v_exp_f32 v51, v51
    v_exp_f32 v52, v52
    v_exp_f32 v53, v53
    v_mfma_f32_32x32x16_bf16 v[32:47], v[96:99], v[16:19], 0
    buffer_load_dwordx4 v1, s[4:7], s23 offen offset:2048 sc1 lds
    v_exp_f32 v54, v54
    v_exp_f32 v55, v55
    v_exp_f32 v56, v56
    v_exp_f32 v57, v57
    v_smfmac_f32_32x32x32_bf16 v[80:95], v[28:31], v[48:55], v8
    s_waitcnt lgkmcnt(0)
    buffer_load_dwordx4 v1, s[4:7], s23 offen offset:3072 sc1 lds
    v_exp_f32 v58, v58
    v_exp_f32 v59, v59
    v_exp_f32 v60, v60
    v_exp_f32 v61, v61
    v_exp_f32 v62, v62
    v_exp_f32 v63, v63
    v_exp_f32 v32, v32
    v_exp_f32 v33, v33
    v_smfmac_f32_32x32x32_bf16 v[80:95], v[4:7], v[56:63], v8
    ds_read_b128 v[24:27], v1 offset:10240
    v_exp_f32 v34, v34
    v_exp_f32 v35, v35
    v_exp_f32 v36, v36
    v_exp_f32 v37, v37
    v_mfma_f32_32x32x16_bf16 v[48:63], v[96:99], v[20:23], 0
    ds_read_b128 v[28:31], v3 offset:2048
    v_exp_f32 v38, v38
    v_exp_f32 v39, v39
    v_exp_f32 v40, v40
    v_exp_f32 v41, v41
    v_smfmac_f32_32x32x32_bf16 v[64:79], v[10:13], v[32:39], v8
    ds_read_b128 v[4:7], v3 offset:2560
    v_exp_f32 v42, v42
    v_exp_f32 v43, v43
    v_exp_f32 v44, v44
    v_exp_f32 v45, v45
    v_exp_f32 v46, v46
    v_exp_f32 v47, v47
    v_exp_f32 v48, v48
    v_exp_f32 v49, v49
    v_smfmac_f32_32x32x32_bf16 v[64:79], v[100:103], v[40:47], v8
    s_waitcnt lgkmcnt(2)
    s_add_u32 m0, s24, 49152
    s_add_u32 s23, s23, 8192
    buffer_load_dwordx4 v1, s[4:7], s23 offen offset:0 sc1 lds
    v_exp_f32 v50, v50
    v_exp_f32 v51, v51
    v_exp_f32 v52, v52
    v_exp_f32 v53, v53
    v_mfma_f32_32x32x16_bf16 v[32:47], v[24:27], v[16:19], 0
    buffer_load_dwordx4 v1, s[4:7], s23 offen offset:1024 sc1 lds
    v_exp_f32 v54, v54
    v_exp_f32 v55, v55
    v_exp_f32 v56, v56
    v_exp_f32 v57, v57
    v_smfmac_f32_32x32x32_bf16 v[80:95], v[10:13], v[48:55], v8
    s_waitcnt lgkmcnt(0)
    buffer_load_dwordx4 v1, s[4:7], s23 offen offset:2048 sc1 lds
    v_exp_f32 v58, v58
    v_exp_f32 v59, v59
    v_exp_f32 v60, v60
    v_exp_f32 v61, v61
    v_exp_f32 v62, v62
    v_exp_f32 v63, v63
    v_exp_f32 v32, v32
    v_exp_f32 v33, v33
    v_smfmac_f32_32x32x32_bf16 v[80:95], v[100:103], v[56:63], v8
    ds_read_b128 v[96:99], v1 offset:11264
    v_exp_f32 v34, v34
    v_exp_f32 v35, v35
    v_exp_f32 v36, v36
    v_exp_f32 v37, v37
    v_mfma_f32_32x32x16_bf16 v[48:63], v[24:27], v[20:23], 0
    ds_read_b128 v[10:13], v3 offset:3072
    v_exp_f32 v38, v38
    v_exp_f32 v39, v39
    v_exp_f32 v40, v40
    v_exp_f32 v41, v41
    v_smfmac_f32_32x32x32_bf16 v[64:79], v[28:31], v[32:39], v8
    ds_read_b128 v[100:103], v3 offset:3584
    v_exp_f32 v42, v42
    v_exp_f32 v43, v43
    v_exp_f32 v44, v44
    v_exp_f32 v45, v45
    v_exp_f32 v46, v46
    v_exp_f32 v47, v47
    v_exp_f32 v48, v48
    v_exp_f32 v49, v49
    v_smfmac_f32_32x32x32_bf16 v[64:79], v[4:7], v[40:47], v8
    s_waitcnt lgkmcnt(2)
    buffer_load_dwordx4 v1, s[4:7], s23 offen offset:3072 sc1 lds
    v_exp_f32 v50, v50
    v_exp_f32 v51, v51
    v_exp_f32 v52, v52
    v_exp_f32 v53, v53
    v_mfma_f32_32x32x16_bf16 v[32:47], v[96:99], v[16:19], 0
    s_add_u32 m0, s24, 57344
    s_add_u32 s23, s23, 8192
    buffer_load_dwordx4 v1, s[4:7], s23 offen offset:0 sc1 lds
    v_exp_f32 v54, v54
    v_exp_f32 v55, v55
    v_exp_f32 v56, v56
    v_exp_f32 v57, v57
    v_smfmac_f32_32x32x32_bf16 v[80:95], v[28:31], v[48:55], v8
    s_waitcnt lgkmcnt(0)
    buffer_load_dwordx4 v1, s[4:7], s23 offen offset:1024 sc1 lds
    v_exp_f32 v58, v58
    v_exp_f32 v59, v59
    v_exp_f32 v60, v60
    v_exp_f32 v61, v61
    v_exp_f32 v62, v62
    v_exp_f32 v63, v63
    v_exp_f32 v32, v32
    v_exp_f32 v33, v33
    v_smfmac_f32_32x32x32_bf16 v[80:95], v[4:7], v[56:63], v8
    ds_read_b128 v[24:27], v1 offset:12288
    v_exp_f32 v34, v34
    v_exp_f32 v35, v35
    v_exp_f32 v36, v36
    v_exp_f32 v37, v37
    v_mfma_f32_32x32x16_bf16 v[48:63], v[96:99], v[20:23], 0
    v_add_u32 v3, v2, v3
    ds_read_b128 v[28:31], v3 offset:0
    v_exp_f32 v38, v38
    v_exp_f32 v39, v39
    v_exp_f32 v40, v40
    v_exp_f32 v41, v41
    v_smfmac_f32_32x32x32_bf16 v[64:79], v[10:13], v[32:39], v8
    ds_read_b128 v[4:7], v3 offset:512
    v_exp_f32 v42, v42
    v_exp_f32 v43, v43
    v_exp_f32 v44, v44
    v_exp_f32 v45, v45
    v_exp_f32 v46, v46
    v_exp_f32 v47, v47
    v_exp_f32 v48, v48
    v_exp_f32 v49, v49
    v_smfmac_f32_32x32x32_bf16 v[64:79], v[100:103], v[40:47], v8
    s_waitcnt lgkmcnt(2)
    buffer_load_dwordx4 v1, s[4:7], s23 offen offset:2048 sc1 lds
    v_exp_f32 v50, v50
    v_exp_f32 v51, v51
    v_exp_f32 v52, v52
    v_exp_f32 v53, v53
    v_mfma_f32_32x32x16_bf16 v[32:47], v[24:27], v[16:19], 0
    buffer_load_dwordx4 v1, s[4:7], s23 offen offset:3072 sc1 lds
    v_exp_f32 v54, v54
    v_exp_f32 v55, v55
    v_exp_f32 v56, v56
    v_exp_f32 v57, v57
    v_smfmac_f32_32x32x32_bf16 v[80:95], v[10:13], v[48:55], v8
    s_waitcnt lgkmcnt(0)
    v_exp_f32 v58, v58
    v_exp_f32 v59, v59
    v_exp_f32 v60, v60
    v_exp_f32 v61, v61
    v_exp_f32 v62, v62
    v_exp_f32 v63, v63
    v_exp_f32 v32, v32
    v_exp_f32 v33, v33
    v_smfmac_f32_32x32x32_bf16 v[80:95], v[100:103], v[56:63], v8
    ds_read_b128 v[96:99], v1 offset:13312
    v_exp_f32 v34, v34
    v_exp_f32 v35, v35
    v_exp_f32 v36, v36
    v_exp_f32 v37, v37
    v_mfma_f32_32x32x16_bf16 v[48:63], v[24:27], v[20:23], 0
    ds_read_b128 v[10:13], v3 offset:1024
    v_exp_f32 v38, v38
    v_exp_f32 v39, v39
    v_exp_f32 v40, v40
    v_exp_f32 v41, v41
    v_smfmac_f32_32x32x32_bf16 v[64:79], v[28:31], v[32:39], v8
    ds_read_b128 v[100:103], v3 offset:1536
    v_exp_f32 v42, v42
    v_exp_f32 v43, v43
    v_exp_f32 v44, v44
    v_exp_f32 v45, v45
    v_exp_f32 v46, v46
    v_exp_f32 v47, v47
    v_exp_f32 v48, v48
    v_exp_f32 v49, v49
    v_smfmac_f32_32x32x32_bf16 v[64:79], v[4:7], v[40:47], v8
    s_waitcnt lgkmcnt(2)
    v_exp_f32 v50, v50
    v_exp_f32 v51, v51
    v_exp_f32 v52, v52
    v_exp_f32 v53, v53
    v_mfma_f32_32x32x16_bf16 v[32:47], v[96:99], v[16:19], 0
    v_exp_f32 v54, v54
    v_exp_f32 v55, v55
    v_exp_f32 v56, v56
    v_exp_f32 v57, v57
    v_smfmac_f32_32x32x32_bf16 v[80:95], v[28:31], v[48:55], v8
    s_waitcnt lgkmcnt(0)
    v_exp_f32 v58, v58
    v_exp_f32 v59, v59
    v_exp_f32 v60, v60
    v_exp_f32 v61, v61
    v_exp_f32 v62, v62
    v_exp_f32 v63, v63
    v_exp_f32 v32, v32
    v_exp_f32 v33, v33
    v_smfmac_f32_32x32x32_bf16 v[80:95], v[4:7], v[56:63], v8
    ds_read_b128 v[24:27], v1 offset:14336
    v_exp_f32 v34, v34
    v_exp_f32 v35, v35
    v_exp_f32 v36, v36
    v_exp_f32 v37, v37
    v_mfma_f32_32x32x16_bf16 v[48:63], v[96:99], v[20:23], 0
    ds_read_b128 v[28:31], v3 offset:2048
    v_exp_f32 v38, v38
    v_exp_f32 v39, v39
    v_exp_f32 v40, v40
    v_exp_f32 v41, v41
    v_smfmac_f32_32x32x32_bf16 v[64:79], v[10:13], v[32:39], v8
    ds_read_b128 v[4:7], v3 offset:2560
    v_exp_f32 v42, v42
    v_exp_f32 v43, v43
    v_exp_f32 v44, v44
    v_exp_f32 v45, v45
    v_exp_f32 v46, v46
    v_exp_f32 v47, v47
    v_exp_f32 v48, v48
    v_exp_f32 v49, v49
    v_smfmac_f32_32x32x32_bf16 v[64:79], v[100:103], v[40:47], v8
    s_waitcnt lgkmcnt(2)
    v_exp_f32 v50, v50
    v_exp_f32 v51, v51
    v_exp_f32 v52, v52
    v_exp_f32 v53, v53
    v_mfma_f32_32x32x16_bf16 v[32:47], v[24:27], v[16:19], 0
    v_exp_f32 v54, v54
    v_exp_f32 v55, v55
    v_exp_f32 v56, v56
    v_exp_f32 v57, v57
    v_smfmac_f32_32x32x32_bf16 v[80:95], v[10:13], v[48:55], v8
    s_waitcnt lgkmcnt(0)
    v_exp_f32 v58, v58
    v_exp_f32 v59, v59
    v_exp_f32 v60, v60
    v_exp_f32 v61, v61
    v_exp_f32 v62, v62
    v_exp_f32 v63, v63
    v_exp_f32 v32, v32
    v_exp_f32 v33, v33
    v_smfmac_f32_32x32x32_bf16 v[80:95], v[100:103], v[56:63], v8
    ds_read_b128 v[96:99], v1 offset:15360
    v_exp_f32 v34, v34
    v_exp_f32 v35, v35
    v_exp_f32 v36, v36
    v_exp_f32 v37, v37
    v_mfma_f32_32x32x16_bf16 v[48:63], v[24:27], v[20:23], 0
    ds_read_b128 v[10:13], v3 offset:3072
    v_exp_f32 v38, v38
    v_exp_f32 v39, v39
    v_exp_f32 v40, v40
    v_exp_f32 v41, v41
    v_smfmac_f32_32x32x32_bf16 v[64:79], v[28:31], v[32:39], v8
    ds_read_b128 v[100:103], v3 offset:3584
    v_exp_f32 v42, v42
    v_exp_f32 v43, v43
    v_exp_f32 v44, v44
    v_exp_f32 v45, v45
    v_exp_f32 v46, v46
    v_exp_f32 v47, v47
    v_exp_f32 v48, v48
    v_exp_f32 v49, v49
    v_smfmac_f32_32x32x32_bf16 v[64:79], v[4:7], v[40:47], v8
    s_waitcnt lgkmcnt(2)
    v_exp_f32 v50, v50
    v_exp_f32 v51, v51
    v_exp_f32 v52, v52
    v_exp_f32 v53, v53
    v_mfma_f32_32x32x16_bf16 v[32:47], v[96:99], v[16:19], 0
    v_exp_f32 v54, v54
    v_exp_f32 v55, v55
    v_exp_f32 v56, v56
    v_exp_f32 v57, v57
    v_smfmac_f32_32x32x32_bf16 v[80:95], v[28:31], v[48:55], v8
    s_waitcnt lgkmcnt(0)
    v_exp_f32 v58, v58
    v_exp_f32 v59, v59
    v_exp_f32 v60, v60
    v_exp_f32 v61, v61
    v_exp_f32 v62, v62
    v_exp_f32 v63, v63
    v_exp_f32 v32, v32
    v_exp_f32 v33, v33
    v_smfmac_f32_32x32x32_bf16 v[80:95], v[4:7], v[56:63], v8
    ds_read_b128 v[24:27], v1 offset:16384
    v_exp_f32 v34, v34
    v_exp_f32 v35, v35
    v_exp_f32 v36, v36
    v_exp_f32 v37, v37
    v_mfma_f32_32x32x16_bf16 v[48:63], v[96:99], v[20:23], 0
    v_add_u32 v3, v2, v3
    ds_read_b128 v[28:31], v3 offset:0
    v_exp_f32 v38, v38
    v_exp_f32 v39, v39
    v_exp_f32 v40, v40
    v_exp_f32 v41, v41
    v_smfmac_f32_32x32x32_bf16 v[64:79], v[10:13], v[32:39], v8
    ds_read_b128 v[4:7], v3 offset:512
    v_exp_f32 v42, v42
    v_exp_f32 v43, v43
    v_exp_f32 v44, v44
    v_exp_f32 v45, v45
    v_exp_f32 v46, v46
    v_exp_f32 v47, v47
    v_exp_f32 v48, v48
    v_exp_f32 v49, v49
    v_smfmac_f32_32x32x32_bf16 v[64:79], v[100:103], v[40:47], v8
    s_waitcnt lgkmcnt(2)
    v_exp_f32 v50, v50
    v_exp_f32 v51, v51
    v_exp_f32 v52, v52
    v_exp_f32 v53, v53
    v_mfma_f32_32x32x16_bf16 v[32:47], v[24:27], v[16:19], 0
    v_exp_f32 v54, v54
    v_exp_f32 v55, v55
    v_exp_f32 v56, v56
    v_exp_f32 v57, v57
    v_smfmac_f32_32x32x32_bf16 v[80:95], v[10:13], v[48:55], v8
    s_waitcnt lgkmcnt(0)
    v_exp_f32 v58, v58
    v_exp_f32 v59, v59
    v_exp_f32 v60, v60
    v_exp_f32 v61, v61
    v_exp_f32 v62, v62
    v_exp_f32 v63, v63
    v_exp_f32 v32, v32
    v_exp_f32 v33, v33
    v_smfmac_f32_32x32x32_bf16 v[80:95], v[100:103], v[56:63], v8
    ds_read_b128 v[96:99], v1 offset:17408
    v_exp_f32 v34, v34
    v_exp_f32 v35, v35
    v_exp_f32 v36, v36
    v_exp_f32 v37, v37
    v_mfma_f32_32x32x16_bf16 v[48:63], v[24:27], v[20:23], 0
    ds_read_b128 v[10:13], v3 offset:1024
    v_exp_f32 v38, v38
    v_exp_f32 v39, v39
    v_exp_f32 v40, v40
    v_exp_f32 v41, v41
    v_smfmac_f32_32x32x32_bf16 v[64:79], v[28:31], v[32:39], v8
    ds_read_b128 v[100:103], v3 offset:1536
    v_exp_f32 v42, v42
    v_exp_f32 v43, v43
    v_exp_f32 v44, v44
    v_exp_f32 v45, v45
    v_exp_f32 v46, v46
    v_exp_f32 v47, v47
    v_exp_f32 v48, v48
    v_exp_f32 v49, v49
    v_smfmac_f32_32x32x32_bf16 v[64:79], v[4:7], v[40:47], v8
    s_waitcnt lgkmcnt(2)
    v_exp_f32 v50, v50
    v_exp_f32 v51, v51
    v_exp_f32 v52, v52
    v_exp_f32 v53, v53
    v_mfma_f32_32x32x16_bf16 v[32:47], v[96:99], v[16:19], 0
    v_exp_f32 v54, v54
    v_exp_f32 v55, v55
    v_exp_f32 v56, v56
    v_exp_f32 v57, v57
    v_smfmac_f32_32x32x32_bf16 v[80:95], v[28:31], v[48:55], v8
    s_waitcnt lgkmcnt(0)
    v_exp_f32 v58, v58
    v_exp_f32 v59, v59
    v_exp_f32 v60, v60
    v_exp_f32 v61, v61
    v_exp_f32 v62, v62
    v_exp_f32 v63, v63
    v_exp_f32 v32, v32
    v_exp_f32 v33, v33
    v_smfmac_f32_32x32x32_bf16 v[80:95], v[4:7], v[56:63], v8
    ds_read_b128 v[24:27], v1 offset:18432
    v_exp_f32 v34, v34
    v_exp_f32 v35, v35
    v_exp_f32 v36, v36
    v_exp_f32 v37, v37
    v_mfma_f32_32x32x16_bf16 v[48:63], v[96:99], v[20:23], 0
    ds_read_b128 v[28:31], v3 offset:2048
    v_exp_f32 v38, v38
    v_exp_f32 v39, v39
    v_exp_f32 v40, v40
    v_exp_f32 v41, v41
    v_smfmac_f32_32x32x32_bf16 v[64:79], v[10:13], v[32:39], v8
    ds_read_b128 v[4:7], v3 offset:2560
    v_exp_f32 v42, v42
    v_exp_f32 v43, v43
    v_exp_f32 v44, v44
    v_exp_f32 v45, v45
    v_exp_f32 v46, v46
    v_exp_f32 v47, v47
    v_exp_f32 v48, v48
    v_exp_f32 v49, v49
    v_smfmac_f32_32x32x32_bf16 v[64:79], v[100:103], v[40:47], v8
    s_waitcnt lgkmcnt(2)
    v_exp_f32 v50, v50
    v_exp_f32 v51, v51
    v_exp_f32 v52, v52
    v_exp_f32 v53, v53
    v_mfma_f32_32x32x16_bf16 v[32:47], v[24:27], v[16:19], 0
    v_exp_f32 v54, v54
    v_exp_f32 v55, v55
    v_exp_f32 v56, v56
    v_exp_f32 v57, v57
    v_smfmac_f32_32x32x32_bf16 v[80:95], v[10:13], v[48:55], v8
    s_waitcnt lgkmcnt(0)
    v_exp_f32 v58, v58
    v_exp_f32 v59, v59
    v_exp_f32 v60, v60
    v_exp_f32 v61, v61
    v_exp_f32 v62, v62
    v_exp_f32 v63, v63
    v_exp_f32 v32, v32
    v_exp_f32 v33, v33
    v_smfmac_f32_32x32x32_bf16 v[80:95], v[100:103], v[56:63], v8
    ds_read_b128 v[96:99], v1 offset:19456
    v_exp_f32 v34, v34
    v_exp_f32 v35, v35
    v_exp_f32 v36, v36
    v_exp_f32 v37, v37
    v_mfma_f32_32x32x16_bf16 v[48:63], v[24:27], v[20:23], 0
    ds_read_b128 v[10:13], v3 offset:3072
    v_exp_f32 v38, v38
    v_exp_f32 v39, v39
    v_exp_f32 v40, v40
    v_exp_f32 v41, v41
    v_smfmac_f32_32x32x32_bf16 v[64:79], v[28:31], v[32:39], v8
    ds_read_b128 v[100:103], v3 offset:3584
    v_exp_f32 v42, v42
    v_exp_f32 v43, v43
    v_exp_f32 v44, v44
    v_exp_f32 v45, v45
    v_exp_f32 v46, v46
    v_exp_f32 v47, v47
    v_exp_f32 v48, v48
    v_exp_f32 v49, v49
    v_smfmac_f32_32x32x32_bf16 v[64:79], v[4:7], v[40:47], v8
    s_waitcnt lgkmcnt(2)
    v_exp_f32 v50, v50
    v_exp_f32 v51, v51
    v_exp_f32 v52, v52
    v_exp_f32 v53, v53
    v_mfma_f32_32x32x16_bf16 v[32:47], v[96:99], v[16:19], 0
    v_exp_f32 v54, v54
    v_exp_f32 v55, v55
    v_exp_f32 v56, v56
    v_exp_f32 v57, v57
    v_smfmac_f32_32x32x32_bf16 v[80:95], v[28:31], v[48:55], v8
    s_waitcnt lgkmcnt(0)
    v_exp_f32 v58, v58
    v_exp_f32 v59, v59
    v_exp_f32 v60, v60
    v_exp_f32 v61, v61
    v_exp_f32 v62, v62
    v_exp_f32 v63, v63
    v_exp_f32 v32, v32
    v_exp_f32 v33, v33
    v_smfmac_f32_32x32x32_bf16 v[80:95], v[4:7], v[56:63], v8
    ds_read_b128 v[24:27], v1 offset:20480
    v_exp_f32 v34, v34
    v_exp_f32 v35, v35
    v_exp_f32 v36, v36
    v_exp_f32 v37, v37
    v_mfma_f32_32x32x16_bf16 v[48:63], v[96:99], v[20:23], 0
    v_add_u32 v3, v2, v3
    ds_read_b128 v[28:31], v3 offset:0
    v_exp_f32 v38, v38
    v_exp_f32 v39, v39
    v_exp_f32 v40, v40
    v_exp_f32 v41, v41
    v_smfmac_f32_32x32x32_bf16 v[64:79], v[10:13], v[32:39], v8
    ds_read_b128 v[4:7], v3 offset:512
    v_exp_f32 v42, v42
    v_exp_f32 v43, v43
    v_exp_f32 v44, v44
    v_exp_f32 v45, v45
    v_exp_f32 v46, v46
    v_exp_f32 v47, v47
    v_exp_f32 v48, v48
    v_exp_f32 v49, v49
    v_smfmac_f32_32x32x32_bf16 v[64:79], v[100:103], v[40:47], v8
    s_waitcnt lgkmcnt(2)
    v_exp_f32 v50, v50
    v_exp_f32 v51, v51
    v_exp_f32 v52, v52
    v_exp_f32 v53, v53
    v_mfma_f32_32x32x16_bf16 v[32:47], v[24:27], v[16:19], 0
    v_exp_f32 v54, v54
    v_exp_f32 v55, v55
    v_exp_f32 v56, v56
    v_exp_f32 v57, v57
    v_smfmac_f32_32x32x32_bf16 v[80:95], v[10:13], v[48:55], v8
    s_waitcnt lgkmcnt(0)
    v_exp_f32 v58, v58
    v_exp_f32 v59, v59
    v_exp_f32 v60, v60
    v_exp_f32 v61, v61
    v_exp_f32 v62, v62
    v_exp_f32 v63, v63
    v_exp_f32 v32, v32
    v_exp_f32 v33, v33
    v_smfmac_f32_32x32x32_bf16 v[80:95], v[100:103], v[56:63], v8
    buffer_load_dword v255, v9, s[4:7], s37 offen sc1
    ds_read_b128 v[96:99], v1 offset:21504
    v_exp_f32 v34, v34
    v_exp_f32 v35, v35
    v_exp_f32 v36, v36
    v_exp_f32 v37, v37
    v_mfma_f32_32x32x16_bf16 v[48:63], v[24:27], v[20:23], 0
    ds_read_b128 v[10:13], v3 offset:1024
    v_exp_f32 v38, v38
    v_exp_f32 v39, v39
    v_exp_f32 v40, v40
    v_exp_f32 v41, v41
    v_smfmac_f32_32x32x32_bf16 v[64:79], v[28:31], v[32:39], v8
    ds_read_b128 v[100:103], v3 offset:1536
    v_exp_f32 v42, v42
    v_exp_f32 v43, v43
    v_exp_f32 v44, v44
    v_exp_f32 v45, v45
    v_exp_f32 v46, v46
    v_exp_f32 v47, v47
    v_exp_f32 v48, v48
    v_exp_f32 v49, v49
    v_smfmac_f32_32x32x32_bf16 v[64:79], v[4:7], v[40:47], v8
    s_waitcnt lgkmcnt(2)
    v_exp_f32 v50, v50
    v_exp_f32 v51, v51
    v_exp_f32 v52, v52
    v_exp_f32 v53, v53
    v_mfma_f32_32x32x16_bf16 v[32:47], v[96:99], v[16:19], 0
    v_exp_f32 v54, v54
    v_exp_f32 v55, v55
    v_exp_f32 v56, v56
    v_exp_f32 v57, v57
    v_smfmac_f32_32x32x32_bf16 v[80:95], v[28:31], v[48:55], v8
    s_waitcnt lgkmcnt(0)
    v_exp_f32 v58, v58
    v_exp_f32 v59, v59
    v_exp_f32 v60, v60
    v_exp_f32 v61, v61
    v_exp_f32 v62, v62
    v_exp_f32 v63, v63
    v_exp_f32 v32, v32
    v_exp_f32 v33, v33
    v_smfmac_f32_32x32x32_bf16 v[80:95], v[4:7], v[56:63], v8
    ds_read_b128 v[24:27], v1 offset:22528
    v_exp_f32 v34, v34
    v_exp_f32 v35, v35
    v_exp_f32 v36, v36
    v_exp_f32 v37, v37
    v_mfma_f32_32x32x16_bf16 v[48:63], v[96:99], v[20:23], 0
    ds_read_b128 v[28:31], v3 offset:2048
    v_exp_f32 v38, v38
    v_exp_f32 v39, v39
    v_exp_f32 v40, v40
    v_exp_f32 v41, v41
    v_smfmac_f32_32x32x32_bf16 v[64:79], v[10:13], v[32:39], v8
    ds_read_b128 v[4:7], v3 offset:2560
    v_exp_f32 v42, v42
    v_exp_f32 v43, v43
    v_exp_f32 v44, v44
    v_exp_f32 v45, v45
    v_exp_f32 v46, v46
    v_exp_f32 v47, v47
    v_exp_f32 v48, v48
    v_exp_f32 v49, v49
    v_smfmac_f32_32x32x32_bf16 v[64:79], v[100:103], v[40:47], v8
    s_waitcnt lgkmcnt(2)
    v_exp_f32 v50, v50
    v_exp_f32 v51, v51
    v_exp_f32 v52, v52
    v_exp_f32 v53, v53
    v_mfma_f32_32x32x16_bf16 v[32:47], v[24:27], v[16:19], 0
    v_exp_f32 v54, v54
    v_exp_f32 v55, v55
    v_exp_f32 v56, v56
    v_exp_f32 v57, v57
    v_smfmac_f32_32x32x32_bf16 v[80:95], v[10:13], v[48:55], v8
    s_waitcnt lgkmcnt(0)
    v_exp_f32 v58, v58
    v_exp_f32 v59, v59
    v_exp_f32 v60, v60
    v_exp_f32 v61, v61
    v_exp_f32 v62, v62
    v_exp_f32 v63, v63
    v_exp_f32 v32, v32
    v_exp_f32 v33, v33
    v_smfmac_f32_32x32x32_bf16 v[80:95], v[100:103], v[56:63], v8
    ds_read_b128 v[96:99], v1 offset:23552
    v_exp_f32 v34, v34
    v_exp_f32 v35, v35
    v_exp_f32 v36, v36
    v_exp_f32 v37, v37
    v_mfma_f32_32x32x16_bf16 v[48:63], v[24:27], v[20:23], 0
    ds_read_b128 v[10:13], v3 offset:3072
    v_exp_f32 v38, v38
    v_exp_f32 v39, v39
    v_exp_f32 v40, v40
    v_exp_f32 v41, v41
    v_smfmac_f32_32x32x32_bf16 v[64:79], v[28:31], v[32:39], v8
    ds_read_b128 v[100:103], v3 offset:3584
    v_exp_f32 v42, v42
    v_exp_f32 v43, v43
    v_exp_f32 v44, v44
    v_exp_f32 v45, v45
    v_exp_f32 v46, v46
    v_exp_f32 v47, v47
    v_exp_f32 v48, v48
    v_exp_f32 v49, v49
    v_smfmac_f32_32x32x32_bf16 v[64:79], v[4:7], v[40:47], v8
    s_waitcnt lgkmcnt(2)
    v_exp_f32 v50, v50
    v_exp_f32 v51, v51
    v_exp_f32 v52, v52
    v_exp_f32 v53, v53
    v_mfma_f32_32x32x16_bf16 v[32:47], v[96:99], v[16:19], 0
    v_exp_f32 v54, v54
    v_exp_f32 v55, v55
    v_exp_f32 v56, v56
    v_exp_f32 v57, v57
    v_smfmac_f32_32x32x32_bf16 v[80:95], v[28:31], v[48:55], v8
    s_waitcnt lgkmcnt(0)
    v_exp_f32 v58, v58
    v_exp_f32 v59, v59
    v_exp_f32 v60, v60
    v_exp_f32 v61, v61
    v_exp_f32 v62, v62
    v_exp_f32 v63, v63
    v_exp_f32 v32, v32
    v_exp_f32 v33, v33
    v_smfmac_f32_32x32x32_bf16 v[80:95], v[4:7], v[56:63], v8
    s_waitcnt vmcnt(0)
    v_cmp_gt_u32 vcc, 32, v255
    s_nop 0
    s_cbranch_vccnz L_notready
L_ready:
    v_lshlrev_b32 v9, 6, v0
    s_waitcnt vmcnt(1)
    s_barrier
    ds_read_b128 v[24:27], v1 offset:24576
    v_exp_f32 v34, v34
    v_exp_f32 v35, v35
    v_exp_f32 v36, v36
    v_exp_f32 v37, v37
    v_mfma_f32_32x32x16_bf16 v[48:63], v[96:99], v[20:23], 0
    v_add_u32 v3, v2, v3
    ds_read_b128 v[28:31], v3 offset:0
    v_exp_f32 v38, v38
    v_exp_f32 v39, v39
    v_exp_f32 v40, v40
    v_exp_f32 v41, v41
    v_smfmac_f32_32x32x32_bf16 v[64:79], v[10:13], v[32:39], v8
    ds_read_b128 v[4:7], v3 offset:512
    v_exp_f32 v42, v42
    v_exp_f32 v43, v43
    v_exp_f32 v44, v44
    v_exp_f32 v45, v45
    v_exp_f32 v46, v46
    v_exp_f32 v47, v47
    v_exp_f32 v48, v48
    v_exp_f32 v49, v49
    v_smfmac_f32_32x32x32_bf16 v[64:79], v[100:103], v[40:47], v8
    s_waitcnt lgkmcnt(2)
    s_mul_i32 s55, s53, 32768
    s_mul_i32 s56, s54, 16384
    s_add_u32 s55, s55, s56
    s_add_u32 s55, s55, 3276800
    buffer_load_dwordx4 a[192:195], v1, s[4:7], s55 offen offset:0
    v_exp_f32 v50, v50
    v_exp_f32 v51, v51
    v_exp_f32 v52, v52
    v_exp_f32 v53, v53
    v_mfma_f32_32x32x16_bf16 v[32:47], v[24:27], v[16:19], 0
    buffer_load_dwordx4 a[196:199], v1, s[4:7], s55 offen offset:1024
    v_exp_f32 v54, v54
    v_exp_f32 v55, v55
    v_exp_f32 v56, v56
    v_exp_f32 v57, v57
    v_smfmac_f32_32x32x32_bf16 v[80:95], v[10:13], v[48:55], v8
    s_waitcnt lgkmcnt(0)
    buffer_load_dwordx4 a[200:203], v1, s[4:7], s55 offen offset:2048
    v_exp_f32 v58, v58
    v_exp_f32 v59, v59
    v_exp_f32 v60, v60
    v_exp_f32 v61, v61
    v_exp_f32 v62, v62
    v_exp_f32 v63, v63
    v_exp_f32 v32, v32
    v_exp_f32 v33, v33
    v_smfmac_f32_32x32x32_bf16 v[80:95], v[100:103], v[56:63], v8
    ds_read_b128 v[96:99], v1 offset:25600
    v_exp_f32 v34, v34
    v_exp_f32 v35, v35
    v_exp_f32 v36, v36
    v_exp_f32 v37, v37
    v_mfma_f32_32x32x16_bf16 v[48:63], v[24:27], v[20:23], 0
    ds_read_b128 v[10:13], v3 offset:1024
    v_exp_f32 v38, v38
    v_exp_f32 v39, v39
    v_exp_f32 v40, v40
    v_exp_f32 v41, v41
    v_smfmac_f32_32x32x32_bf16 v[64:79], v[28:31], v[32:39], v8
    ds_read_b128 v[100:103], v3 offset:1536
    v_exp_f32 v42, v42
    v_exp_f32 v43, v43
    v_exp_f32 v44, v44
    v_exp_f32 v45, v45
    v_exp_f32 v46, v46
    v_exp_f32 v47, v47
    v_exp_f32 v48, v48
    v_exp_f32 v49, v49
    v_smfmac_f32_32x32x32_bf16 v[64:79], v[4:7], v[40:47], v8
    s_waitcnt lgkmcnt(2)
    buffer_load_dwordx4 a[204:207], v1, s[4:7], s55 offen offset:3072
    v_exp_f32 v50, v50
    v_exp_f32 v51, v51
    v_exp_f32 v52, v52
    v_exp_f32 v53, v53
    v_mfma_f32_32x32x16_bf16 v[32:47], v[96:99], v[16:19], 0
    s_add_u32 s55, s55, 4096
    buffer_load_dwordx4 a[208:211], v1, s[4:7], s55 offen offset:0
    v_exp_f32 v54, v54
    v_exp_f32 v55, v55
    v_exp_f32 v56, v56
    v_exp_f32 v57, v57
    v_smfmac_f32_32x32x32_bf16 v[80:95], v[28:31], v[48:55], v8
    s_waitcnt lgkmcnt(0)
    buffer_load_dwordx4 a[212:215], v1, s[4:7], s55 offen offset:1024
    v_exp_f32 v58, v58
    v_exp_f32 v59, v59
    v_exp_f32 v60, v60
    v_exp_f32 v61, v61
    v_exp_f32 v62, v62
    v_exp_f32 v63, v63
    v_exp_f32 v32, v32
    v_exp_f32 v33, v33
    v_smfmac_f32_32x32x32_bf16 v[80:95], v[4:7], v[56:63], v8
    ds_read_b128 v[24:27], v1 offset:26624
    v_exp_f32 v34, v34
    v_exp_f32 v35, v35
    v_exp_f32 v36, v36
    v_exp_f32 v37, v37
    v_mfma_f32_32x32x16_bf16 v[48:63], v[96:99], v[20:23], 0
    ds_read_b128 v[28:31], v3 offset:2048
    v_exp_f32 v38, v38
    v_exp_f32 v39, v39
    v_exp_f32 v40, v40
    v_exp_f32 v41, v41
    v_smfmac_f32_32x32x32_bf16 v[64:79], v[10:13], v[32:39], v8
    ds_read_b128 v[4:7], v3 offset:2560
    v_exp_f32 v42, v42
    v_exp_f32 v43, v43
    v_exp_f32 v44, v44
    v_exp_f32 v45, v45
    v_exp_f32 v46, v46
    v_exp_f32 v47, v47
    v_exp_f32 v48, v48
    v_exp_f32 v49, v49
    v_smfmac_f32_32x32x32_bf16 v[64:79], v[100:103], v[40:47], v8
    s_waitcnt lgkmcnt(2)
    buffer_load_dwordx4 a[216:219], v1, s[4:7], s55 offen offset:2048
    v_exp_f32 v50, v50
    v_exp_f32 v51, v51
    v_exp_f32 v52, v52
    v_exp_f32 v53, v53
    v_mfma_f32_32x32x16_bf16 v[32:47], v[24:27], v[16:19], 0
    buffer_load_dwordx4 a[220:223], v1, s[4:7], s55 offen offset:3072
    v_exp_f32 v54, v54
    v_exp_f32 v55, v55
    v_exp_f32 v56, v56
    v_exp_f32 v57, v57
    v_smfmac_f32_32x32x32_bf16 v[80:95], v[10:13], v[48:55], v8
    s_waitcnt lgkmcnt(0)
    s_add_u32 s55, s55, 4096
    buffer_load_dwordx4 a[224:227], v1, s[4:7], s55 offen offset:0
    v_exp_f32 v58, v58
    v_exp_f32 v59, v59
    v_exp_f32 v60, v60
    v_exp_f32 v61, v61
    v_exp_f32 v62, v62
    v_exp_f32 v63, v63
    v_exp_f32 v32, v32
    v_exp_f32 v33, v33
    v_smfmac_f32_32x32x32_bf16 v[80:95], v[100:103], v[56:63], v8
    ds_read_b128 v[96:99], v1 offset:27648
    v_exp_f32 v34, v34
    v_exp_f32 v35, v35
    v_exp_f32 v36, v36
    v_exp_f32 v37, v37
    v_mfma_f32_32x32x16_bf16 v[48:63], v[24:27], v[20:23], 0
    ds_read_b128 v[10:13], v3 offset:3072
    v_exp_f32 v38, v38
    v_exp_f32 v39, v39
    v_exp_f32 v40, v40
    v_exp_f32 v41, v41
    v_smfmac_f32_32x32x32_bf16 v[64:79], v[28:31], v[32:39], v8
    ds_read_b128 v[100:103], v3 offset:3584
    v_exp_f32 v42, v42
    v_exp_f32 v43, v43
    v_exp_f32 v44, v44
    v_exp_f32 v45, v45
    v_exp_f32 v46, v46
    v_exp_f32 v47, v47
    v_exp_f32 v48, v48
    v_exp_f32 v49, v49
    v_smfmac_f32_32x32x32_bf16 v[64:79], v[4:7], v[40:47], v8
    s_waitcnt lgkmcnt(2)
    buffer_load_dwordx4 a[228:231], v1, s[4:7], s55 offen offset:1024
    v_exp_f32 v50, v50
    v_exp_f32 v51, v51
    v_exp_f32 v52, v52
    v_exp_f32 v53, v53
    v_mfma_f32_32x32x16_bf16 v[32:47], v[96:99], v[16:19], 0
    buffer_load_dwordx4 a[232:235], v1, s[4:7], s55 offen offset:2048
    v_exp_f32 v54, v54
    v_exp_f32 v55, v55
    v_exp_f32 v56, v56
    v_exp_f32 v57, v57
    v_smfmac_f32_32x32x32_bf16 v[80:95], v[28:31], v[48:55], v8
    s_waitcnt lgkmcnt(0)
    buffer_load_dwordx4 a[236:239], v1, s[4:7], s55 offen offset:3072
    v_exp_f32 v58, v58
    v_exp_f32 v59, v59
    v_exp_f32 v60, v60
    v_exp_f32 v61, v61
    v_exp_f32 v62, v62
    v_exp_f32 v63, v63
    v_exp_f32 v32, v32
    v_exp_f32 v33, v33
    v_smfmac_f32_32x32x32_bf16 v[80:95], v[4:7], v[56:63], v8
    ds_read_b128 v[24:27], v1 offset:28672
    v_exp_f32 v34, v34
    v_exp_f32 v35, v35
    v_exp_f32 v36, v36
    v_exp_f32 v37, v37
    v_mfma_f32_32x32x16_bf16 v[48:63], v[96:99], v[20:23], 0
    v_add_u32 v3, v2, v3
    ds_read_b128 v[28:31], v3 offset:0
    v_exp_f32 v38, v38
    v_exp_f32 v39, v39
    v_exp_f32 v40, v40
    v_exp_f32 v41, v41
    v_smfmac_f32_32x32x32_bf16 v[64:79], v[10:13], v[32:39], v8
    ds_read_b128 v[4:7], v3 offset:512
    v_exp_f32 v42, v42
    v_exp_f32 v43, v43
    v_exp_f32 v44, v44
    v_exp_f32 v45, v45
    v_exp_f32 v46, v46
    v_exp_f32 v47, v47
    v_exp_f32 v48, v48
    v_exp_f32 v49, v49
    v_smfmac_f32_32x32x32_bf16 v[64:79], v[100:103], v[40:47], v8
    s_waitcnt lgkmcnt(2)
    s_add_u32 s55, s55, 4096
    buffer_load_dwordx4 a[240:243], v1, s[4:7], s55 offen offset:0
    v_exp_f32 v50, v50
    v_exp_f32 v51, v51
    v_exp_f32 v52, v52
    v_exp_f32 v53, v53
    v_mfma_f32_32x32x16_bf16 v[32:47], v[24:27], v[16:19], 0
    buffer_load_dwordx4 a[244:247], v1, s[4:7], s55 offen offset:1024
    v_exp_f32 v54, v54
    v_exp_f32 v55, v55
    v_exp_f32 v56, v56
    v_exp_f32 v57, v57
    v_smfmac_f32_32x32x32_bf16 v[80:95], v[10:13], v[48:55], v8
    s_waitcnt lgkmcnt(0)
    buffer_load_dwordx4 a[248:251], v1, s[4:7], s55 offen offset:2048
    v_exp_f32 v58, v58
    v_exp_f32 v59, v59
    v_exp_f32 v60, v60
    v_exp_f32 v61, v61
    v_exp_f32 v62, v62
    v_exp_f32 v63, v63
    v_exp_f32 v32, v32
    v_exp_f32 v33, v33
    v_smfmac_f32_32x32x32_bf16 v[80:95], v[100:103], v[56:63], v8
    ds_read_b128 v[96:99], v1 offset:29696
    v_exp_f32 v34, v34
    v_exp_f32 v35, v35
    v_exp_f32 v36, v36
    v_exp_f32 v37, v37
    v_mfma_f32_32x32x16_bf16 v[48:63], v[24:27], v[20:23], 0
    ds_read_b128 v[10:13], v3 offset:1024
    v_exp_f32 v38, v38
    v_exp_f32 v39, v39
    v_exp_f32 v40, v40
    v_exp_f32 v41, v41
    v_smfmac_f32_32x32x32_bf16 v[64:79], v[28:31], v[32:39], v8
    ds_read_b128 v[100:103], v3 offset:1536
    v_exp_f32 v42, v42
    v_exp_f32 v43, v43
    v_exp_f32 v44, v44
    v_exp_f32 v45, v45
    v_exp_f32 v46, v46
    v_exp_f32 v47, v47
    v_exp_f32 v48, v48
    v_exp_f32 v49, v49
    v_smfmac_f32_32x32x32_bf16 v[64:79], v[4:7], v[40:47], v8
    s_waitcnt lgkmcnt(2)
    buffer_load_dwordx4 a[252:255], v1, s[4:7], s55 offen offset:3072
    v_exp_f32 v50, v50
    v_exp_f32 v51, v51
    v_exp_f32 v52, v52
    v_exp_f32 v53, v53
    v_mfma_f32_32x32x16_bf16 v[32:47], v[96:99], v[16:19], 0
    s_mul_i32 s55, s10, 196608
    s_and_b32 s56, s8, 1
    s_lshl_b32 s56, s56, 14
    s_add_u32 s55, s55, s56
    s_lshl_b32 s56, s54, 15
    s_add_u32 s57, s55, s56
    s_add_u32 s57, s57, 1835008
    buffer_load_dwordx4 a[128:131], v1, s[4:7], s57 offen offset:0
    v_exp_f32 v54, v54
    v_exp_f32 v55, v55
    v_exp_f32 v56, v56
    v_exp_f32 v57, v57
    v_smfmac_f32_32x32x32_bf16 v[80:95], v[28:31], v[48:55], v8
    s_waitcnt lgkmcnt(0)
    buffer_load_dwordx4 a[132:135], v1, s[4:7], s57 offen offset:1024
    v_exp_f32 v58, v58
    v_exp_f32 v59, v59
    v_exp_f32 v60, v60
    v_exp_f32 v61, v61
    v_exp_f32 v62, v62
    v_exp_f32 v63, v63
    v_exp_f32 v32, v32
    v_exp_f32 v33, v33
    v_smfmac_f32_32x32x32_bf16 v[80:95], v[4:7], v[56:63], v8
    ds_read_b128 v[24:27], v1 offset:30720
    v_exp_f32 v34, v34
    v_exp_f32 v35, v35
    v_exp_f32 v36, v36
    v_exp_f32 v37, v37
    v_mfma_f32_32x32x16_bf16 v[48:63], v[96:99], v[20:23], 0
    ds_read_b128 v[28:31], v3 offset:2048
    v_exp_f32 v38, v38
    v_exp_f32 v39, v39
    v_exp_f32 v40, v40
    v_exp_f32 v41, v41
    v_smfmac_f32_32x32x32_bf16 v[64:79], v[10:13], v[32:39], v8
    ds_read_b128 v[4:7], v3 offset:2560
    v_exp_f32 v42, v42
    v_exp_f32 v43, v43
    v_exp_f32 v44, v44
    v_exp_f32 v45, v45
    v_exp_f32 v46, v46
    v_exp_f32 v47, v47
    v_exp_f32 v48, v48
    v_exp_f32 v49, v49
    v_smfmac_f32_32x32x32_bf16 v[64:79], v[100:103], v[40:47], v8
    s_waitcnt lgkmcnt(2)
    buffer_load_dwordx4 a[136:139], v1, s[4:7], s57 offen offset:2048
    v_exp_f32 v50, v50
    v_exp_f32 v51, v51
    v_exp_f32 v52, v52
    v_exp_f32 v53, v53
    v_mfma_f32_32x32x16_bf16 v[32:47], v[24:27], v[16:19], 0
    buffer_load_dwordx4 a[140:143], v1, s[4:7], s57 offen offset:3072
    v_exp_f32 v54, v54
    v_exp_f32 v55, v55
    v_exp_f32 v56, v56
    v_exp_f32 v57, v57
    v_smfmac_f32_32x32x32_bf16 v[80:95], v[10:13], v[48:55], v8
    s_waitcnt lgkmcnt(0)
    s_add_u32 s57, s57, 4096
    buffer_load_dwordx4 a[144:147], v1, s[4:7], s57 offen offset:0
    v_exp_f32 v58, v58
    v_exp_f32 v59, v59
    v_exp_f32 v60, v60
    v_exp_f32 v61, v61
    v_exp_f32 v62, v62
    v_exp_f32 v63, v63
    v_exp_f32 v32, v32
    v_exp_f32 v33, v33
    v_smfmac_f32_32x32x32_bf16 v[80:95], v[100:103], v[56:63], v8
    ds_read_b128 v[96:99], v1 offset:31744
    v_exp_f32 v34, v34
    v_exp_f32 v35, v35
    v_exp_f32 v36, v36
    v_exp_f32 v37, v37
    v_mfma_f32_32x32x16_bf16 v[48:63], v[24:27], v[20:23], 0
    ds_read_b128 v[10:13], v3 offset:3072
    v_exp_f32 v38, v38
    v_exp_f32 v39, v39
    v_exp_f32 v40, v40
    v_exp_f32 v41, v41
    v_smfmac_f32_32x32x32_bf16 v[64:79], v[28:31], v[32:39], v8
    ds_read_b128 v[100:103], v3 offset:3584
    v_exp_f32 v42, v42
    v_exp_f32 v43, v43
    v_exp_f32 v44, v44
    v_exp_f32 v45, v45
    v_exp_f32 v46, v46
    v_exp_f32 v47, v47
    v_exp_f32 v48, v48
    v_exp_f32 v49, v49
    v_smfmac_f32_32x32x32_bf16 v[64:79], v[4:7], v[40:47], v8
    s_waitcnt lgkmcnt(2)
    buffer_load_dwordx4 a[148:151], v1, s[4:7], s57 offen offset:1024
    v_exp_f32 v50, v50
    v_exp_f32 v51, v51
    v_exp_f32 v52, v52
    v_exp_f32 v53, v53
    v_mfma_f32_32x32x16_bf16 v[32:47], v[96:99], v[16:19], 0
    buffer_load_dwordx4 a[152:155], v1, s[4:7], s57 offen offset:2048
    v_exp_f32 v54, v54
    v_exp_f32 v55, v55
    v_exp_f32 v56, v56
    v_exp_f32 v57, v57
    v_smfmac_f32_32x32x32_bf16 v[80:95], v[28:31], v[48:55], v8
    s_waitcnt lgkmcnt(0)
    buffer_load_dwordx4 a[156:159], v1, s[4:7], s57 offen offset:3072
    v_exp_f32 v58, v58
    v_exp_f32 v59, v59
    v_exp_f32 v60, v60
    v_exp_f32 v61, v61
    v_exp_f32 v62, v62
    v_exp_f32 v63, v63
    v_exp_f32 v32, v32
    v_exp_f32 v33, v33
    v_smfmac_f32_32x32x32_bf16 v[80:95], v[4:7], v[56:63], v8
    ds_read_b128 v[24:27], v1 offset:32768
    v_exp_f32 v34, v34
    v_exp_f32 v35, v35
    v_exp_f32 v36, v36
    v_exp_f32 v37, v37
    v_mfma_f32_32x32x16_bf16 v[48:63], v[96:99], v[20:23], 0
    v_add_u32 v3, v2, v3
    ds_read_b128 v[28:31], v3 offset:0
    v_exp_f32 v38, v38
    v_exp_f32 v39, v39
    v_exp_f32 v40, v40
    v_exp_f32 v41, v41
    v_smfmac_f32_32x32x32_bf16 v[64:79], v[10:13], v[32:39], v8
    ds_read_b128 v[4:7], v3 offset:512
    v_exp_f32 v42, v42
    v_exp_f32 v43, v43
    v_exp_f32 v44, v44
    v_exp_f32 v45, v45
    v_exp_f32 v46, v46
    v_exp_f32 v47, v47
    v_exp_f32 v48, v48
    v_exp_f32 v49, v49
    v_smfmac_f32_32x32x32_bf16 v[64:79], v[100:103], v[40:47], v8
    s_waitcnt lgkmcnt(2)
    s_add_u32 s57, s57, 4096
    buffer_load_dwordx4 a[160:163], v1, s[4:7], s57 offen offset:0
    v_exp_f32 v50, v50
    v_exp_f32 v51, v51
    v_exp_f32 v52, v52
    v_exp_f32 v53, v53
    v_mfma_f32_32x32x16_bf16 v[32:47], v[24:27], v[16:19], 0
    buffer_load_dwordx4 a[164:167], v1, s[4:7], s57 offen offset:1024
    v_exp_f32 v54, v54
    v_exp_f32 v55, v55
    v_exp_f32 v56, v56
    v_exp_f32 v57, v57
    v_smfmac_f32_32x32x32_bf16 v[80:95], v[10:13], v[48:55], v8
    s_waitcnt lgkmcnt(0)
    buffer_load_dwordx4 a[168:171], v1, s[4:7], s57 offen offset:2048
    v_exp_f32 v58, v58
    v_exp_f32 v59, v59
    v_exp_f32 v60, v60
    v_exp_f32 v61, v61
    v_exp_f32 v62, v62
    v_exp_f32 v63, v63
    v_exp_f32 v32, v32
    v_exp_f32 v33, v33
    v_smfmac_f32_32x32x32_bf16 v[80:95], v[100:103], v[56:63], v8
    ds_read_b128 v[96:99], v1 offset:33792
    v_exp_f32 v34, v34
    v_exp_f32 v35, v35
    v_exp_f32 v36, v36
    v_exp_f32 v37, v37
    v_mfma_f32_32x32x16_bf16 v[48:63], v[24:27], v[20:23], 0
    ds_read_b128 v[10:13], v3 offset:1024
    v_exp_f32 v38, v38
    v_exp_f32 v39, v39
    v_exp_f32 v40, v40
    v_exp_f32 v41, v41
    v_smfmac_f32_32x32x32_bf16 v[64:79], v[28:31], v[32:39], v8
    ds_read_b128 v[100:103], v3 offset:1536
    v_exp_f32 v42, v42
    v_exp_f32 v43, v43
    v_exp_f32 v44, v44
    v_exp_f32 v45, v45
    v_exp_f32 v46, v46
    v_exp_f32 v47, v47
    v_exp_f32 v48, v48
    v_exp_f32 v49, v49
    v_smfmac_f32_32x32x32_bf16 v[64:79], v[4:7], v[40:47], v8
    s_waitcnt lgkmcnt(2)
    buffer_load_dwordx4 a[172:175], v1, s[4:7], s57 offen offset:3072
    v_exp_f32 v50, v50
    v_exp_f32 v51, v51
    v_exp_f32 v52, v52
    v_exp_f32 v53, v53
    v_mfma_f32_32x32x16_bf16 v[32:47], v[96:99], v[16:19], 0
    s_add_u32 s57, s57, 4096
    buffer_load_dwordx4 a[176:179], v1, s[4:7], s57 offen offset:0
    v_exp_f32 v54, v54
    v_exp_f32 v55, v55
    v_exp_f32 v56, v56
    v_exp_f32 v57, v57
    v_smfmac_f32_32x32x32_bf16 v[80:95], v[28:31], v[48:55], v8
    s_waitcnt lgkmcnt(0)
    buffer_load_dwordx4 a[180:183], v1, s[4:7], s57 offen offset:1024
    v_exp_f32 v58, v58
    v_exp_f32 v59, v59
    v_exp_f32 v60, v60
    v_exp_f32 v61, v61
    v_exp_f32 v62, v62
    v_exp_f32 v63, v63
    v_exp_f32 v32, v32
    v_exp_f32 v33, v33
    v_smfmac_f32_32x32x32_bf16 v[80:95], v[4:7], v[56:63], v8
    ds_read_b128 v[24:27], v1 offset:34816
    v_exp_f32 v34, v34
    v_exp_f32 v35, v35
    v_exp_f32 v36, v36
    v_exp_f32 v37, v37
    v_mfma_f32_32x32x16_bf16 v[48:63], v[96:99], v[20:23], 0
    ds_read_b128 v[28:31], v3 offset:2048
    v_exp_f32 v38, v38
    v_exp_f32 v39, v39
    v_exp_f32 v40, v40
    v_exp_f32 v41, v41
    v_smfmac_f32_32x32x32_bf16 v[64:79], v[10:13], v[32:39], v8
    ds_read_b128 v[4:7], v3 offset:2560
    v_exp_f32 v42, v42
    v_exp_f32 v43, v43
    v_exp_f32 v44, v44
    v_exp_f32 v45, v45
    v_exp_f32 v46, v46
    v_exp_f32 v47, v47
    v_exp_f32 v48, v48
    v_exp_f32 v49, v49
    v_smfmac_f32_32x32x32_bf16 v[64:79], v[100:103], v[40:47], v8
    s_waitcnt lgkmcnt(2)
    buffer_load_dwordx4 a[184:187], v1, s[4:7], s57 offen offset:2048
    v_exp_f32 v50, v50
    v_exp_f32 v51, v51
    v_exp_f32 v52, v52
    v_exp_f32 v53, v53
    v_mfma_f32_32x32x16_bf16 v[32:47], v[24:27], v[16:19], 0
    buffer_load_dwordx4 a[188:191], v1, s[4:7], s57 offen offset:3072
    v_exp_f32 v54, v54
    v_exp_f32 v55, v55
    v_exp_f32 v56, v56
    v_exp_f32 v57, v57
    v_smfmac_f32_32x32x32_bf16 v[80:95], v[10:13], v[48:55], v8
    s_waitcnt lgkmcnt(0)
    s_lshl_b32 s56, s8, 15
    s_add_u32 s55, s55, s56
    s_xor_b32 s57, s55, 16384
    s_add_u32 s55, s55, 1703936
    buffer_load_dwordx4 a[0:3], v1, s[4:7], s55 offen offset:0
    v_exp_f32 v58, v58
    v_exp_f32 v59, v59
    v_exp_f32 v60, v60
    v_exp_f32 v61, v61
    v_exp_f32 v62, v62
    v_exp_f32 v63, v63
    v_exp_f32 v32, v32
    v_exp_f32 v33, v33
    v_smfmac_f32_32x32x32_bf16 v[80:95], v[100:103], v[56:63], v8
    ds_read_b128 v[96:99], v1 offset:35840
    v_exp_f32 v34, v34
    v_exp_f32 v35, v35
    v_exp_f32 v36, v36
    v_exp_f32 v37, v37
    v_mfma_f32_32x32x16_bf16 v[48:63], v[24:27], v[20:23], 0
    ds_read_b128 v[10:13], v3 offset:3072
    v_exp_f32 v38, v38
    v_exp_f32 v39, v39
    v_exp_f32 v40, v40
    v_exp_f32 v41, v41
    v_smfmac_f32_32x32x32_bf16 v[64:79], v[28:31], v[32:39], v8
    ds_read_b128 v[100:103], v3 offset:3584
    v_exp_f32 v42, v42
    v_exp_f32 v43, v43
    v_exp_f32 v44, v44
    v_exp_f32 v45, v45
    v_exp_f32 v46, v46
    v_exp_f32 v47, v47
    v_exp_f32 v48, v48
    v_exp_f32 v49, v49
    v_smfmac_f32_32x32x32_bf16 v[64:79], v[4:7], v[40:47], v8
    s_waitcnt lgkmcnt(2)
    buffer_load_dwordx4 a[4:7], v1, s[4:7], s55 offen offset:1024
    v_exp_f32 v50, v50
    v_exp_f32 v51, v51
    v_exp_f32 v52, v52
    v_exp_f32 v53, v53
    v_mfma_f32_32x32x16_bf16 v[32:47], v[96:99], v[16:19], 0
    buffer_load_dwordx4 a[8:11], v1, s[4:7], s55 offen offset:2048
    v_exp_f32 v54, v54
    v_exp_f32 v55, v55
    v_exp_f32 v56, v56
    v_exp_f32 v57, v57
    v_smfmac_f32_32x32x32_bf16 v[80:95], v[28:31], v[48:55], v8
    s_waitcnt lgkmcnt(0)
    buffer_load_dwordx4 a[12:15], v1, s[4:7], s55 offen offset:3072
    v_exp_f32 v58, v58
    v_exp_f32 v59, v59
    v_exp_f32 v60, v60
    v_exp_f32 v61, v61
    v_exp_f32 v62, v62
    v_exp_f32 v63, v63
    v_exp_f32 v32, v32
    v_exp_f32 v33, v33
    v_smfmac_f32_32x32x32_bf16 v[80:95], v[4:7], v[56:63], v8
    ds_read_b128 v[24:27], v1 offset:36864
    v_exp_f32 v34, v34
    v_exp_f32 v35, v35
    v_exp_f32 v36, v36
    v_exp_f32 v37, v37
    v_mfma_f32_32x32x16_bf16 v[48:63], v[96:99], v[20:23], 0
    v_add_u32 v3, v2, v3
    ds_read_b128 v[28:31], v3 offset:0
    v_exp_f32 v38, v38
    v_exp_f32 v39, v39
    v_exp_f32 v40, v40
    v_exp_f32 v41, v41
    v_smfmac_f32_32x32x32_bf16 v[64:79], v[10:13], v[32:39], v8
    ds_read_b128 v[4:7], v3 offset:512
    v_exp_f32 v42, v42
    v_exp_f32 v43, v43
    v_exp_f32 v44, v44
    v_exp_f32 v45, v45
    v_exp_f32 v46, v46
    v_exp_f32 v47, v47
    v_exp_f32 v48, v48
    v_exp_f32 v49, v49
    v_smfmac_f32_32x32x32_bf16 v[64:79], v[100:103], v[40:47], v8
    s_waitcnt lgkmcnt(2)
    s_add_u32 s55, s55, 4096
    buffer_load_dwordx4 a[16:19], v1, s[4:7], s55 offen offset:0
    v_exp_f32 v50, v50
    v_exp_f32 v51, v51
    v_exp_f32 v52, v52
    v_exp_f32 v53, v53
    v_mfma_f32_32x32x16_bf16 v[32:47], v[24:27], v[16:19], 0
    buffer_load_dwordx4 a[20:23], v1, s[4:7], s55 offen offset:1024
    v_exp_f32 v54, v54
    v_exp_f32 v55, v55
    v_exp_f32 v56, v56
    v_exp_f32 v57, v57
    v_smfmac_f32_32x32x32_bf16 v[80:95], v[10:13], v[48:55], v8
    s_waitcnt lgkmcnt(0)
    buffer_load_dwordx4 a[24:27], v1, s[4:7], s55 offen offset:2048
    v_exp_f32 v58, v58
    v_exp_f32 v59, v59
    v_exp_f32 v60, v60
    v_exp_f32 v61, v61
    v_exp_f32 v62, v62
    v_exp_f32 v63, v63
    v_exp_f32 v32, v32
    v_exp_f32 v33, v33
    v_smfmac_f32_32x32x32_bf16 v[80:95], v[100:103], v[56:63], v8
    ds_read_b128 v[96:99], v1 offset:37888
    v_exp_f32 v34, v34
    v_exp_f32 v35, v35
    v_exp_f32 v36, v36
    v_exp_f32 v37, v37
    v_mfma_f32_32x32x16_bf16 v[48:63], v[24:27], v[20:23], 0
    ds_read_b128 v[10:13], v3 offset:1024
    v_exp_f32 v38, v38
    v_exp_f32 v39, v39
    v_exp_f32 v40, v40
    v_exp_f32 v41, v41
    v_smfmac_f32_32x32x32_bf16 v[64:79], v[28:31], v[32:39], v8
    ds_read_b128 v[100:103], v3 offset:1536
    v_exp_f32 v42, v42
    v_exp_f32 v43, v43
    v_exp_f32 v44, v44
    v_exp_f32 v45, v45
    v_exp_f32 v46, v46
    v_exp_f32 v47, v47
    v_exp_f32 v48, v48
    v_exp_f32 v49, v49
    v_smfmac_f32_32x32x32_bf16 v[64:79], v[4:7], v[40:47], v8
    s_waitcnt lgkmcnt(2)
    buffer_load_dwordx4 a[28:31], v1, s[4:7], s55 offen offset:3072
    v_exp_f32 v50, v50
    v_exp_f32 v51, v51
    v_exp_f32 v52, v52
    v_exp_f32 v53, v53
    v_mfma_f32_32x32x16_bf16 v[32:47], v[96:99], v[16:19], 0
    s_add_u32 s55, s55, 4096
    buffer_load_dwordx4 a[32:35], v1, s[4:7], s55 offen offset:0
    v_exp_f32 v54, v54
    v_exp_f32 v55, v55
    v_exp_f32 v56, v56
    v_exp_f32 v57, v57
    v_smfmac_f32_32x32x32_bf16 v[80:95], v[28:31], v[48:55], v8
    s_waitcnt lgkmcnt(0)
    buffer_load_dwordx4 a[36:39], v1, s[4:7], s55 offen offset:1024
    v_exp_f32 v58, v58
    v_exp_f32 v59, v59
    v_exp_f32 v60, v60
    v_exp_f32 v61, v61
    v_exp_f32 v62, v62
    v_exp_f32 v63, v63
    v_exp_f32 v32, v32
    v_exp_f32 v33, v33
    v_smfmac_f32_32x32x32_bf16 v[80:95], v[4:7], v[56:63], v8
    ds_read_b128 v[24:27], v1 offset:38912
    v_exp_f32 v34, v34
    v_exp_f32 v35, v35
    v_exp_f32 v36, v36
    v_exp_f32 v37, v37
    v_mfma_f32_32x32x16_bf16 v[48:63], v[96:99], v[20:23], 0
    ds_read_b128 v[28:31], v3 offset:2048
    v_exp_f32 v38, v38
    v_exp_f32 v39, v39
    v_exp_f32 v40, v40
    v_exp_f32 v41, v41
    v_smfmac_f32_32x32x32_bf16 v[64:79], v[10:13], v[32:39], v8
    ds_read_b128 v[4:7], v3 offset:2560
    v_exp_f32 v42, v42
    v_exp_f32 v43, v43
    v_exp_f32 v44, v44
    v_exp_f32 v45, v45
    v_exp_f32 v46, v46
    v_exp_f32 v47, v47
    v_exp_f32 v48, v48
    v_exp_f32 v49, v49
    v_smfmac_f32_32x32x32_bf16 v[64:79], v[100:103], v[40:47], v8
    s_waitcnt lgkmcnt(2)
    buffer_load_dwordx4 a[40:43], v1, s[4:7], s55 offen offset:2048
    v_exp_f32 v50, v50
    v_exp_f32 v51, v51
    v_exp_f32 v52, v52
    v_exp_f32 v53, v53
    v_mfma_f32_32x32x16_bf16 v[32:47], v[24:27], v[16:19], 0
    buffer_load_dwordx4 a[44:47], v1, s[4:7], s55 offen offset:3072
    v_exp_f32 v54, v54
    v_exp_f32 v55, v55
    v_exp_f32 v56, v56
    v_exp_f32 v57, v57
    v_smfmac_f32_32x32x32_bf16 v[80:95], v[10:13], v[48:55], v8
    s_waitcnt lgkmcnt(0)
    s_add_u32 s55, s55, 4096
    buffer_load_dwordx4 a[48:51], v1, s[4:7], s55 offen offset:0
    v_exp_f32 v58, v58
    v_exp_f32 v59, v59
    v_exp_f32 v60, v60
    v_exp_f32 v61, v61
    v_exp_f32 v62, v62
    v_exp_f32 v63, v63
    v_exp_f32 v32, v32
    v_exp_f32 v33, v33
    v_smfmac_f32_32x32x32_bf16 v[80:95], v[100:103], v[56:63], v8
    ds_read_b128 v[96:99], v1 offset:39936
    v_exp_f32 v34, v34
    v_exp_f32 v35, v35
    v_exp_f32 v36, v36
    v_exp_f32 v37, v37
    v_mfma_f32_32x32x16_bf16 v[48:63], v[24:27], v[20:23], 0
    ds_read_b128 v[10:13], v3 offset:3072
    v_exp_f32 v38, v38
    v_exp_f32 v39, v39
    v_exp_f32 v40, v40
    v_exp_f32 v41, v41
    v_smfmac_f32_32x32x32_bf16 v[64:79], v[28:31], v[32:39], v8
    ds_read_b128 v[100:103], v3 offset:3584
    v_exp_f32 v42, v42
    v_exp_f32 v43, v43
    v_exp_f32 v44, v44
    v_exp_f32 v45, v45
    v_exp_f32 v46, v46
    v_exp_f32 v47, v47
    v_exp_f32 v48, v48
    v_exp_f32 v49, v49
    v_smfmac_f32_32x32x32_bf16 v[64:79], v[4:7], v[40:47], v8
    s_waitcnt lgkmcnt(2)
    buffer_load_dwordx4 a[52:55], v1, s[4:7], s55 offen offset:1024
    v_exp_f32 v50, v50
    v_exp_f32 v51, v51
    v_exp_f32 v52, v52
    v_exp_f32 v53, v53
    v_mfma_f32_32x32x16_bf16 v[32:47], v[96:99], v[16:19], 0
    buffer_load_dwordx4 a[56:59], v1, s[4:7], s55 offen offset:2048
    v_exp_f32 v54, v54
    v_exp_f32 v55, v55
    v_exp_f32 v56, v56
    v_exp_f32 v57, v57
    v_smfmac_f32_32x32x32_bf16 v[80:95], v[28:31], v[48:55], v8
    s_waitcnt lgkmcnt(0)
    buffer_load_dwordx4 a[60:63], v1, s[4:7], s55 offen offset:3072
    v_exp_f32 v58, v58
    v_exp_f32 v59, v59
    v_exp_f32 v60, v60
    v_exp_f32 v61, v61
    v_exp_f32 v62, v62
    v_exp_f32 v63, v63
    v_exp_f32 v32, v32
    v_exp_f32 v33, v33
    v_smfmac_f32_32x32x32_bf16 v[80:95], v[4:7], v[56:63], v8
    ds_read_b128 v[24:27], v1 offset:40960
    v_exp_f32 v34, v34
    v_exp_f32 v35, v35
    v_exp_f32 v36, v36
    v_exp_f32 v37, v37
    v_mfma_f32_32x32x16_bf16 v[48:63], v[96:99], v[20:23], 0
    v_add_u32 v3, v2, v3
    ds_read_b128 v[28:31], v3 offset:0
    v_exp_f32 v38, v38
    v_exp_f32 v39, v39
    v_exp_f32 v40, v40
    v_exp_f32 v41, v41
    v_smfmac_f32_32x32x32_bf16 v[64:79], v[10:13], v[32:39], v8
    ds_read_b128 v[4:7], v3 offset:512
    v_exp_f32 v42, v42
    v_exp_f32 v43, v43
    v_exp_f32 v44, v44
    v_exp_f32 v45, v45
    v_exp_f32 v46, v46
    v_exp_f32 v47, v47
    v_exp_f32 v48, v48
    v_exp_f32 v49, v49
    v_smfmac_f32_32x32x32_bf16 v[64:79], v[100:103], v[40:47], v8
    s_waitcnt lgkmcnt(2)
    s_add_u32 s57, s57, 1703936
    buffer_load_dwordx4 a[64:67], v1, s[4:7], s57 offen offset:0
    v_exp_f32 v50, v50
    v_exp_f32 v51, v51
    v_exp_f32 v52, v52
    v_exp_f32 v53, v53
    v_mfma_f32_32x32x16_bf16 v[32:47], v[24:27], v[16:19], 0
    buffer_load_dwordx4 a[68:71], v1, s[4:7], s57 offen offset:1024
    v_exp_f32 v54, v54
    v_exp_f32 v55, v55
    v_exp_f32 v56, v56
    v_exp_f32 v57, v57
    v_smfmac_f32_32x32x32_bf16 v[80:95], v[10:13], v[48:55], v8
    s_waitcnt lgkmcnt(0)
    buffer_load_dwordx4 a[72:75], v1, s[4:7], s57 offen offset:2048
    v_exp_f32 v58, v58
    v_exp_f32 v59, v59
    v_exp_f32 v60, v60
    v_exp_f32 v61, v61
    v_exp_f32 v62, v62
    v_exp_f32 v63, v63
    v_exp_f32 v32, v32
    v_exp_f32 v33, v33
    v_smfmac_f32_32x32x32_bf16 v[80:95], v[100:103], v[56:63], v8
    ds_read_b128 v[96:99], v1 offset:41984
    v_exp_f32 v34, v34
    v_exp_f32 v35, v35
    v_exp_f32 v36, v36
    v_exp_f32 v37, v37
    v_mfma_f32_32x32x16_bf16 v[48:63], v[24:27], v[20:23], 0
    ds_read_b128 v[10:13], v3 offset:1024
    v_exp_f32 v38, v38
    v_exp_f32 v39, v39
    v_exp_f32 v40, v40
    v_exp_f32 v41, v41
    v_smfmac_f32_32x32x32_bf16 v[64:79], v[28:31], v[32:39], v8
    ds_read_b128 v[100:103], v3 offset:1536
    v_exp_f32 v42, v42
    v_exp_f32 v43, v43
    v_exp_f32 v44, v44
    v_exp_f32 v45, v45
    v_exp_f32 v46, v46
    v_exp_f32 v47, v47
    v_exp_f32 v48, v48
    v_exp_f32 v49, v49
    v_smfmac_f32_32x32x32_bf16 v[64:79], v[4:7], v[40:47], v8
    s_waitcnt lgkmcnt(2)
    buffer_load_dwordx4 a[76:79], v1, s[4:7], s57 offen offset:3072
    v_exp_f32 v50, v50
    v_exp_f32 v51, v51
    v_exp_f32 v52, v52
    v_exp_f32 v53, v53
    v_mfma_f32_32x32x16_bf16 v[32:47], v[96:99], v[16:19], 0
    s_add_u32 s57, s57, 4096
    buffer_load_dwordx4 a[80:83], v1, s[4:7], s57 offen offset:0
    v_exp_f32 v54, v54
    v_exp_f32 v55, v55
    v_exp_f32 v56, v56
    v_exp_f32 v57, v57
    v_smfmac_f32_32x32x32_bf16 v[80:95], v[28:31], v[48:55], v8
    s_waitcnt lgkmcnt(0)
    buffer_load_dwordx4 a[84:87], v1, s[4:7], s57 offen offset:1024
    v_exp_f32 v58, v58
    v_exp_f32 v59, v59
    v_exp_f32 v60, v60
    v_exp_f32 v61, v61
    v_exp_f32 v62, v62
    v_exp_f32 v63, v63
    v_exp_f32 v32, v32
    v_exp_f32 v33, v33
    v_smfmac_f32_32x32x32_bf16 v[80:95], v[4:7], v[56:63], v8
    ds_read_b128 v[24:27], v1 offset:43008
    v_exp_f32 v34, v34
    v_exp_f32 v35, v35
    v_exp_f32 v36, v36
    v_exp_f32 v37, v37
    v_mfma_f32_32x32x16_bf16 v[48:63], v[96:99], v[20:23], 0
    ds_read_b128 v[28:31], v3 offset:2048
    v_exp_f32 v38, v38
    v_exp_f32 v39, v39
    v_exp_f32 v40, v40
    v_exp_f32 v41, v41
    v_smfmac_f32_32x32x32_bf16 v[64:79], v[10:13], v[32:39], v8
    ds_read_b128 v[4:7], v3 offset:2560
    v_exp_f32 v42, v42
    v_exp_f32 v43, v43
    v_exp_f32 v44, v44
    v_exp_f32 v45, v45
    v_exp_f32 v46, v46
    v_exp_f32 v47, v47
    v_exp_f32 v48, v48
    v_exp_f32 v49, v49
    v_smfmac_f32_32x32x32_bf16 v[64:79], v[100:103], v[40:47], v8
    s_waitcnt lgkmcnt(2)
    buffer_load_dwordx4 a[88:91], v1, s[4:7], s57 offen offset:2048
    v_exp_f32 v50, v50
    v_exp_f32 v51, v51
    v_exp_f32 v52, v52
    v_exp_f32 v53, v53
    v_mfma_f32_32x32x16_bf16 v[32:47], v[24:27], v[16:19], 0
    buffer_load_dwordx4 a[92:95], v1, s[4:7], s57 offen offset:3072
    v_exp_f32 v54, v54
    v_exp_f32 v55, v55
    v_exp_f32 v56, v56
    v_exp_f32 v57, v57
    v_smfmac_f32_32x32x32_bf16 v[80:95], v[10:13], v[48:55], v8
    s_waitcnt lgkmcnt(0)
    s_add_u32 s57, s57, 4096
    buffer_load_dwordx4 a[96:99], v1, s[4:7], s57 offen offset:0
    v_exp_f32 v58, v58
    v_exp_f32 v59, v59
    v_exp_f32 v60, v60
    v_exp_f32 v61, v61
    v_exp_f32 v62, v62
    v_exp_f32 v63, v63
    v_exp_f32 v32, v32
    v_exp_f32 v33, v33
    v_smfmac_f32_32x32x32_bf16 v[80:95], v[100:103], v[56:63], v8
    ds_read_b128 v[96:99], v1 offset:44032
    v_exp_f32 v34, v34
    v_exp_f32 v35, v35
    v_exp_f32 v36, v36
    v_exp_f32 v37, v37
    v_mfma_f32_32x32x16_bf16 v[48:63], v[24:27], v[20:23], 0
    ds_read_b128 v[10:13], v3 offset:3072
    v_exp_f32 v38, v38
    v_exp_f32 v39, v39
    v_exp_f32 v40, v40
    v_exp_f32 v41, v41
    v_smfmac_f32_32x32x32_bf16 v[64:79], v[28:31], v[32:39], v8
    ds_read_b128 v[100:103], v3 offset:3584
    v_exp_f32 v42, v42
    v_exp_f32 v43, v43
    v_exp_f32 v44, v44
    v_exp_f32 v45, v45
    v_exp_f32 v46, v46
    v_exp_f32 v47, v47
    v_exp_f32 v48, v48
    v_exp_f32 v49, v49
    v_smfmac_f32_32x32x32_bf16 v[64:79], v[4:7], v[40:47], v8
    s_waitcnt lgkmcnt(2)
    buffer_load_dwordx4 a[100:103], v1, s[4:7], s57 offen offset:1024
    v_exp_f32 v50, v50
    v_exp_f32 v51, v51
    v_exp_f32 v52, v52
    v_exp_f32 v53, v53
    v_mfma_f32_32x32x16_bf16 v[32:47], v[96:99], v[16:19], 0
    buffer_load_dwordx4 a[104:107], v1, s[4:7], s57 offen offset:2048
    v_exp_f32 v54, v54
    v_exp_f32 v55, v55
    v_exp_f32 v56, v56
    v_exp_f32 v57, v57
    v_smfmac_f32_32x32x32_bf16 v[80:95], v[28:31], v[48:55], v8
    s_waitcnt lgkmcnt(0)
    buffer_load_dwordx4 a[108:111], v1, s[4:7], s57 offen offset:3072
    v_exp_f32 v58, v58
    v_exp_f32 v59, v59
    v_exp_f32 v60, v60
    v_exp_f32 v61, v61
    v_exp_f32 v62, v62
    v_exp_f32 v63, v63
    s_add_u32 s57, s57, 4096
    buffer_load_dwordx4 a[112:115], v1, s[4:7], s57 offen offset:0
    buffer_load_dwordx4 a[116:119], v1, s[4:7], s57 offen offset:1024
    buffer_load_dwordx4 a[120:123], v1, s[4:7], s57 offen offset:2048
    buffer_load_dwordx4 a[124:127], v1, s[4:7], s57 offen offset:3072
    s_cmp_lg_u32 s11, 0
    s_cbranch_scc1 L_att_nold
    v_exp_f32 v32, v32
    v_exp_f32 v33, v33
    v_smfmac_f32_32x32x32_bf16 v[80:95], v[4:7], v[56:63], v8
    ds_read_b128 v[24:27], v1 offset:45056
    v_exp_f32 v34, v34
    v_exp_f32 v35, v35
    v_exp_f32 v36, v36
    v_exp_f32 v37, v37
    v_mfma_f32_32x32x16_bf16 v[48:63], v[96:99], v[20:23], 0
    v_add_u32 v3, v2, v3
    ds_read_b128 v[28:31], v3 offset:0
    v_exp_f32 v38, v38
    v_exp_f32 v39, v39
    v_exp_f32 v40, v40
    v_exp_f32 v41, v41
    v_smfmac_f32_32x32x32_bf16 v[64:79], v[10:13], v[32:39], v8
    ds_read_b128 v[4:7], v3 offset:512
    v_exp_f32 v42, v42
    v_exp_f32 v43, v43
    v_exp_f32 v44, v44
    v_exp_f32 v45, v45
    v_exp_f32 v46, v46
    v_exp_f32 v47, v47
    v_exp_f32 v48, v48
    v_exp_f32 v49, v49
    v_smfmac_f32_32x32x32_bf16 v[64:79], v[100:103], v[40:47], v8
    s_waitcnt lgkmcnt(2)
    s_mul_i32 s57, s53, 88064
    s_mul_i32 s56, s54, 44032
    s_add_u32 s57, s57, s56
    s_add_u32 s57, s57, 3801088
    buffer_load_dwordx4 v[104:107], v1, s[4:7], s57 offen offset:0
    v_exp_f32 v50, v50
    v_exp_f32 v51, v51
    v_exp_f32 v52, v52
    v_exp_f32 v53, v53
    v_mfma_f32_32x32x16_bf16 v[32:47], v[24:27], v[16:19], 0
    buffer_load_dwordx4 v[108:111], v1, s[4:7], s57 offen offset:1024
    v_exp_f32 v54, v54
    v_exp_f32 v55, v55
    v_exp_f32 v56, v56
    v_exp_f32 v57, v57
    v_smfmac_f32_32x32x32_bf16 v[80:95], v[10:13], v[48:55], v8
    s_waitcnt lgkmcnt(0)
    buffer_load_dwordx4 v[112:115], v1, s[4:7], s57 offen offset:2048
    v_exp_f32 v58, v58
    v_exp_f32 v59, v59
    v_exp_f32 v60, v60
    v_exp_f32 v61, v61
    v_exp_f32 v62, v62
    v_exp_f32 v63, v63
    v_exp_f32 v32, v32
    v_exp_f32 v33, v33
    v_smfmac_f32_32x32x32_bf16 v[80:95], v[100:103], v[56:63], v8
    ds_read_b128 v[96:99], v1 offset:46080
    v_exp_f32 v34, v34
    v_exp_f32 v35, v35
    v_exp_f32 v36, v36
    v_exp_f32 v37, v37
    v_mfma_f32_32x32x16_bf16 v[48:63], v[24:27], v[20:23], 0
    ds_read_b128 v[10:13], v3 offset:1024
    v_exp_f32 v38, v38
    v_exp_f32 v39, v39
    v_exp_f32 v40, v40
    v_exp_f32 v41, v41
    v_smfmac_f32_32x32x32_bf16 v[64:79], v[28:31], v[32:39], v8
    ds_read_b128 v[100:103], v3 offset:1536
    v_exp_f32 v42, v42
    v_exp_f32 v43, v43
    v_exp_f32 v44, v44
    v_exp_f32 v45, v45
    v_exp_f32 v46, v46
    v_exp_f32 v47, v47
    v_exp_f32 v48, v48
    v_exp_f32 v49, v49
    v_smfmac_f32_32x32x32_bf16 v[64:79], v[4:7], v[40:47], v8
    s_waitcnt lgkmcnt(2)
    buffer_load_dwordx4 v[116:119], v1, s[4:7], s57 offen offset:3072
    v_exp_f32 v50, v50
    v_exp_f32 v51, v51
    v_exp_f32 v52, v52
    v_exp_f32 v53, v53
    v_mfma_f32_32x32x16_bf16 v[32:47], v[96:99], v[16:19], 0
    s_add_u32 s57, s57, 4096
    buffer_load_dwordx4 v[120:123], v1, s[4:7], s57 offen offset:0
    v_exp_f32 v54, v54
    v_exp_f32 v55, v55
    v_exp_f32 v56, v56
    v_exp_f32 v57, v57
    v_smfmac_f32_32x32x32_bf16 v[80:95], v[28:31], v[48:55], v8
    s_waitcnt lgkmcnt(0)
    buffer_load_dwordx4 v[124:127], v1, s[4:7], s57 offen offset:1024
    v_exp_f32 v58, v58
    v_exp_f32 v59, v59
    v_exp_f32 v60, v60
    v_exp_f32 v61, v61
    v_exp_f32 v62, v62
    v_exp_f32 v63, v63
    v_exp_f32 v32, v32
    v_exp_f32 v33, v33
    v_smfmac_f32_32x32x32_bf16 v[80:95], v[4:7], v[56:63], v8
    ds_read_b128 v[24:27], v1 offset:47104
    v_exp_f32 v34, v34
    v_exp_f32 v35, v35
    v_exp_f32 v36, v36
    v_exp_f32 v37, v37
    v_mfma_f32_32x32x16_bf16 v[48:63], v[96:99], v[20:23], 0
    ds_read_b128 v[28:31], v3 offset:2048
    v_exp_f32 v38, v38
    v_exp_f32 v39, v39
    v_exp_f32 v40, v40
    v_exp_f32 v41, v41
    v_smfmac_f32_32x32x32_bf16 v[64:79], v[10:13], v[32:39], v8
    ds_read_b128 v[4:7], v3 offset:2560
    v_exp_f32 v42, v42
    v_exp_f32 v43, v43
    v_exp_f32 v44, v44
    v_exp_f32 v45, v45
    v_exp_f32 v46, v46
    v_exp_f32 v47, v47
    v_exp_f32 v48, v48
    v_exp_f32 v49, v49
    v_smfmac_f32_32x32x32_bf16 v[64:79], v[100:103], v[40:47], v8
    s_waitcnt lgkmcnt(2)
    buffer_load_dwordx4 v[128:131], v1, s[4:7], s57 offen offset:2048
    v_exp_f32 v50, v50
    v_exp_f32 v51, v51
    v_exp_f32 v52, v52
    v_exp_f32 v53, v53
    v_mfma_f32_32x32x16_bf16 v[32:47], v[24:27], v[16:19], 0
    buffer_load_dwordx4 v[132:135], v1, s[4:7], s57 offen offset:3072
    v_exp_f32 v54, v54
    v_exp_f32 v55, v55
    v_exp_f32 v56, v56
    v_exp_f32 v57, v57
    v_smfmac_f32_32x32x32_bf16 v[80:95], v[10:13], v[48:55], v8
    s_waitcnt lgkmcnt(0)
    s_add_u32 s57, s57, 4096
    buffer_load_dwordx4 v[136:139], v1, s[4:7], s57 offen offset:0
    v_exp_f32 v58, v58
    v_exp_f32 v59, v59
    v_exp_f32 v60, v60
    v_exp_f32 v61, v61
    v_exp_f32 v62, v62
    v_exp_f32 v63, v63
    v_exp_f32 v32, v32
    v_exp_f32 v33, v33
    v_smfmac_f32_32x32x32_bf16 v[80:95], v[100:103], v[56:63], v8
    ds_read_b128 v[96:99], v1 offset:48128
    v_exp_f32 v34, v34
    v_exp_f32 v35, v35
    v_exp_f32 v36, v36
    v_exp_f32 v37, v37
    v_mfma_f32_32x32x16_bf16 v[48:63], v[24:27], v[20:23], 0
    ds_read_b128 v[10:13], v3 offset:3072
    v_exp_f32 v38, v38
    v_exp_f32 v39, v39
    v_exp_f32 v40, v40
    v_exp_f32 v41, v41
    v_smfmac_f32_32x32x32_bf16 v[64:79], v[28:31], v[32:39], v8
    ds_read_b128 v[100:103], v3 offset:3584
    v_exp_f32 v42, v42
    v_exp_f32 v43, v43
    v_exp_f32 v44, v44
    v_exp_f32 v45, v45
    v_exp_f32 v46, v46
    v_exp_f32 v47, v47
    v_exp_f32 v48, v48
    v_exp_f32 v49, v49
    v_smfmac_f32_32x32x32_bf16 v[64:79], v[4:7], v[40:47], v8
    s_waitcnt lgkmcnt(2)
    buffer_load_dwordx4 v[140:143], v1, s[4:7], s57 offen offset:1024
    v_exp_f32 v50, v50
    v_exp_f32 v51, v51
    v_exp_f32 v52, v52
    v_exp_f32 v53, v53
    v_mfma_f32_32x32x16_bf16 v[32:47], v[96:99], v[16:19], 0
    buffer_load_dwordx4 v[144:147], v1, s[4:7], s57 offen offset:2048
    v_exp_f32 v54, v54
    v_exp_f32 v55, v55
    v_exp_f32 v56, v56
    v_exp_f32 v57, v57
    v_smfmac_f32_32x32x32_bf16 v[80:95], v[28:31], v[48:55], v8
    s_waitcnt lgkmcnt(0)
    buffer_load_dwordx4 v[148:151], v1, s[4:7], s57 offen offset:3072
    v_exp_f32 v58, v58
    v_exp_f32 v59, v59
    v_exp_f32 v60, v60
    v_exp_f32 v61, v61
    v_exp_f32 v62, v62
    v_exp_f32 v63, v63
    v_exp_f32 v32, v32
    v_exp_f32 v33, v33
    v_smfmac_f32_32x32x32_bf16 v[80:95], v[4:7], v[56:63], v8
    ds_read_b128 v[24:27], v1 offset:49152
    v_exp_f32 v34, v34
    v_exp_f32 v35, v35
    v_exp_f32 v36, v36
    v_exp_f32 v37, v37
    v_mfma_f32_32x32x16_bf16 v[48:63], v[96:99], v[20:23], 0
    v_add_u32 v3, v2, v3
    ds_read_b128 v[28:31], v3 offset:0
    v_exp_f32 v38, v38
    v_exp_f32 v39, v39
    v_exp_f32 v40, v40
    v_exp_f32 v41, v41
    v_smfmac_f32_32x32x32_bf16 v[64:79], v[10:13], v[32:39], v8
    ds_read_b128 v[4:7], v3 offset:512
    v_exp_f32 v42, v42
    v_exp_f32 v43, v43
    v_exp_f32 v44, v44
    v_exp_f32 v45, v45
    v_exp_f32 v46, v46
    v_exp_f32 v47, v47
    v_exp_f32 v48, v48
    v_exp_f32 v49, v49
    v_smfmac_f32_32x32x32_bf16 v[64:79], v[100:103], v[40:47], v8
    s_waitcnt lgkmcnt(2)
    s_add_u32 s57, s57, 4096
    buffer_load_dwordx4 v[152:155], v1, s[4:7], s57 offen offset:0
    v_exp_f32 v50, v50
    v_exp_f32 v51, v51
    v_exp_f32 v52, v52
    v_exp_f32 v53, v53
    v_mfma_f32_32x32x16_bf16 v[32:47], v[24:27], v[16:19], 0
    buffer_load_dwordx4 v[156:159], v1, s[4:7], s57 offen offset:1024
    v_exp_f32 v54, v54
    v_exp_f32 v55, v55
    v_exp_f32 v56, v56
    v_exp_f32 v57, v57
    v_smfmac_f32_32x32x32_bf16 v[80:95], v[10:13], v[48:55], v8
    s_waitcnt lgkmcnt(0)
    buffer_load_dwordx4 v[160:163], v1, s[4:7], s57 offen offset:2048
    v_exp_f32 v58, v58
    v_exp_f32 v59, v59
    v_exp_f32 v60, v60
    v_exp_f32 v61, v61
    v_exp_f32 v62, v62
    v_exp_f32 v63, v63
    v_exp_f32 v32, v32
    v_exp_f32 v33, v33
    v_smfmac_f32_32x32x32_bf16 v[80:95], v[100:103], v[56:63], v8
    ds_read_b128 v[96:99], v1 offset:50176
    v_exp_f32 v34, v34
    v_exp_f32 v35, v35
    v_exp_f32 v36, v36
    v_exp_f32 v37, v37
    v_mfma_f32_32x32x16_bf16 v[48:63], v[24:27], v[20:23], 0
    ds_read_b128 v[10:13], v3 offset:1024
    v_exp_f32 v38, v38
    v_exp_f32 v39, v39
    v_exp_f32 v40, v40
    v_exp_f32 v41, v41
    v_smfmac_f32_32x32x32_bf16 v[64:79], v[28:31], v[32:39], v8
    ds_read_b128 v[100:103], v3 offset:1536
    v_exp_f32 v42, v42
    v_exp_f32 v43, v43
    v_exp_f32 v44, v44
    v_exp_f32 v45, v45
    v_exp_f32 v46, v46
    v_exp_f32 v47, v47
    v_exp_f32 v48, v48
    v_exp_f32 v49, v49
    v_smfmac_f32_32x32x32_bf16 v[64:79], v[4:7], v[40:47], v8
    s_waitcnt lgkmcnt(2)
    buffer_load_dwordx4 v[164:167], v1, s[4:7], s57 offen offset:3072
    v_exp_f32 v50, v50
    v_exp_f32 v51, v51
    v_exp_f32 v52, v52
    v_exp_f32 v53, v53
    v_mfma_f32_32x32x16_bf16 v[32:47], v[96:99], v[16:19], 0
    s_add_u32 s57, s57, 4096
    buffer_load_dwordx4 v[168:171], v1, s[4:7], s57 offen offset:0
    v_exp_f32 v54, v54
    v_exp_f32 v55, v55
    v_exp_f32 v56, v56
    v_exp_f32 v57, v57
    v_smfmac_f32_32x32x32_bf16 v[80:95], v[28:31], v[48:55], v8
    s_waitcnt lgkmcnt(0)
    buffer_load_dwordx4 v[172:175], v1, s[4:7], s57 offen offset:1024
    v_exp_f32 v58, v58
    v_exp_f32 v59, v59
    v_exp_f32 v60, v60
    v_exp_f32 v61, v61
    v_exp_f32 v62, v62
    v_exp_f32 v63, v63
    v_exp_f32 v32, v32
    v_exp_f32 v33, v33
    v_smfmac_f32_32x32x32_bf16 v[80:95], v[4:7], v[56:63], v8
    ds_read_b128 v[24:27], v1 offset:51200
    v_exp_f32 v34, v34
    v_exp_f32 v35, v35
    v_exp_f32 v36, v36
    v_exp_f32 v37, v37
    v_mfma_f32_32x32x16_bf16 v[48:63], v[96:99], v[20:23], 0
    ds_read_b128 v[28:31], v3 offset:2048
    v_exp_f32 v38, v38
    v_exp_f32 v39, v39
    v_exp_f32 v40, v40
    v_exp_f32 v41, v41
    v_smfmac_f32_32x32x32_bf16 v[64:79], v[10:13], v[32:39], v8
    ds_read_b128 v[4:7], v3 offset:2560
    v_exp_f32 v42, v42
    v_exp_f32 v43, v43
    v_exp_f32 v44, v44
    v_exp_f32 v45, v45
    v_exp_f32 v46, v46
    v_exp_f32 v47, v47
    v_exp_f32 v48, v48
    v_exp_f32 v49, v49
    v_smfmac_f32_32x32x32_bf16 v[64:79], v[100:103], v[40:47], v8
    s_waitcnt lgkmcnt(2)
    buffer_load_dwordx4 v[176:179], v1, s[4:7], s57 offen offset:2048
    v_exp_f32 v50, v50
    v_exp_f32 v51, v51
    v_exp_f32 v52, v52
    v_exp_f32 v53, v53
    v_mfma_f32_32x32x16_bf16 v[32:47], v[24:27], v[16:19], 0
    buffer_load_dwordx4 v[180:183], v1, s[4:7], s57 offen offset:3072
    v_exp_f32 v54, v54
    v_exp_f32 v55, v55
    v_exp_f32 v56, v56
    v_exp_f32 v57, v57
    v_smfmac_f32_32x32x32_bf16 v[80:95], v[10:13], v[48:55], v8
    s_waitcnt lgkmcnt(0)
    s_add_u32 s57, s57, 4096
    buffer_load_dwordx4 v[184:187], v1, s[4:7], s57 offen offset:0
    v_exp_f32 v58, v58
    v_exp_f32 v59, v59
    v_exp_f32 v60, v60
    v_exp_f32 v61, v61
    v_exp_f32 v62, v62
    v_exp_f32 v63, v63
    v_exp_f32 v32, v32
    v_exp_f32 v33, v33
    v_smfmac_f32_32x32x32_bf16 v[80:95], v[100:103], v[56:63], v8
    ds_read_b128 v[96:99], v1 offset:52224
    v_exp_f32 v34, v34
    v_exp_f32 v35, v35
    v_exp_f32 v36, v36
    v_exp_f32 v37, v37
    v_mfma_f32_32x32x16_bf16 v[48:63], v[24:27], v[20:23], 0
    ds_read_b128 v[10:13], v3 offset:3072
    v_exp_f32 v38, v38
    v_exp_f32 v39, v39
    v_exp_f32 v40, v40
    v_exp_f32 v41, v41
    v_smfmac_f32_32x32x32_bf16 v[64:79], v[28:31], v[32:39], v8
    ds_read_b128 v[100:103], v3 offset:3584
    v_exp_f32 v42, v42
    v_exp_f32 v43, v43
    v_exp_f32 v44, v44
    v_exp_f32 v45, v45
    v_exp_f32 v46, v46
    v_exp_f32 v47, v47
    v_exp_f32 v48, v48
    v_exp_f32 v49, v49
    v_smfmac_f32_32x32x32_bf16 v[64:79], v[4:7], v[40:47], v8
    s_waitcnt lgkmcnt(2)
    buffer_load_dwordx4 v[188:191], v1, s[4:7], s57 offen offset:1024
    v_exp_f32 v50, v50
    v_exp_f32 v51, v51
    v_exp_f32 v52, v52
    v_exp_f32 v53, v53
    v_mfma_f32_32x32x16_bf16 v[32:47], v[96:99], v[16:19], 0
    buffer_load_dwordx4 v[192:195], v1, s[4:7], s57 offen offset:2048
    v_exp_f32 v54, v54
    v_exp_f32 v55, v55
    v_exp_f32 v56, v56
    v_exp_f32 v57, v57
    v_smfmac_f32_32x32x32_bf16 v[80:95], v[28:31], v[48:55], v8
    s_waitcnt lgkmcnt(0)
    buffer_load_dwordx4 v[196:199], v1, s[4:7], s57 offen offset:3072
    v_exp_f32 v58, v58
    v_exp_f32 v59, v59
    v_exp_f32 v60, v60
    v_exp_f32 v61, v61
    v_exp_f32 v62, v62
    v_exp_f32 v63, v63
    v_exp_f32 v32, v32
    v_exp_f32 v33, v33
    v_smfmac_f32_32x32x32_bf16 v[80:95], v[4:7], v[56:63], v8
    ds_read_b128 v[24:27], v1 offset:53248
    v_exp_f32 v34, v34
    v_exp_f32 v35, v35
    v_exp_f32 v36, v36
    v_exp_f32 v37, v37
    v_mfma_f32_32x32x16_bf16 v[48:63], v[96:99], v[20:23], 0
    v_add_u32 v3, v2, v3
    ds_read_b128 v[28:31], v3 offset:0
    v_exp_f32 v38, v38
    v_exp_f32 v39, v39
    v_exp_f32 v40, v40
    v_exp_f32 v41, v41
    v_smfmac_f32_32x32x32_bf16 v[64:79], v[10:13], v[32:39], v8
    ds_read_b128 v[4:7], v3 offset:512
    v_exp_f32 v42, v42
    v_exp_f32 v43, v43
    v_exp_f32 v44, v44
    v_exp_f32 v45, v45
    v_exp_f32 v46, v46
    v_exp_f32 v47, v47
    v_exp_f32 v48, v48
    v_exp_f32 v49, v49
    v_smfmac_f32_32x32x32_bf16 v[64:79], v[100:103], v[40:47], v8
    s_waitcnt lgkmcnt(2)
    s_add_u32 s57, s57, 4096
    buffer_load_dwordx4 v[200:203], v1, s[4:7], s57 offen offset:0
    v_exp_f32 v50, v50
    v_exp_f32 v51, v51
    v_exp_f32 v52, v52
    v_exp_f32 v53, v53
    v_mfma_f32_32x32x16_bf16 v[32:47], v[24:27], v[16:19], 0
    buffer_load_dwordx4 v[204:207], v1, s[4:7], s57 offen offset:1024
    v_exp_f32 v54, v54
    v_exp_f32 v55, v55
    v_exp_f32 v56, v56
    v_exp_f32 v57, v57
    v_smfmac_f32_32x32x32_bf16 v[80:95], v[10:13], v[48:55], v8
    s_waitcnt lgkmcnt(0)
    buffer_load_dwordx4 v[208:211], v1, s[4:7], s57 offen offset:2048
    v_exp_f32 v58, v58
    v_exp_f32 v59, v59
    v_exp_f32 v60, v60
    v_exp_f32 v61, v61
    v_exp_f32 v62, v62
    v_exp_f32 v63, v63
    v_exp_f32 v32, v32
    v_exp_f32 v33, v33
    v_smfmac_f32_32x32x32_bf16 v[80:95], v[100:103], v[56:63], v8
    ds_read_b128 v[96:99], v1 offset:54272
    v_exp_f32 v34, v34
    v_exp_f32 v35, v35
    v_exp_f32 v36, v36
    v_exp_f32 v37, v37
    v_mfma_f32_32x32x16_bf16 v[48:63], v[24:27], v[20:23], 0
    ds_read_b128 v[10:13], v3 offset:1024
    v_exp_f32 v38, v38
    v_exp_f32 v39, v39
    v_exp_f32 v40, v40
    v_exp_f32 v41, v41
    v_smfmac_f32_32x32x32_bf16 v[64:79], v[28:31], v[32:39], v8
    ds_read_b128 v[100:103], v3 offset:1536
    v_exp_f32 v42, v42
    v_exp_f32 v43, v43
    v_exp_f32 v44, v44
    v_exp_f32 v45, v45
    v_exp_f32 v46, v46
    v_exp_f32 v47, v47
    v_exp_f32 v48, v48
    v_exp_f32 v49, v49
    v_smfmac_f32_32x32x32_bf16 v[64:79], v[4:7], v[40:47], v8
    s_waitcnt lgkmcnt(2)
    buffer_load_dwordx4 v[212:215], v1, s[4:7], s57 offen offset:3072
    v_exp_f32 v50, v50
    v_exp_f32 v51, v51
    v_exp_f32 v52, v52
    v_exp_f32 v53, v53
    v_mfma_f32_32x32x16_bf16 v[32:47], v[96:99], v[16:19], 0
    s_add_u32 s57, s57, 4096
    buffer_load_dwordx4 v[216:219], v1, s[4:7], s57 offen offset:0
    v_exp_f32 v54, v54
    v_exp_f32 v55, v55
    v_exp_f32 v56, v56
    v_exp_f32 v57, v57
    v_smfmac_f32_32x32x32_bf16 v[80:95], v[28:31], v[48:55], v8
    s_waitcnt lgkmcnt(0)
    buffer_load_dwordx4 v[220:223], v1, s[4:7], s57 offen offset:1024
    v_exp_f32 v58, v58
    v_exp_f32 v59, v59
    v_exp_f32 v60, v60
    v_exp_f32 v61, v61
    v_exp_f32 v62, v62
    v_exp_f32 v63, v63
    v_exp_f32 v32, v32
    v_exp_f32 v33, v33
    v_smfmac_f32_32x32x32_bf16 v[80:95], v[4:7], v[56:63], v8
    ds_read_b128 v[24:27], v1 offset:55296
    v_exp_f32 v34, v34
    v_exp_f32 v35, v35
    v_exp_f32 v36, v36
    v_exp_f32 v37, v37
    v_mfma_f32_32x32x16_bf16 v[48:63], v[96:99], v[20:23], 0
    ds_read_b128 v[28:31], v3 offset:2048
    v_exp_f32 v38, v38
    v_exp_f32 v39, v39
    v_exp_f32 v40, v40
    v_exp_f32 v41, v41
    v_smfmac_f32_32x32x32_bf16 v[64:79], v[10:13], v[32:39], v8
    ds_read_b128 v[4:7], v3 offset:2560
    v_exp_f32 v42, v42
    v_exp_f32 v43, v43
    v_exp_f32 v44, v44
    v_exp_f32 v45, v45
    v_exp_f32 v46, v46
    v_exp_f32 v47, v47
    v_exp_f32 v48, v48
    v_exp_f32 v49, v49
    v_smfmac_f32_32x32x32_bf16 v[64:79], v[100:103], v[40:47], v8
    s_waitcnt lgkmcnt(2)
    buffer_load_dwordx4 v[224:227], v1, s[4:7], s57 offen offset:2048
    v_exp_f32 v50, v50
    v_exp_f32 v51, v51
    v_exp_f32 v52, v52
    v_exp_f32 v53, v53
    v_mfma_f32_32x32x16_bf16 v[32:47], v[24:27], v[16:19], 0
    buffer_load_dwordx4 v[228:231], v1, s[4:7], s57 offen offset:3072
    v_exp_f32 v54, v54
    v_exp_f32 v55, v55
    v_exp_f32 v56, v56
    v_exp_f32 v57, v57
    v_smfmac_f32_32x32x32_bf16 v[80:95], v[10:13], v[48:55], v8
    s_waitcnt lgkmcnt(0)
    s_add_u32 s57, s57, 4096
    buffer_load_dwordx4 v[232:235], v1, s[4:7], s57 offen offset:0
    v_exp_f32 v58, v58
    v_exp_f32 v59, v59
    v_exp_f32 v60, v60
    v_exp_f32 v61, v61
    v_exp_f32 v62, v62
    v_exp_f32 v63, v63
    v_exp_f32 v32, v32
    v_exp_f32 v33, v33
    v_smfmac_f32_32x32x32_bf16 v[80:95], v[100:103], v[56:63], v8
    ds_read_b128 v[96:99], v1 offset:56320
    v_exp_f32 v34, v34
    v_exp_f32 v35, v35
    v_exp_f32 v36, v36
    v_exp_f32 v37, v37
    v_mfma_f32_32x32x16_bf16 v[48:63], v[24:27], v[20:23], 0
    ds_read_b128 v[10:13], v3 offset:3072
    v_exp_f32 v38, v38
    v_exp_f32 v39, v39
    v_exp_f32 v40, v40
    v_exp_f32 v41, v41
    v_smfmac_f32_32x32x32_bf16 v[64:79], v[28:31], v[32:39], v8
    ds_read_b128 v[100:103], v3 offset:3584
    v_exp_f32 v42, v42
    v_exp_f32 v43, v43
    v_exp_f32 v44, v44
    v_exp_f32 v45, v45
    v_exp_f32 v46, v46
    v_exp_f32 v47, v47
    v_exp_f32 v48, v48
    v_exp_f32 v49, v49
    v_smfmac_f32_32x32x32_bf16 v[64:79], v[4:7], v[40:47], v8
    s_waitcnt lgkmcnt(2)
    buffer_load_dwordx4 v[236:239], v1, s[4:7], s57 offen offset:1024
    v_exp_f32 v50, v50
    v_exp_f32 v51, v51
    v_exp_f32 v52, v52
    v_exp_f32 v53, v53
    v_mfma_f32_32x32x16_bf16 v[32:47], v[96:99], v[16:19], 0
    buffer_load_dwordx4 v[240:243], v1, s[4:7], s57 offen offset:2048
    v_exp_f32 v54, v54
    v_exp_f32 v55, v55
    v_exp_f32 v56, v56
    v_exp_f32 v57, v57
    v_smfmac_f32_32x32x32_bf16 v[80:95], v[28:31], v[48:55], v8
    s_waitcnt lgkmcnt(0)
    buffer_load_dwordx4 v[244:247], v1, s[4:7], s57 offen offset:3072
    v_exp_f32 v58, v58
    v_exp_f32 v59, v59
    v_exp_f32 v60, v60
    v_exp_f32 v61, v61
    v_exp_f32 v62, v62
    v_exp_f32 v63, v63
    v_exp_f32 v32, v32
    v_exp_f32 v33, v33
    v_smfmac_f32_32x32x32_bf16 v[80:95], v[4:7], v[56:63], v8
    ds_read_b128 v[24:27], v1 offset:57344
    v_exp_f32 v34, v34
    v_exp_f32 v35, v35
    v_exp_f32 v36, v36
    v_exp_f32 v37, v37
    v_mfma_f32_32x32x16_bf16 v[48:63], v[96:99], v[20:23], 0
    v_add_u32 v3, v2, v3
    ds_read_b128 v[28:31], v3 offset:0
    v_exp_f32 v38, v38
    v_exp_f32 v39, v39
    v_exp_f32 v40, v40
    v_exp_f32 v41, v41
    v_smfmac_f32_32x32x32_bf16 v[64:79], v[10:13], v[32:39], v8
    ds_read_b128 v[4:7], v3 offset:512
    v_exp_f32 v42, v42
    v_exp_f32 v43, v43
    v_exp_f32 v44, v44
    v_exp_f32 v45, v45
    v_exp_f32 v46, v46
    v_exp_f32 v47, v47
    v_exp_f32 v48, v48
    v_exp_f32 v49, v49
    v_smfmac_f32_32x32x32_bf16 v[64:79], v[100:103], v[40:47], v8
    s_waitcnt lgkmcnt(2)
    s_add_u32 s57, s57, 4096
    buffer_load_dwordx4 v[248:251], v1, s[4:7], s57 offen offset:0
    v_exp_f32 v50, v50
    v_exp_f32 v51, v51
    v_exp_f32 v52, v52
    v_exp_f32 v53, v53
    v_mfma_f32_32x32x16_bf16 v[32:47], v[24:27], v[16:19], 0
    s_and_b32 s56, s9, 3
    s_mul_i32 s56, s56, 12288
    s_mul_i32 s55, s52, 49152
    s_add_u32 s55, s55, s56
    s_add_u32 s55, s55, 131072
    buffer_load_dword v255, v9, s[4:7], s55 offen
    v_exp_f32 v54, v54
    v_exp_f32 v55, v55
    v_exp_f32 v56, v56
    v_exp_f32 v57, v57
    v_smfmac_f32_32x32x32_bf16 v[80:95], v[10:13], v[48:55], v8
    s_waitcnt lgkmcnt(0)
    s_add_u32 s55, s55, 4096
    buffer_load_dword v255, v9, s[4:7], s55 offen
    v_exp_f32 v58, v58
    v_exp_f32 v59, v59
    v_exp_f32 v60, v60
    v_exp_f32 v61, v61
    v_exp_f32 v62, v62
    v_exp_f32 v63, v63
    v_exp_f32 v32, v32
    v_exp_f32 v33, v33
    v_smfmac_f32_32x32x32_bf16 v[80:95], v[100:103], v[56:63], v8
    ds_read_b128 v[96:99], v1 offset:58368
    v_exp_f32 v34, v34
    v_exp_f32 v35, v35
    v_exp_f32 v36, v36
    v_exp_f32 v37, v37
    v_mfma_f32_32x32x16_bf16 v[48:63], v[24:27], v[20:23], 0
    ds_read_b128 v[10:13], v3 offset:1024
    v_exp_f32 v38, v38
    v_exp_f32 v39, v39
    v_exp_f32 v40, v40
    v_exp_f32 v41, v41
    v_smfmac_f32_32x32x32_bf16 v[64:79], v[28:31], v[32:39], v8
    ds_read_b128 v[100:103], v3 offset:1536
    v_exp_f32 v42, v42
    v_exp_f32 v43, v43
    v_exp_f32 v44, v44
    v_exp_f32 v45, v45
    v_exp_f32 v46, v46
    v_exp_f32 v47, v47
    v_exp_f32 v48, v48
    v_exp_f32 v49, v49
    v_smfmac_f32_32x32x32_bf16 v[64:79], v[4:7], v[40:47], v8
    s_waitcnt lgkmcnt(2)
    s_add_u32 s55, s55, 4096
    buffer_load_dword v255, v9, s[4:7], s55 offen
    v_exp_f32 v50, v50
    v_exp_f32 v51, v51
    v_exp_f32 v52, v52
    v_exp_f32 v53, v53
    v_mfma_f32_32x32x16_bf16 v[32:47], v[96:99], v[16:19], 0
    s_getpc_b64 s[16:17]
L_pc2:
    s_mov_b32 s18, L_codeend-L_pc2
    s_mov_b32 s19, 0x20000
    s_and_b32 s55, s52, 7
    s_lshl_b32 s55, s55, 12
    buffer_load_dword v255, v9, s[16:19], s55 offen
    v_exp_f32 v54, v54
    v_exp_f32 v55, v55
    v_exp_f32 v56, v56
    v_exp_f32 v57, v57
    v_smfmac_f32_32x32x32_bf16 v[80:95], v[28:31], v[48:55], v8
    s_waitcnt lgkmcnt(0)
    v_exp_f32 v58, v58
    v_exp_f32 v59, v59
    v_exp_f32 v60, v60
    v_exp_f32 v61, v61
    v_exp_f32 v62, v62
    v_exp_f32 v63, v63
L_att_join:
    v_exp_f32 v32, v32
    v_exp_f32 v33, v33
    v_smfmac_f32_32x32x32_bf16 v[80:95], v[4:7], v[56:63], v8
    ds_read_b128 v[24:27], v1 offset:59392
    v_exp_f32 v34, v34
    v_exp_f32 v35, v35
    v_exp_f32 v36, v36
    v_exp_f32 v37, v37
    v_mfma_f32_32x32x16_bf16 v[48:63], v[96:99], v[20:23], 0
    ds_read_b128 v[28:31], v3 offset:2048
    v_exp_f32 v38, v38
    v_exp_f32 v39, v39
    v_exp_f32 v40, v40
    v_exp_f32 v41, v41
    v_smfmac_f32_32x32x32_bf16 v[64:79], v[10:13], v[32:39], v8
    ds_read_b128 v[4:7], v3 offset:2560
    v_exp_f32 v42, v42
    v_exp_f32 v43, v43
    v_exp_f32 v44, v44
    v_exp_f32 v45, v45
    v_exp_f32 v46, v46
    v_exp_f32 v47, v47
    v_exp_f32 v48, v48
    v_exp_f32 v49, v49
    v_smfmac_f32_32x32x32_bf16 v[64:79], v[100:103], v[40:47], v8
    s_waitcnt lgkmcnt(2)
    v_exp_f32 v50, v50
    v_exp_f32 v51, v51
    v_exp_f32 v52, v52
    v_exp_f32 v53, v53
    v_mfma_f32_32x32x16_bf16 v[32:47], v[24:27], v[16:19], 0
    v_exp_f32 v54, v54
    v_exp_f32 v55, v55
    v_exp_f32 v56, v56
    v_exp_f32 v57, v57
    v_smfmac_f32_32x32x32_bf16 v[80:95], v[10:13], v[48:55], v8
    s_waitcnt lgkmcnt(0)
    v_exp_f32 v58, v58
    v_exp_f32 v59, v59
    v_exp_f32 v60, v60
    v_exp_f32 v61, v61
    v_exp_f32 v62, v62
    v_exp_f32 v63, v63
    v_exp_f32 v32, v32
    v_exp_f32 v33, v33
    v_smfmac_f32_32x32x32_bf16 v[80:95], v[100:103], v[56:63], v8
    ds_read_b128 v[96:99], v1 offset:60416
    v_exp_f32 v34, v34
    v_exp_f32 v35, v35
    v_exp_f32 v36, v36
    v_exp_f32 v37, v37
    v_mfma_f32_32x32x16_bf16 v[48:63], v[24:27], v[20:23], 0
    ds_read_b128 v[10:13], v3 offset:3072
    v_exp_f32 v38, v38
    v_exp_f32 v39, v39
    v_exp_f32 v40, v40
    v_exp_f32 v41, v41
    v_smfmac_f32_32x32x32_bf16 v[64:79], v[28:31], v[32:39], v8
    ds_read_b128 v[100:103], v3 offset:3584
    v_exp_f32 v42, v42
    v_exp_f32 v43, v43
    v_exp_f32 v44, v44
    v_exp_f32 v45, v45
    v_exp_f32 v46, v46
    v_exp_f32 v47, v47
    v_exp_f32 v48, v48
    v_exp_f32 v49, v49
    v_smfmac_f32_32x32x32_bf16 v[64:79], v[4:7], v[40:47], v8
    s_waitcnt lgkmcnt(2)
    v_exp_f32 v50, v50
    v_exp_f32 v51, v51
    v_exp_f32 v52, v52
    v_exp_f32 v53, v53
    v_mfma_f32_32x32x16_bf16 v[32:47], v[96:99], v[16:19], 0
    v_exp_f32 v54, v54
    v_exp_f32 v55, v55
    v_exp_f32 v56, v56
    v_exp_f32 v57, v57
    v_smfmac_f32_32x32x32_bf16 v[80:95], v[28:31], v[48:55], v8
    s_waitcnt lgkmcnt(0)
    v_exp_f32 v58, v58
    v_exp_f32 v59, v59
    v_exp_f32 v60, v60
    v_exp_f32 v61, v61
    v_exp_f32 v62, v62
    v_exp_f32 v63, v63
    v_exp_f32 v32, v32
    v_exp_f32 v33, v33
    v_smfmac_f32_32x32x32_bf16 v[80:95], v[4:7], v[56:63], v8
    ds_read_b128 v[24:27], v1 offset:61440
    v_exp_f32 v34, v34
    v_exp_f32 v35, v35
    v_exp_f32 v36, v36
    v_exp_f32 v37, v37
    v_mfma_f32_32x32x16_bf16 v[48:63], v[96:99], v[20:23], 0
    v_add_u32 v3, v2, v3
    ds_read_b128 v[28:31], v3 offset:0
    v_exp_f32 v38, v38
    v_exp_f32 v39, v39
    v_exp_f32 v40, v40
    v_exp_f32 v41, v41
    v_smfmac_f32_32x32x32_bf16 v[64:79], v[10:13], v[32:39], v8
    ds_read_b128 v[4:7], v3 offset:512
    v_exp_f32 v42, v42
    v_exp_f32 v43, v43
    v_exp_f32 v44, v44
    v_exp_f32 v45, v45
    v_exp_f32 v46, v46
    v_exp_f32 v47, v47
    v_exp_f32 v48, v48
    v_exp_f32 v49, v49
    v_smfmac_f32_32x32x32_bf16 v[64:79], v[100:103], v[40:47], v8
    s_waitcnt lgkmcnt(2)
    v_exp_f32 v50, v50
    v_exp_f32 v51, v51
    v_exp_f32 v52, v52
    v_exp_f32 v53, v53
    v_mfma_f32_32x32x16_bf16 v[32:47], v[24:27], v[16:19], 0
    v_exp_f32 v54, v54
    v_exp_f32 v55, v55
    v_exp_f32 v56, v56
    v_exp_f32 v57, v57
    v_smfmac_f32_32x32x32_bf16 v[80:95], v[10:13], v[48:55], v8
    s_waitcnt lgkmcnt(0)
    v_exp_f32 v58, v58
    v_exp_f32 v59, v59
    v_exp_f32 v60, v60
    v_exp_f32 v61, v61
    v_exp_f32 v62, v62
    v_exp_f32 v63, v63
    v_exp_f32 v32, v32
    v_exp_f32 v33, v33
    v_smfmac_f32_32x32x32_bf16 v[80:95], v[100:103], v[56:63], v8
    ds_read_b128 v[96:99], v1 offset:62464
    v_exp_f32 v34, v34
    v_exp_f32 v35, v35
    v_exp_f32 v36, v36
    v_exp_f32 v37, v37
    v_mfma_f32_32x32x16_bf16 v[48:63], v[24:27], v[20:23], 0
    ds_read_b128 v[10:13], v3 offset:1024
    v_exp_f32 v38, v38
    v_exp_f32 v39, v39
    v_exp_f32 v40, v40
    v_exp_f32 v41, v41
    v_smfmac_f32_32x32x32_bf16 v[64:79], v[28:31], v[32:39], v8
    ds_read_b128 v[100:103], v3 offset:1536
    v_exp_f32 v42, v42
    v_exp_f32 v43, v43
    v_exp_f32 v44, v44
    v_exp_f32 v45, v45
    v_exp_f32 v46, v46
    v_exp_f32 v47, v47
    v_exp_f32 v48, v48
    v_exp_f32 v49, v49
    v_smfmac_f32_32x32x32_bf16 v[64:79], v[4:7], v[40:47], v8
    s_waitcnt lgkmcnt(2)
    v_exp_f32 v50, v50
    v_exp_f32 v51, v51
    v_exp_f32 v52, v52
    v_exp_f32 v53, v53
    v_mfma_f32_32x32x16_bf16 v[32:47], v[96:99], v[16:19], 0
    v_exp_f32 v54, v54
    v_exp_f32 v55, v55
    v_exp_f32 v56, v56
    v_exp_f32 v57, v57
    v_smfmac_f32_32x32x32_bf16 v[80:95], v[28:31], v[48:55], v8
    s_waitcnt lgkmcnt(0)
    v_exp_f32 v58, v58
    v_exp_f32 v59, v59
    v_exp_f32 v60, v60
    v_exp_f32 v61, v61
    v_exp_f32 v62, v62
    v_exp_f32 v63, v63
    v_exp_f32 v32, v32
    v_exp_f32 v33, v33
    v_smfmac_f32_32x32x32_bf16 v[80:95], v[4:7], v[56:63], v8
    ds_read_b128 v[24:27], v1 offset:63488
    v_exp_f32 v34, v34
    v_exp_f32 v35, v35
    v_exp_f32 v36, v36
    v_exp_f32 v37, v37
    v_mfma_f32_32x32x16_bf16 v[48:63], v[96:99], v[20:23], 0
    ds_read_b128 v[28:31], v3 offset:2048
    v_exp_f32 v38, v38
    v_exp_f32 v39, v39
    v_exp_f32 v40, v40
    v_exp_f32 v41, v41
    v_smfmac_f32_32x32x32_bf16 v[64:79], v[10:13], v[32:39], v8
    ds_read_b128 v[4:7], v3 offset:2560
    v_exp_f32 v42, v42
    v_exp_f32 v43, v43
    v_exp_f32 v44, v44
    v_exp_f32 v45, v45
    v_exp_f32 v46, v46
    v_exp_f32 v47, v47
    v_exp_f32 v48, v48
    v_exp_f32 v49, v49
    v_smfmac_f32_32x32x32_bf16 v[64:79], v[100:103], v[40:47], v8
    s_waitcnt lgkmcnt(2)
    v_exp_f32 v50, v50
    v_exp_f32 v51, v51
    v_exp_f32 v52, v52
    v_exp_f32 v53, v53
    v_mfma_f32_32x32x16_bf16 v[32:47], v[24:27], v[16:19], 0
    v_exp_f32 v54, v54
    v_exp_f32 v55, v55
    v_exp_f32 v56, v56
    v_exp_f32 v57, v57
    v_smfmac_f32_32x32x32_bf16 v[80:95], v[10:13], v[48:55], v8
    s_waitcnt lgkmcnt(0)
    v_exp_f32 v58, v58
    v_exp_f32 v59, v59
    v_exp_f32 v60, v60
    v_exp_f32 v61, v61
    v_exp_f32 v62, v62
    v_exp_f32 v63, v63
    v_exp_f32 v32, v32
    v_exp_f32 v33, v33
    v_smfmac_f32_32x32x32_bf16 v[80:95], v[100:103], v[56:63], v8
    ds_read_b128 v[96:99], v1 offset:64512
    v_exp_f32 v34, v34
    v_exp_f32 v35, v35
    v_exp_f32 v36, v36
    v_exp_f32 v37, v37
    v_mfma_f32_32x32x16_bf16 v[48:63], v[24:27], v[20:23], 0
    ds_read_b128 v[10:13], v3 offset:3072
    v_exp_f32 v38, v38
    v_exp_f32 v39, v39
    v_exp_f32 v40, v40
    v_exp_f32 v41, v41
    v_smfmac_f32_32x32x32_bf16 v[64:79], v[28:31], v[32:39], v8
    ds_read_b128 v[100:103], v3 offset:3584
    v_exp_f32 v42, v42
    v_exp_f32 v43, v43
    v_exp_f32 v44, v44
    v_exp_f32 v45, v45
    v_exp_f32 v46, v46
    v_exp_f32 v47, v47
    v_exp_f32 v48, v48
    v_exp_f32 v49, v49
    v_smfmac_f32_32x32x32_bf16 v[64:79], v[4:7], v[40:47], v8
    s_waitcnt lgkmcnt(2)
    v_exp_f32 v50, v50
    v_exp_f32 v51, v51
    v_exp_f32 v52, v52
    v_exp_f32 v53, v53
    v_mfma_f32_32x32x16_bf16 v[32:47], v[96:99], v[16:19], 0
    v_exp_f32 v54, v54
    v_exp_f32 v55, v55
    v_exp_f32 v56, v56
    v_exp_f32 v57, v57
    v_smfmac_f32_32x32x32_bf16 v[80:95], v[28:31], v[48:55], v8
    s_waitcnt lgkmcnt(0)
    v_exp_f32 v58, v58
    v_exp_f32 v59, v59
    v_exp_f32 v60, v60
    v_exp_f32 v61, v61
    v_exp_f32 v62, v62
    v_exp_f32 v63, v63
    v_exp_f32 v32, v32
    v_exp_f32 v33, v33
    v_smfmac_f32_32x32x32_bf16 v[80:95], v[4:7], v[56:63], v8
    v_exp_f32 v34, v34
    v_exp_f32 v35, v35
    v_exp_f32 v36, v36
    v_exp_f32 v37, v37
    v_mfma_f32_32x32x16_bf16 v[48:63], v[96:99], v[20:23], 0
    v_exp_f32 v38, v38
    v_exp_f32 v39, v39
    v_exp_f32 v40, v40
    v_exp_f32 v41, v41
    v_smfmac_f32_32x32x32_bf16 v[64:79], v[10:13], v[32:39], v8
    v_exp_f32 v42, v42
    v_exp_f32 v43, v43
    v_exp_f32 v44, v44
    v_exp_f32 v45, v45
    v_exp_f32 v46, v46
    v_exp_f32 v47, v47
    s_nop 0
    v_exp_f32 v48, v48
    v_exp_f32 v49, v49
    v_smfmac_f32_32x32x32_bf16 v[64:79], v[100:103], v[40:47], v8
    v_exp_f32 v50, v50
    v_exp_f32 v51, v51
    v_exp_f32 v52, v52
    v_exp_f32 v53, v53
    v_exp_f32 v54, v54
    v_exp_f32 v55, v55
    v_exp_f32 v56, v56
    v_exp_f32 v57, v57
    v_smfmac_f32_32x32x32_bf16 v[80:95], v[10:13], v[48:55], v8
    v_exp_f32 v58, v58
    v_exp_f32 v59, v59
    v_exp_f32 v60, v60
    v_exp_f32 v61, v61
    v_exp_f32 v62, v62
    v_exp_f32 v63, v63
    s_nop 1
    v_smfmac_f32_32x32x32_bf16 v[80:95], v[100:103], v[56:63], v8
    v_cmp_le_f32 s[28:29], s26, v72
    v_cmp_ge_f32 s[30:31], s27, v72
    s_nop 0
    s_and_b64 s[28:29], s[28:29], s[30:31]
    s_cmp_eq_u64 s[28:29], -1
    s_cbranch_scc0 L_slow0
L_fin0:
    v_rcp_f32 v72, v72
    s_nop 0
    v_pk_mul_f32 v[64:65], v[64:65], v[72:73] op_sel_hi:[1,0]
    v_pk_mul_f32 v[66:67], v[66:67], v[72:73] op_sel_hi:[1,0]
    v_pk_mul_f32 v[68:69], v[68:69], v[72:73] op_sel_hi:[1,0]
    v_pk_mul_f32 v[70:71], v[70:71], v[72:73] op_sel_hi:[1,0]
    v_cvt_pk_bf16_f32 v76, v64, v65
    v_cvt_pk_bf16_f32 v77, v66, v67
    v_cvt_pk_bf16_f32 v78, v68, v69
    v_cvt_pk_bf16_f32 v79, v70, v71
    buffer_store_dwordx4 v[76:79], v1, s[4:7], s25 offen sc1
    s_add_u32 s25, s25, 32768
    v_cmp_le_f32 s[28:29], s26, v88
    v_cmp_ge_f32 s[30:31], s27, v88
    s_nop 0
    s_and_b64 s[28:29], s[28:29], s[30:31]
    s_cmp_eq_u64 s[28:29], -1
    s_cbranch_scc0 L_slow1
L_fin1:
    v_rcp_f32 v88, v88
    s_nop 0
    v_pk_mul_f32 v[80:81], v[80:81], v[88:89] op_sel_hi:[1,0]
    v_pk_mul_f32 v[82:83], v[82:83], v[88:89] op_sel_hi:[1,0]
    v_pk_mul_f32 v[84:85], v[84:85], v[88:89] op_sel_hi:[1,0]
    v_pk_mul_f32 v[86:87], v[86:87], v[88:89] op_sel_hi:[1,0]
    v_cvt_pk_bf16_f32 v92, v80, v81
    v_cvt_pk_bf16_f32 v93, v82, v83
    v_cvt_pk_bf16_f32 v94, v84, v85
    v_cvt_pk_bf16_f32 v95, v86, v87
    buffer_store_dwordx4 v[92:95], v1, s[4:7], s25 offen sc1
    v_lshrrev_b32 v2, 5, v0
    v_bfe_u32 v3, v0, 4, 1
    v_and_b32 v4, 15, v0
    v_lshlrev_b32 v10, 14, v3
    v_lshl_add_u32 v10, v2, 8, v10
    v_lshl_add_u32 v10, v4, 4, v10
    s_lshl_b32 s35, s9, 16
    s_lshl_b32 s26, s54, 15
    s_add_u32 s35, s35, s26
    s_lshl_b32 s26, s53, 10
    s_add_u32 s35, s35, s26
    s_add_u32 s35, s35, s13
    s_add_u32 s26, s35, 0
    v_and_b32 v7, 31, v0
    v_lshlrev_b32 v8, 3, v7
    v_lshl_add_u32 v8, v2, 2, v8
    v_lshlrev_b32 v7, 10, v7
    v_lshl_add_u32 v7, v2, 4, v7
    s_lshl_b32 s34, s9, 16
    s_lshl_b32 s27, s54, 15
    s_add_u32 s34, s34, s27
    s_lshl_b32 s27, s53, 6
    s_add_u32 s34, s34, s27
    s_cmp_eq_u32 s11, 0
    s_cbranch_scc0 L_resws
    buffer_load_dwordx4 v[24:27], v7, s[68:71], s34 offen offset:0
    buffer_load_dwordx4 v[28:31], v7, s[68:71], s34 offen offset:32
    s_branch L_resdone
L_resws:
    buffer_load_dwordx4 v[24:27], v10, s[4:7], s26 offen offset:0 sc1
    buffer_load_dwordx4 v[28:31], v10, s[4:7], s26 offen offset:512 sc1
L_resdone:
    s_mul_i32 s27, s54, 98304
    v_add_u32 v11, s27, v1
    v_xor_b32 v12, 0x8000, v11
    s_lshl_b32 s28, s8, 12
    s_add_u32 s28, s28, 131072
    v_add_u32 v13, s28, v1
    v_xor_b32 v6, 8192, v13
    s_and_b32 s20, s8, 1
    s_lshl_b32 s27, s9, 1
    s_add_u32 s27, s27, s20
    s_mul_i32 s27, s27, 32768
    s_mul_i32 s24, s54, 16384
    s_add_u32 s27, s27, s24
    s_add_u32 s27, s27, s13
    s_add_u32 s27, s27, 10485760
    s_lshl_b32 s28, s8, 15
    s_lshl_b32 s25, s9, 16
    s_lshl_b32 s29, s54, 15
    s_add_u32 s25, s25, s29
    s_lshl_b32 s29, s53, 11
    s_add_u32 s25, s25, s29
    s_add_u32 s25, s25, s13
    s_add_u32 s25, s25, 2097152
    s_lshl_b32 s29, s9, 13
    s_lshl_b32 s30, s53, 9
    s_add_u32 s29, s29, s30
    s_lshl_b32 s30, s54, 8
    s_add_u32 s29, s29, s30
    s_add_u32 s29, s29, s13
    s_add_u32 s29, s29, 19398656
    s_waitcnt vmcnt(2) lgkmcnt(0)
    s_barrier
    s_cmp_lg_u32 s8, 0
    s_cbranch_scc1 L_arr6
    s_atomic_add s36, s[38:39], 512
    s_atomic_add s36, s[38:39], 640
    s_atomic_add s36, s[38:39], 768
    s_atomic_add s36, s[38:39], 896
L_arr6:
    s_cmp_lg_u32 s8, 1
    s_cbranch_scc1 L_pw7
    s_mov_b32 s58, 0x40000
L_poll8:
    s_mov_b32 s101, 0
    s_atomic_add s101, s[60:61], 512 glc
    s_sub_u32 s58, s58, 1
    s_waitcnt lgkmcnt(0)
    s_cbranch_scc1 L_poll8_x
    s_cmp_lt_u32 s101, 32
    s_sleep 1
    s_cbranch_scc1 L_poll8
L_poll8_x:
L_pw7:
    s_barrier
    s_add_u32 m0, s28, 0
    s_nop 0
    buffer_load_dwordx4 v1, s[4:7], s27 offen offset:0 sc1 lds
    buffer_load_dwordx4 v1, s[4:7], s27 offen offset:1024 sc1 lds
    buffer_load_dwordx4 v1, s[4:7], s27 offen offset:2048 sc1 lds
    buffer_load_dwordx4 v1, s[4:7], s27 offen offset:3072 sc1 lds
    s_add_u32 m0, s28, 4096
    s_add_u32 s27, s27, 4096
    buffer_load_dwordx4 v1, s[4:7], s27 offen offset:0 sc1 lds
    buffer_load_dwordx4 v1, s[4:7], s27 offen offset:1024 sc1 lds
    buffer_load_dwordx4 v1, s[4:7], s27 offen offset:2048 sc1 lds
    buffer_load_dwordx4 v1, s[4:7], s27 offen offset:3072 sc1 lds
    s_add_u32 m0, s28, 8192
    s_add_u32 s27, s27, 4096
    buffer_load_dwordx4 v1, s[4:7], s27 offen offset:0 sc1 lds
    buffer_load_dwordx4 v1, s[4:7], s27 offen offset:1024 sc1 lds
    buffer_load_dwordx4 v1, s[4:7], s27 offen offset:2048 sc1 lds
    buffer_load_dwordx4 v1, s[4:7], s27 offen offset:3072 sc1 lds
    s_waitcnt vmcnt(12)
    v_permlane32_swap_b32 v24, v26
    v_permlane32_swap_b32 v25, v27
    v_permlane32_swap_b32 v28, v30
    v_permlane32_swap_b32 v29, v31
    v_lshlrev_b32 v40, 16, v24
    v_and_b32 v41, 0xffff0000, v24
    v_lshlrev_b32 v42, 16, v25
    v_and_b32 v43, 0xffff0000, v25
    v_lshlrev_b32 v44, 16, v26
    v_and_b32 v45, 0xffff0000, v26
    v_lshlrev_b32 v46, 16, v27
    v_and_b32 v47, 0xffff0000, v27
    v_lshlrev_b32 v48, 16, v28
    v_and_b32 v49, 0xffff0000, v28
    v_lshlrev_b32 v50, 16, v29
    v_and_b32 v51, 0xffff0000, v29
    v_lshlrev_b32 v52, 16, v30
    v_and_b32 v53, 0xffff0000, v30
    v_lshlrev_b32 v54, 16, v31
    v_and_b32 v55, 0xffff0000, v31
    s_waitcnt vmcnt(8)
    s_barrier
    ds_read_b128 v[16:19], v12 offset:0
    ds_read_b128 v[20:23], v12 offset:1024
    ds_read_b128 v[24:27], v12 offset:2048
    ds_read_b128 v[28:31], v12 offset:3072
    s_waitcnt lgkmcnt(3)
    v_mfma_f32_32x32x16_bf16 v[56:71], a[192:195], v[16:19], 0
    s_waitcnt lgkmcnt(2)
    s_waitcnt vmcnt(4)
    s_barrier
    ds_read_b128 v[32:35], v12 offset:4096
    s_add_u32 m0, s28, 12288
    s_add_u32 s27, s27, 4096
    buffer_load_dwordx4 v1, s[4:7], s27 offen offset:0 sc1 lds
    v_mfma_f32_32x32x16_bf16 v[56:71], a[196:199], v[20:23], v[56:71]
    s_waitcnt lgkmcnt(2)
    ds_read_b128 v[36:39], v11 offset:0
    buffer_load_dwordx4 v1, s[4:7], s27 offen offset:1024 sc1 lds
    v_mfma_f32_32x32x16_bf16 v[56:71], a[200:203], v[24:27], v[56:71]
    s_waitcnt lgkmcnt(2)
    ds_read_b128 v[16:19], v12 offset:5120
    buffer_load_dwordx4 v1, s[4:7], s27 offen offset:2048 sc1 lds
    v_mfma_f32_32x32x16_bf16 v[56:71], a[204:207], v[28:31], v[56:71]
    s_waitcnt lgkmcnt(2)
    ds_read_b128 v[20:23], v11 offset:1024
    buffer_load_dwordx4 v1, s[4:7], s27 offen offset:3072 sc1 lds
    v_mfma_f32_32x32x16_bf16 v[56:71], a[208:211], v[32:35], v[56:71]
    s_waitcnt lgkmcnt(2)
    ds_read_b128 v[24:27], v12 offset:6144
    v_mfma_f32_32x32x16_bf16 v[40:55], a[192:195], v[36:39], v[40:55]
    s_waitcnt lgkmcnt(2)
    ds_read_b128 v[28:31], v11 offset:2048
    v_mfma_f32_32x32x16_bf16 v[56:71], a[212:215], v[16:19], v[56:71]
    s_waitcnt lgkmcnt(2)
    ds_read_b128 v[32:35], v12 offset:7168
    v_mfma_f32_32x32x16_bf16 v[40:55], a[196:199], v[20:23], v[40:55]
    s_waitcnt lgkmcnt(2)
    ds_read_b128 v[36:39], v11 offset:3072
    v_mfma_f32_32x32x16_bf16 v[56:71], a[216:219], v[24:27], v[56:71]
    s_waitcnt lgkmcnt(2)
    s_waitcnt vmcnt(4)
    s_barrier
    ds_read_b128 v[16:19], v12 offset:8192
    v_mfma_f32_32x32x16_bf16 v[40:55], a[200:203], v[28:31], v[40:55]
    s_waitcnt lgkmcnt(2)
    ds_read_b128 v[20:23], v11 offset:4096
    v_mfma_f32_32x32x16_bf16 v[56:71], a[220:223], v[32:35], v[56:71]
    s_waitcnt lgkmcnt(2)
    ds_read_b128 v[24:27], v12 offset:9216
    v_mfma_f32_32x32x16_bf16 v[40:55], a[204:207], v[36:39], v[40:55]
    s_waitcnt lgkmcnt(2)
    ds_read_b128 v[28:31], v11 offset:5120
    v_mfma_f32_32x32x16_bf16 v[56:71], a[224:227], v[16:19], v[56:71]
    s_waitcnt lgkmcnt(2)
    ds_read_b128 v[32:35], v12 offset:10240
    v_mfma_f32_32x32x16_bf16 v[40:55], a[208:211], v[20:23], v[40:55]
    s_waitcnt lgkmcnt(2)
    ds_read_b128 v[36:39], v11 offset:6144
    v_mfma_f32_32x32x16_bf16 v[56:71], a[228:231], v[24:27], v[56:71]
    s_waitcnt lgkmcnt(2)
    ds_read_b128 v[16:19], v12 offset:11264
    v_mfma_f32_32x32x16_bf16 v[40:55], a[212:215], v[28:31], v[40:55]
    s_waitcnt lgkmcnt(2)
    ds_read_b128 v[20:23], v11 offset:7168
    v_mfma_f32_32x32x16_bf16 v[56:71], a[232:235], v[32:35], v[56:71]
    s_waitcnt lgkmcnt(2)
    s_waitcnt vmcnt(0)
    s_barrier
    ds_read_b128 v[24:27], v12 offset:12288
    v_mfma_f32_32x32x16_bf16 v[40:55], a[216:219], v[36:39], v[40:55]
    s_waitcnt lgkmcnt(2)
    ds_read_b128 v[28:31], v11 offset:8192
    v_mfma_f32_32x32x16_bf16 v[56:71], a[236:239], v[16:19], v[56:71]
    s_waitcnt lgkmcnt(2)
    ds_read_b128 v[32:35], v12 offset:13312
    v_mfma_f32_32x32x16_bf16 v[40:55], a[220:223], v[20:23], v[40:55]
    s_waitcnt lgkmcnt(2)
    ds_read_b128 v[36:39], v11 offset:9216
    v_mfma_f32_32x32x16_bf16 v[56:71], a[240:243], v[24:27], v[56:71]
    s_waitcnt lgkmcnt(2)
    ds_read_b128 v[16:19], v12 offset:14336
    v_mfma_f32_32x32x16_bf16 v[40:55], a[224:227], v[28:31], v[40:55]
    s_waitcnt lgkmcnt(2)
    ds_read_b128 v[20:23], v11 offset:10240
    v_mfma_f32_32x32x16_bf16 v[56:71], a[244:247], v[32:35], v[56:71]
    s_waitcnt lgkmcnt(2)
    ds_read_b128 v[24:27], v12 offset:15360
    v_mfma_f32_32x32x16_bf16 v[40:55], a[228:231], v[36:39], v[40:55]
    s_waitcnt lgkmcnt(2)
    ds_read_b128 v[28:31], v11 offset:11264
    v_mfma_f32_32x32x16_bf16 v[56:71], a[248:251], v[16:19], v[56:71]
    s_waitcnt lgkmcnt(2)
    ds_read_b128 v[32:35], v11 offset:12288
    v_mfma_f32_32x32x16_bf16 v[40:55], a[232:235], v[20:23], v[40:55]
    s_waitcnt lgkmcnt(2)
    ds_read_b128 v[36:39], v11 offset:13312
    v_mfma_f32_32x32x16_bf16 v[56:71], a[252:255], v[24:27], v[56:71]
    s_waitcnt lgkmcnt(2)
    ds_read_b128 v[16:19], v11 offset:14336
    v_mfma_f32_32x32x16_bf16 v[40:55], a[236:239], v[28:31], v[40:55]
    s_waitcnt lgkmcnt(2)
    ds_read_b128 v[20:23], v11 offset:15360
    v_mfma_f32_32x32x16_bf16 v[40:55], a[240:243], v[32:35], v[40:55]
    s_waitcnt lgkmcnt(2)
    s_nop 4
    ds_write_b128 v13, v[56:59] offset:0
    ds_write_b128 v13, v[60:63] offset:1024
    ds_write_b128 v13, v[64:67] offset:2048
    ds_write_b128 v13, v[68:71] offset:3072
    v_mfma_f32_32x32x16_bf16 v[40:55], a[244:247], v[36:39], v[40:55]
    s_waitcnt lgkmcnt(5)
    v_mfma_f32_32x32x16_bf16 v[40:55], a[248:251], v[16:19], v[40:55]
    s_waitcnt lgkmcnt(4)
    v_mfma_f32_32x32x16_bf16 v[40:55], a[252:255], v[20:23], v[40:55]
    s_waitcnt lgkmcnt(0)
    s_barrier
    ds_read_b128 v[56:59], v6 offset:0
    ds_read_b128 v[60:63], v6 offset:1024
    ds_read_b128 v[64:67], v6 offset:2048
    ds_read_b128 v[68:71], v6 offset:3072
    s_waitcnt lgkmcnt(3)
    s_nop 4
    v_pk_add_f32 v[40:41], v[40:41], v[56:57]
    v_pk_add_f32 v[42:43], v[42:43], v[58:59]
    s_waitcnt lgkmcnt(2)
    v_pk_add_f32 v[44:45], v[44:45], v[60:61]
    v_pk_add_f32 v[46:47], v[46:47], v[62:63]
    s_waitcnt lgkmcnt(1)
    v_pk_add_f32 v[48:49], v[48:49], v[64:65]
    v_pk_add_f32 v[50:51], v[50:51], v[66:67]
    s_waitcnt lgkmcnt(0)
    v_pk_add_f32 v[52:53], v[52:53], v[68:69]
    v_pk_add_f32 v[54:55], v[54:55], v[70:71]
    v_cvt_pk_bf16_f32 v72, v40, v41
    v_cvt_pk_bf16_f32 v73, v42, v43
    v_cvt_pk_bf16_f32 v74, v44, v45
    v_cvt_pk_bf16_f32 v75, v46, v47
    v_cvt_pk_bf16_f32 v76, v48, v49
    v_cvt_pk_bf16_f32 v77, v50, v51
    v_cvt_pk_bf16_f32 v78, v52, v53
    v_cvt_pk_bf16_f32 v79, v54, v55
    buffer_store_dwordx4 v[72:75], v1, s[4:7], s25 offen offset:0 sc1
    buffer_store_dwordx4 v[76:79], v1, s[4:7], s25 offen offset:1024 sc1
    v_pk_add_f32 v[16:17], v[40:41], v[42:43]
    v_pk_mul_f32 v[18:19], v[40:41], v[40:41]
    v_pk_fma_f32 v[18:19], v[42:43], v[42:43], v[18:19]
    v_pk_add_f32 v[16:17], v[16:17], v[44:45]
    v_pk_fma_f32 v[18:19], v[44:45], v[44:45], v[18:19]
    v_pk_add_f32 v[16:17], v[16:17], v[46:47]
    v_pk_fma_f32 v[18:19], v[46:47], v[46:47], v[18:19]
    v_pk_add_f32 v[16:17], v[16:17], v[48:49]
    v_pk_fma_f32 v[18:19], v[48:49], v[48:49], v[18:19]
    v_pk_add_f32 v[16:17], v[16:17], v[50:51]
    v_pk_fma_f32 v[18:19], v[50:51], v[50:51], v[18:19]
    v_pk_add_f32 v[16:17], v[16:17], v[52:53]
    v_pk_fma_f32 v[18:19], v[52:53], v[52:53], v[18:19]
    v_pk_add_f32 v[16:17], v[16:17], v[54:55]
    v_pk_fma_f32 v[18:19], v[54:55], v[54:55], v[18:19]
    v_add_f32 v16, v16, v17
    v_add_f32 v18, v18, v19
    s_nop 1
    v_permlane32_swap_b32 v16, v18
    v_add_f32 v16, v16, v18
    buffer_store_dword v16, v8, s[4:7], s29 offen sc1
    v_lshrrev_b32 v2, 4, v0
    v_and_b32 v3, 15, v0
    s_lshl_b32 s25, s8, 6
    s_add_u32 s25, s25, 155648
    v_lshrrev_b32 v8, 3, v0
    v_and_b32 v9, 7, v0
    v_lshlrev_b32 v8, 9, v8
    v_lshl_add_u32 v8, v9, 4, v8
    v_lshrrev_b32 v7, 5, v0
    v_lshl_add_u32 v9, v9, 1, v7
    v_lshl_add_u32 v9, v9, 2, s25
    s_lshl_b32 s24, s9, 13
    s_lshl_b32 s25, s8, 7
    s_add_u32 s24, s24, s25
    s_add_u32 s24, s24, s13
    s_add_u32 s24, s24, 19398656
    s_lshl_b32 s26, s9, 16
    s_lshl_b32 s27, s8, 13
    s_add_u32 s26, s26, s27
    s_add_u32 s26, s26, s13
    s_add_u32 s26, s26, 2097152
    s_and_b32 s20, s8, 1
    s_mul_i32 s21, s10, 6
    s_add_u32 s22, s21, s8
    s_add_u32 s23, s21, s54
    s_add_u32 s23, s23, 4
    s_mul_i32 s21, s9, 196608
    s_add_u32 s21, s21, s13
    s_add_u32 s21, s21, 12582912
    s_lshl_b32 s28, s22, 11
    s_add_u32 s28, s28, s21
    s_lshl_b32 s29, s23, 1
    s_add_u32 s29, s29, s20
    s_lshl_b32 s29, s29, 10
    s_add_u32 s29, s29, s21
    v_lshlrev_b32 v60, 1, v0
    v_cmp_gt_u32 vcc, 32, v0
    v_mov_b32 v61, 0x10000
    s_lshl_b32 s22, s22, 6
    v_cndmask_b32 v60, v61, v60, vcc
    s_lshl_b32 s23, s23, 6
    s_cmp_eq_u32 s20, 0
    s_cselect_b32 s23, s23, 0x10000
    buffer_load_ushort v62, v60, s[40:43], s22 offen
    buffer_load_ushort v63, v60, s[40:43], s23 offen
    s_lshl_b32 s20, s20, 14
    v_add_u32 v10, s20, v1
    v_xor_b32 v11, 0x4000, v10
    s_mov_b32 s32, 0xbdd2d3e8
    v_mov_b32 v4, 0xc0135761
    v_mov_b32 v5, 0xbdd2d3e8
    v_and_b32 v56, 1, v2
    v_cmp_eq_u32 vcc, v56, v3
    v_mov_b32 v57, 0x3f803f80
    s_lshl_b32 s20, s8, 12
    v_cndmask_b32 v56, 0, v57, vcc
    s_add_u32 s20, s20, 131072
    v_mov_b32 v57, v56
    v_mov_b32 v58, v56
    v_mov_b32 v59, v56
    v_add_u32 v12, s20, v1
    s_waitcnt vmcnt(2) lgkmcnt(0)
    s_barrier
    s_cmp_lg_u32 s8, 0
    s_cbranch_scc1 L_arr9
    s_atomic_add s36, s[14:15], 1024
L_arr9:
    v_mfma_f32_16x16x32_bf16 v[48:51], v[56:59], a[0:3], 0
    v_mfma_f32_16x16x32_bf16 v[48:51], v[56:59], a[4:7], v[48:51]
    v_mfma_f32_16x16x32_bf16 v[48:51], v[56:59], a[8:11], v[48:51]
    v_mfma_f32_16x16x32_bf16 v[48:51], v[56:59], a[12:15], v[48:51]
    v_mfma_f32_16x16x32_bf16 v[48:51], v[56:59], a[16:19], v[48:51]
    v_mfma_f32_16x16x32_bf16 v[48:51], v[56:59], a[20:23], v[48:51]
    v_mfma_f32_16x16x32_bf16 v[48:51], v[56:59], a[24:27], v[48:51]
    v_mfma_f32_16x16x32_bf16 v[48:51], v[56:59], a[28:31], v[48:51]
    v_mfma_f32_16x16x32_bf16 v[48:51], v[56:59], a[32:35], v[48:51]
    v_mfma_f32_16x16x32_bf16 v[48:51], v[56:59], a[36:39], v[48:51]
    v_mfma_f32_16x16x32_bf16 v[48:51], v[56:59], a[40:43], v[48:51]
    v_mfma_f32_16x16x32_bf16 v[48:51], v[56:59], a[44:47], v[48:51]
    v_mfma_f32_16x16x32_bf16 v[48:51], v[56:59], a[48:51], v[48:51]
    v_mfma_f32_16x16x32_bf16 v[48:51], v[56:59], a[52:55], v[48:51]
    v_mfma_f32_16x16x32_bf16 v[48:51], v[56:59], a[56:59], v[48:51]
    v_mfma_f32_16x16x32_bf16 v[48:51], v[56:59], a[60:63], v[48:51]
    v_mfma_f32_16x16x32_bf16 v[48:51], v[56:59], a[64:67], v[48:51]
    v_mfma_f32_16x16x32_bf16 v[48:51], v[56:59], a[68:71], v[48:51]
    v_mfma_f32_16x16x32_bf16 v[48:51], v[56:59], a[72:75], v[48:51]
    v_mfma_f32_16x16x32_bf16 v[48:51], v[56:59], a[76:79], v[48:51]
    v_mfma_f32_16x16x32_bf16 v[48:51], v[56:59], a[80:83], v[48:51]
    v_mfma_f32_16x16x32_bf16 v[48:51], v[56:59], a[84:87], v[48:51]
    v_mfma_f32_16x16x32_bf16 v[48:51], v[56:59], a[88:91], v[48:51]
    v_mfma_f32_16x16x32_bf16 v[48:51], v[56:59], a[92:95], v[48:51]
    s_cmp_lg_u32 s8, 1
    s_cbranch_scc1 L_pw10
    s_mov_b32 s58, 0x40000
L_poll11:
    s_mov_b32 s101, 0
    s_atomic_add s101, s[14:15], 1024 glc
    s_sub_u32 s58, s58, 1
    s_waitcnt lgkmcnt(0)
    s_cbranch_scc1 L_poll11_x
    s_cmp_lt_u32 s101, 8
    s_sleep 1
    s_cbranch_scc1 L_poll11
L_poll11_x:
L_pw10:
    s_barrier
    s_add_u32 m0, s27, 0
    s_nop 0
    buffer_load_dwordx4 v1, s[4:7], s26 offen offset:0 sc1 lds
    buffer_load_dwordx4 v1, s[4:7], s26 offen offset:1024 sc1 lds
    buffer_load_dwordx4 v1, s[4:7], s26 offen offset:2048 sc1 lds
    buffer_load_dwordx4 v1, s[4:7], s26 offen offset:3072 sc1 lds
    buffer_load_dwordx4 v[64:67], v8, s[4:7], s24 offen sc1
    s_add_u32 s24, s24, 4096
    buffer_load_dwordx4 v[68:71], v8, s[4:7], s24 offen sc1
    v_lshrrev_b32 v7, 5, v0
    v_bfe_u32 v13, v0, 4, 1
    v_lshlrev_b32 v13, 14, v13
    v_lshl_add_u32 v13, v7, 8, v13
    v_lshl_add_u32 v13, v3, 4, v13
    v_lshlrev_b32 v7, 3, v7
    s_lshl_b32 s34, s9, 16
    s_lshl_b32 s33, s53, 10
    s_add_u32 s35, s34, s33
    s_lshl_b32 s33, s54, 9
    s_add_u32 s35, s35, s33
    s_add_u32 s35, s35, s13
    s_lshl_b32 s30, s53, 6
    s_lshl_b32 s33, s54, 5
    s_add_u32 s30, s30, s33
    s_add_u32 s34, s34, s30
    s_mul_i32 s33, s53, 88064
    s_mul_i32 s31, s54, 44032
    s_add_u32 s33, s33, s31
    s_add_u32 s33, s33, 3837952
    s_lshl_b32 s31, s53, 1
    s_add_u32 s31, s31, s54
    s_lshl_b32 s31, s31, 10
    s_lshl_b32 s20, s9, 16
    s_add_u32 s31, s31, s20
    s_add_u32 s31, s31, s13
    s_add_u32 s31, s31, 2097152
    v_xor_b32 v3, 4096, v12
    v_mfma_f32_16x16x32_bf16 v[48:51], v[56:59], a[96:99], v[48:51]
    v_mfma_f32_16x16x32_bf16 v[48:51], v[56:59], a[100:103], v[48:51]
    v_mfma_f32_16x16x32_bf16 v[48:51], v[56:59], a[104:107], v[48:51]
    v_mfma_f32_16x16x32_bf16 v[48:51], v[56:59], a[108:111], v[48:51]
    v_mfma_f32_16x16x32_bf16 v[48:51], v[56:59], a[112:115], v[48:51]
    s_add_u32 m0, s27, 4096
    s_add_u32 s26, s26, 4096
    buffer_load_dwordx4 v1, s[4:7], s26 offen offset:0 sc1 lds
    v_mfma_f32_16x16x32_bf16 v[48:51], v[56:59], a[116:119], v[48:51]
    v_mfma_f32_16x16x32_bf16 v[48:51], v[56:59], a[120:123], v[48:51]
    v_mfma_f32_16x16x32_bf16 v[48:51], v[56:59], a[124:127], v[48:51]
    v_mfma_f32_16x16x32_bf16 v[52:55], v[56:59], a[128:131], 0
    buffer_load_dwordx4 v1, s[4:7], s26 offen offset:1024 sc1 lds
    v_mfma_f32_16x16x32_bf16 v[52:55], v[56:59], a[132:135], v[52:55]
    v_mfma_f32_16x16x32_bf16 v[52:55], v[56:59], a[136:139], v[52:55]
    v_mfma_f32_16x16x32_bf16 v[52:55], v[56:59], a[140:143], v[52:55]
    v_mfma_f32_16x16x32_bf16 v[52:55], v[56:59], a[144:147], v[52:55]
    buffer_load_dwordx4 v1, s[4:7], s26 offen offset:2048 sc1 lds
    v_mfma_f32_16x16x32_bf16 v[52:55], v[56:59], a[148:151], v[52:55]
    v_mfma_f32_16x16x32_bf16 v[52:55], v[56:59], a[152:155], v[52:55]
    v_mfma_f32_16x16x32_bf16 v[52:55], v[56:59], a[156:159], v[52:55]
    v_mfma_f32_16x16x32_bf16 v[52:55], v[56:59], a[160:163], v[52:55]
    buffer_load_dwordx4 v1, s[4:7], s26 offen offset:3072 sc1 lds
    v_mfma_f32_16x16x32_bf16 v[52:55], v[56:59], a[164:167], v[52:55]
    v_mfma_f32_16x16x32_bf16 v[52:55], v[56:59], a[168:171], v[52:55]
    v_mfma_f32_16x16x32_bf16 v[52:55], v[56:59], a[172:175], v[52:55]
    v_mfma_f32_16x16x32_bf16 v[52:55], v[56:59], a[176:179], v[52:55]
    s_add_u32 m0, s27, 32768
    s_add_u32 s26, s26, 28672
    buffer_load_dwordx4 v1, s[4:7], s26 offen offset:0 sc1 lds
    v_mfma_f32_16x16x32_bf16 v[52:55], v[56:59], a[180:183], v[52:55]
    v_mfma_f32_16x16x32_bf16 v[52:55], v[56:59], a[184:187], v[52:55]
    v_mfma_f32_16x16x32_bf16 v[52:55], v[56:59], a[188:191], v[52:55]
    s_waitcnt vmcnt(7)
    s_barrier
    ds_read_b128 a[228:231], v10 offset:0
    ds_read_b128 a[232:235], v10 offset:1024
    ds_read_b128 a[236:239], v10 offset:2048
    ds_read_b128 a[240:243], v10 offset:3072
    ds_read_b128 a[244:247], v10 offset:8192
    s_waitcnt lgkmcnt(4)
    v_mfma_f32_32x32x16_bf16 v[16:31], a[128:131], a[228:231], 0
    buffer_load_dwordx4 v1, s[4:7], s26 offen offset:1024 sc1 lds
    v_permlane16_swap_b32 v48, v49
    v_cvt_pk_bf16_f32 v88, v48, v48
    v_and_b32 v49, 0xffff0000, v88
    v_sub_f32 v49, v48, v49
    v_cvt_pk_bf16_f32 v49, v49, 0
    v_mfma_f32_32x32x16_bf16 v[32:47], a[0:3], a[228:231], 0
    s_waitcnt lgkmcnt(3)
    ds_read_b128 a[248:251], v10 offset:9216
    v_lshl_or_b32 v89, v62, 16, v49
    v_mov_b32 v90, v62
    v_mov_b32 v91, 0
    v_permlane16_swap_b32 v52, v53
    v_cvt_pk_bf16_f32 v92, v52, v52
    v_mfma_f32_32x32x16_bf16 v[16:31], a[132:135], a[232:235], v[16:31]
    buffer_load_dwordx4 v1, s[4:7], s26 offen offset:2048 sc1 lds
    v_and_b32 v53, 0xffff0000, v92
    v_sub_f32 v53, v52, v53
    v_cvt_pk_bf16_f32 v53, v53, 0
    v_lshl_or_b32 v93, v63, 16, v53
    v_mov_b32 v94, v63
    v_mfma_f32_32x32x16_bf16 v[32:47], a[4:7], a[232:235], v[32:47]
    s_waitcnt lgkmcnt(3)
    ds_read_b128 a[228:231], v10 offset:10240
    v_mov_b32 v95, 0
    v_mfma_f32_32x32x16_bf16 v[16:31], a[136:139], a[236:239], v[16:31]
    buffer_load_dwordx4 v1, s[4:7], s26 offen offset:3072 sc1 lds
    s_waitcnt vmcnt(4)
    s_barrier
    v_mfma_f32_32x32x16_bf16 v[32:47], a[8:11], a[236:239], v[32:47]
    s_waitcnt lgkmcnt(3)
    ds_read_b128 a[232:235], v10 offset:11264
    s_waitcnt vmcnt(8)
    v_add_f32 v64, v64, v68
    v_add_f32 v65, v65, v69
    v_add_f32 v66, v66, v70
    v_add_f32 v67, v67, v71
    s_nop 0
    v_permlane32_swap_b32 v64, v66
    v_mfma_f32_32x32x16_bf16 v[16:31], a[140:143], a[240:243], v[16:31]
    s_add_u32 m0, s27, 36864
    s_add_u32 s26, s26, 4096
    buffer_load_dwordx4 v1, s[4:7], s26 offen offset:0 sc1 lds
    v_permlane32_swap_b32 v65, v67
    v_add_f32 v64, v64, v66
    v_add_f32 v65, v65, v67
    v_mov_b32 v66, v64
    v_mfma_f32_32x32x16_bf16 v[32:47], a[12:15], a[240:243], v[32:47]
    s_waitcnt lgkmcnt(3)
    ds_read_b128 a[236:239], v10 offset:4096
    v_mov_b32 v67, v65
    v_permlane16_swap_b32 v64, v66
    s_nop 0
    v_permlane16_swap_b32 v65, v67
    v_add_f32 v64, v64, v66
    v_add_f32 v65, v65, v67
    v_mfma_f32_32x32x16_bf16 v[16:31], a[160:163], a[244:247], v[16:31]
    buffer_load_dwordx4 v1, s[4:7], s26 offen offset:1024 sc1 lds
    v_add_f32_dpp v64, v64, v64 row_ror:8 row_mask:0xf bank_mask:0xf
    v_add_f32_dpp v65, v65, v65 row_ror:8 row_mask:0xf bank_mask:0xf
    v_mul_f32 v64, 0x3b000000, v64
    v_mul_f32 v65, 0x3b000000, v65
    v_mfma_f32_32x32x16_bf16 v[32:47], a[32:35], a[244:247], v[32:47]
    s_waitcnt lgkmcnt(3)
    ds_read_b128 a[240:243], v10 offset:5120
    v_fma_f32 v65, -v64, v64, v65
    v_max_f32 v65, 0, v65
    v_add_f32 v66, 0x3727c5ac, v65
    v_rsq_f32 v66, v66
    s_nop 0
    v_mul_f32 v67, v66, v66
    v_mfma_f32_32x32x16_bf16 v[16:31], a[164:167], a[248:251], v[16:31]
    buffer_load_dwordx4 v1, s[4:7], s26 offen offset:2048 sc1 lds
    v_mul_f32 v67, v67, v65
    v_add_f32 v67, 0x3727c5ac, v67
    v_rsq_f32 v67, v67
    v_mfma_f32_32x32x16_bf16 v[32:47], a[36:39], a[248:251], v[32:47]
    s_waitcnt lgkmcnt(3)
    ds_read_b128 a[244:247], v10 offset:6144
    v_mul_f32 v66, v66, v67
    v_rcp_f32 v67, v66
    v_sub_f32 v64, 0, v64
    ds_write_b32 v9, v66 offset:512
    v_mfma_f32_32x32x16_bf16 v[16:31], a[168:171], a[228:231], v[16:31]
    buffer_load_dwordx4 v1, s[4:7], s26 offen offset:3072 sc1 lds
    ds_write2_b32 v9, v64, v67 offset1:64
    v_and_b32 v76, 31, v0
    v_lshlrev_b32 v76, 2, v76
    v_add_u32 v76, 155648, v76
    v_mfma_f32_32x32x16_bf16 v[32:47], a[40:43], a[228:231], v[32:47]
    s_waitcnt lgkmcnt(5)
    ds_read_b128 a[248:251], v10 offset:7168
    v_mfma_f32_32x32x16_bf16 v[16:31], a[172:175], a[232:235], v[16:31]
    buffer_load_dwordx4 a[192:195], v1, s[4:7], s33 offen offset:1024
    v_mfma_f32_32x32x16_bf16 v[32:47], a[44:47], a[232:235], v[32:47]
    s_waitcnt lgkmcnt(5)
    ds_read_b128 a[228:231], v10 offset:12288
    v_mfma_f32_32x32x16_bf16 v[16:31], a[144:147], a[236:239], v[16:31]
    buffer_load_dwordx4 a[196:199], v1, s[4:7], s33 offen offset:2048
    v_mfma_f32_32x32x16_bf16 v[32:47], a[16:19], a[236:239], v[32:47]
    s_waitcnt lgkmcnt(5)
    ds_read_b128 a[232:235], v10 offset:13312
    v_mfma_f32_32x32x16_bf16 v[16:31], a[148:151], a[240:243], v[16:31]
    buffer_load_dwordx4 a[200:203], v1, s[4:7], s33 offen offset:3072
    s_waitcnt lgkmcnt(3)
    s_barrier
    ds_read2_b32 v[72:73], v76 offset0:0 offset1:64
    ds_read2_b32 v[74:75], v76 offset0:32 offset1:96
    ds_read2_b32 v[252:253], v76 offset0:128 offset1:160
    v_mfma_f32_32x32x16_bf16 v[32:47], a[20:23], a[240:243], v[32:47]
    s_waitcnt lgkmcnt(8)
    ds_read_b128 a[236:239], v10 offset:14336
    v_mfma_f32_32x32x16_bf16 v[16:31], a[152:155], a[244:247], v[16:31]
    s_add_u32 s33, s33, 4096
    buffer_load_dwordx4 a[204:207], v1, s[4:7], s33 offen offset:0
    v_mfma_f32_32x32x16_bf16 v[32:47], a[24:27], a[244:247], v[32:47]
    s_waitcnt lgkmcnt(6)
    ds_read_b128 a[240:243], v10 offset:15360
    v_mfma_f32_32x32x16_bf16 v[16:31], a[156:159], a[248:251], v[16:31]
    buffer_load_dwordx4 a[208:211], v1, s[4:7], s33 offen offset:1024
    s_waitcnt lgkmcnt(2)
    v_cvt_pk_bf16_f32 v97, v72, v73
    v_lshlrev_b32 v96, 16, v97
    v_and_b32 v98, 0xffff0000, v97
    v_sub_f32 v72, v72, v96
    v_sub_f32 v73, v73, v98
    v_mfma_f32_32x32x16_bf16 v[32:47], a[28:31], a[248:251], v[32:47]
    s_waitcnt lgkmcnt(6)
    ds_read_b128 a[244:247], v11 offset:0
    v_cvt_pk_bf16_f32 v72, v72, v73
    v_lshrrev_b32 v96, 16, v96
    v_lshl_or_b32 v96, v72, 16, v96
    v_lshrrev_b32 v98, 16, v72
    v_mov_b32 v99, 0
    v_mfma_f32_32x32x16_bf16 v[16:31], a[176:179], a[228:231], v[16:31]
    buffer_load_dwordx4 a[212:215], v1, s[4:7], s33 offen offset:2048
    v_cvt_pk_bf16_f32 v101, v74, v75
    v_lshlrev_b32 v100, 16, v101
    v_and_b32 v102, 0xffff0000, v101
    v_sub_f32 v74, v74, v100
    v_sub_f32 v75, v75, v102
    v_mfma_f32_32x32x16_bf16 v[32:47], a[48:51], a[228:231], v[32:47]
    s_waitcnt lgkmcnt(6)
    ds_read_b128 a[248:251], v11 offset:1024
    v_cvt_pk_bf16_f32 v74, v74, v75
    v_lshrrev_b32 v100, 16, v100
    v_lshl_or_b32 v100, v74, 16, v100
    v_lshrrev_b32 v102, 16, v74
    v_mov_b32 v103, 0
    v_mfma_f32_32x32x16_bf16 v[16:31], a[180:183], a[232:235], v[16:31]
    buffer_load_dwordx4 a[216:219], v1, s[4:7], s31 offen sc1
    v_mfma_f32_32x32x16_bf16 v[32:47], a[52:55], a[232:235], v[32:47]
    s_waitcnt lgkmcnt(3)
    ds_read_b128 a[228:231], v11 offset:2048
    v_mfma_f32_32x32x16_bf16 v[16:31], a[184:187], a[236:239], v[16:31]
    s_add_u32 s31, s31, 32768
    buffer_load_dwordx4 a[220:223], v1, s[4:7], s31 offen sc1
    v_mfma_f32_32x32x16_bf16 v[32:47], a[56:59], a[236:239], v[32:47]
    s_waitcnt lgkmcnt(3)
    ds_read_b128 a[232:235], v11 offset:3072
    v_mfma_f32_32x32x16_bf16 v[16:31], a[188:191], a[240:243], v[16:31]
    s_add_u32 s31, s31, 32768
    buffer_load_dwordx2 a[224:225], v7, s[44:47], s30 offen offset:0
    v_mfma_f32_32x32x16_bf16 v[32:47], a[60:63], a[240:243], v[32:47]
    s_waitcnt lgkmcnt(3)
    ds_read_b128 a[236:239], v11 offset:8192
    v_mfma_f32_32x32x16_bf16 v[16:31], v[92:95], v[96:99], v[16:31]
    s_waitcnt lgkmcnt(4)
    buffer_load_dwordx2 a[226:227], v7, s[44:47], s30 offen offset:16
    v_mfma_f32_32x32x16_bf16 v[32:47], a[64:67], a[244:247], v[32:47]
    s_waitcnt lgkmcnt(3)
    ds_read_b128 a[240:243], v11 offset:9216
    v_mfma_f32_32x32x16_bf16 v[32:47], a[68:71], a[248:251], v[32:47]
    s_waitcnt lgkmcnt(3)
    ds_read_b128 a[244:247], v11 offset:10240
    s_nop 3
    ds_write_b128 v12, v[24:27] offset:0
    ds_write_b128 v12, v[28:31] offset:1024
    v_mfma_f32_32x32x16_bf16 v[32:47], a[72:75], a[228:231], v[32:47]
    s_waitcnt lgkmcnt(5)
    ds_read_b128 a[248:251], v11 offset:11264
    v_mfma_f32_32x32x16_bf16 v[32:47], a[76:79], a[232:235], v[32:47]
    s_waitcnt lgkmcnt(5)
    ds_read_b128 a[228:231], v11 offset:4096
    s_waitcnt vmcnt(10) lgkmcnt(2)
    s_barrier
    ds_read_b128 v[24:27], v3 offset:0
    ds_read_b128 v[28:31], v3 offset:1024
    v_mfma_f32_32x32x16_bf16 v[32:47], a[96:99], a[236:239], v[32:47]
    s_waitcnt lgkmcnt(7)
    ds_read_b128 a[232:235], v11 offset:5120
    v_mfma_f32_32x32x16_bf16 v[32:47], a[100:103], a[240:243], v[32:47]
    s_waitcnt lgkmcnt(7)
    ds_read_b128 a[236:239], v11 offset:6144
    v_mfma_f32_32x32x16_bf16 v[32:47], a[104:107], a[244:247], v[32:47]
    s_waitcnt lgkmcnt(5)
    ds_read_b128 a[240:243], v11 offset:7168
    v_mfma_f32_32x32x16_bf16 v[32:47], a[108:111], a[248:251], v[32:47]
    s_waitcnt lgkmcnt(5)
    ds_read_b128 a[244:247], v11 offset:12288
    s_waitcnt lgkmcnt(4)
    v_add_f32 v64, v16, v24
    v_add_f32 v65, v17, v25
    v_add_f32 v66, v18, v26
    v_add_f32 v67, v19, v27
    v_add_f32 v68, v20, v28
    v_add_f32 v69, v21, v29
    v_mfma_f32_32x32x16_bf16 v[32:47], a[80:83], a[228:231], v[32:47]
    s_waitcnt lgkmcnt(3)
    ds_read_b128 a[248:251], v11 offset:13312
    v_add_f32 v70, v22, v30
    v_add_f32 v71, v23, v31
    v_mul_f32 v72, v64, v252
    v_mul_f32 v73, v65, v252
    v_mul_f32 v74, v66, v252
    v_mfma_f32_32x32x16_bf16 v[32:47], a[84:87], a[232:235], v[32:47]
    s_waitcnt lgkmcnt(3)
    ds_read_b128 a[228:231], v11 offset:14336
    v_mul_f32 v75, v67, v252
    v_mul_f32 v76, v72, v72
    v_mul_f32 v77, v73, v73
    v_mul_f32 v78, v74, v74
    v_mul_f32 v79, v75, v75
    v_fma_f32 v76, v76, s32, v4
    v_mfma_f32_32x32x16_bf16 v[32:47], a[88:91], a[236:239], v[32:47]
    s_waitcnt lgkmcnt(3)
    ds_read_b128 a[232:235], v11 offset:15360
    v_fma_f32 v77, v77, s32, v4
    v_fma_f32 v78, v78, s32, v4
    v_fma_f32 v79, v79, s32, v4
    v_mul_f32 v76, v76, v72
    v_mul_f32 v77, v77, v73
    v_mfma_f32_32x32x16_bf16 v[32:47], a[92:95], a[240:243], v[32:47]
    s_waitcnt lgkmcnt(3)
    ds_read_b128 a[236:239], v10 offset:32768
    v_mul_f32 v78, v78, v74
    v_mul_f32 v79, v79, v75
    v_exp_f32 v76, v76
    v_exp_f32 v77, v77
    v_mfma_f32_32x32x16_bf16 v[32:47], a[112:115], a[244:247], v[32:47]
    s_waitcnt lgkmcnt(3)
    ds_read_b128 a[240:243], v10 offset:33792
    v_exp_f32 v78, v78
    v_exp_f32 v79, v79
    v_add_f32 v76, 1.0, v76
    v_mfma_f32_32x32x16_bf16 v[32:47], a[116:119], a[248:251], v[32:47]
    s_waitcnt lgkmcnt(3)
    ds_read_b128 a[244:247], v10 offset:34816
    v_add_f32 v77, 1.0, v77
    v_add_f32 v78, 1.0, v78
    v_add_f32 v79, 1.0, v79
    v_rcp_f32 v76, v76
    v_mfma_f32_32x32x16_bf16 v[32:47], a[120:123], a[228:231], v[32:47]
    s_waitcnt lgkmcnt(3)
    ds_read_b128 a[248:251], v10 offset:35840
    v_rcp_f32 v77, v77
    v_rcp_f32 v78, v78
    v_rcp_f32 v79, v79
    v_mfma_f32_32x32x16_bf16 v[32:47], a[124:127], a[232:235], v[32:47]
    s_waitcnt lgkmcnt(3)
    ds_read_b128 a[228:231], v10 offset:40960
    v_mul_f32 v72, v72, v76
    v_mul_f32 v73, v73, v77
    v_mul_f32 v74, v74, v78
    v_mul_f32 v75, v75, v79
    v_cvt_pk_bf16_f32 v80, v72, v73
    v_mfma_f32_32x32x16_bf16 v[32:47], v[88:91], v[96:99], v[32:47]
    s_waitcnt lgkmcnt(4)
    v_cvt_pk_bf16_f32 v81, v74, v75
    v_mul_f32 v72, v68, v252
    v_mul_f32 v73, v69, v252
    v_mul_f32 v74, v70, v252
    v_mul_f32 v75, v71, v252
    v_mul_f32 v76, v72, v72
    v_mul_f32 v77, v73, v73
    v_mfma_f32_32x32x16_bf16 v[16:31], a[128:131], a[236:239], 0
    v_mul_f32 v78, v74, v74
    v_mul_f32 v79, v75, v75
    v_fma_f32 v76, v76, s32, v4
    v_fma_f32 v77, v77, s32, v4
    v_fma_f32 v78, v78, s32, v4
    v_fma_f32 v79, v79, s32, v4
    v_mfma_f32_32x32x16_bf16 v[48:63], a[0:3], a[236:239], 0
    s_waitcnt lgkmcnt(3)
    ds_read_b128 a[232:235], v10 offset:41984
    v_mul_f32 v76, v76, v72
    v_mul_f32 v77, v77, v73
    v_mul_f32 v78, v78, v74
    v_mul_f32 v79, v79, v75
    v_exp_f32 v76, v76
    v_mfma_f32_32x32x16_bf16 v[16:31], a[132:135], a[240:243], v[16:31]
    v_exp_f32 v77, v77
    v_exp_f32 v78, v78
    v_exp_f32 v79, v79
    v_mfma_f32_32x32x16_bf16 v[48:63], a[4:7], a[240:243], v[48:63]
    s_waitcnt lgkmcnt(3)
    ds_read_b128 a[236:239], v10 offset:43008
    v_add_f32 v76, 1.0, v76
    v_add_f32 v77, 1.0, v77
    v_add_f32 v78, 1.0, v78
    v_add_f32 v79, 1.0, v79
    v_rcp_f32 v76, v76
    v_mfma_f32_32x32x16_bf16 v[16:31], a[136:139], a[244:247], v[16:31]
    v_rcp_f32 v77, v77
    v_rcp_f32 v78, v78
    v_rcp_f32 v79, v79
    v_mfma_f32_32x32x16_bf16 v[48:63], a[8:11], a[244:247], v[48:63]
    s_waitcnt lgkmcnt(3)
    ds_read_b128 a[240:243], v10 offset:44032
    v_mul_f32 v72, v72, v76
    v_mul_f32 v73, v73, v77
    v_mul_f32 v74, v74, v78
    v_mul_f32 v75, v75, v79
    v_cvt_pk_bf16_f32 v82, v72, v73
    v_cvt_pk_bf16_f32 v83, v74, v75
    v_mfma_f32_32x32x16_bf16 v[16:31], a[140:143], a[248:251], v[16:31]
    buffer_store_dwordx4 v[80:83], v1, s[4:7], s29 offen sc1
    v_mul_f32 v72, v32, v252
    v_mul_f32 v73, v33, v252
    v_mul_f32 v74, v34, v252
    v_mul_f32 v75, v35, v252
    v_mfma_f32_32x32x16_bf16 v[48:63], a[12:15], a[248:251], v[48:63]
    s_waitcnt lgkmcnt(3)
    ds_read_b128 a[244:247], v10 offset:36864
    v_mul_f32 v76, v72, v72
    v_mul_f32 v77, v73, v73
    v_mul_f32 v78, v74, v74
    v_mul_f32 v79, v75, v75
    v_fma_f32 v76, v76, s32, v4
    v_fma_f32 v77, v77, s32, v4
    v_mfma_f32_32x32x16_bf16 v[16:31], a[160:163], a[228:231], v[16:31]
    v_fma_f32 v78, v78, s32, v4
    v_fma_f32 v79, v79, s32, v4
    v_mul_f32 v76, v76, v72
    v_mul_f32 v77, v77, v73
    v_mul_f32 v78, v78, v74
    v_mul_f32 v79, v79, v75
    v_mfma_f32_32x32x16_bf16 v[48:63], a[32:35], a[228:231], v[48:63]
    s_waitcnt lgkmcnt(3)
    ds_read_b128 a[248:251], v10 offset:37888
    v_exp_f32 v76, v76
    v_exp_f32 v77, v77
    v_exp_f32 v78, v78
    v_mfma_f32_32x32x16_bf16 v[16:31], a[164:167], a[232:235], v[16:31]
    v_exp_f32 v79, v79
    v_add_f32 v76, 1.0, v76
    v_add_f32 v77, 1.0, v77
    v_add_f32 v78, 1.0, v78
    v_add_f32 v79, 1.0, v79
    v_mfma_f32_32x32x16_bf16 v[48:63], a[36:39], a[232:235], v[48:63]
    s_waitcnt lgkmcnt(3)
    ds_read_b128 a[228:231], v10 offset:38912
    v_rcp_f32 v76, v76
    v_rcp_f32 v77, v77
    v_rcp_f32 v78, v78
    v_mfma_f32_32x32x16_bf16 v[16:31], a[168:171], a[236:239], v[16:31]
    v_rcp_f32 v79, v79
    v_mul_f32 v72, v72, v76
    v_mul_f32 v73, v73, v77
    v_mul_f32 v74, v74, v78
    v_mul_f32 v75, v75, v79
    v_mfma_f32_32x32x16_bf16 v[48:63], a[40:43], a[236:239], v[48:63]
    s_waitcnt lgkmcnt(3)
    ds_read_b128 a[232:235], v10 offset:39936
    v_cvt_pk_bf16_f32 v84, v72, v73
    v_cvt_pk_bf16_f32 v85, v74, v75
    v_mul_f32 v72, v36, v252
    v_mul_f32 v73, v37, v252
    v_mul_f32 v74, v38, v252
    v_mul_f32 v75, v39, v252
    v_mfma_f32_32x32x16_bf16 v[16:31], a[172:175], a[240:243], v[16:31]
    v_mul_f32 v76, v72, v72
    v_mul_f32 v77, v73, v73
    v_mul_f32 v78, v74, v74
    v_mul_f32 v79, v75, v75
    v_fma_f32 v76, v76, s32, v4
    v_fma_f32 v77, v77, s32, v4
    v_mfma_f32_32x32x16_bf16 v[48:63], a[44:47], a[240:243], v[48:63]
    s_waitcnt lgkmcnt(3)
    ds_read_b128 a[236:239], v10 offset:45056
    v_fma_f32 v78, v78, s32, v4
    v_fma_f32 v79, v79, s32, v4
    v_mul_f32 v76, v76, v72
    v_mul_f32 v77, v77, v73
    v_mul_f32 v78, v78, v74
    v_mul_f32 v79, v79, v75
    v_mfma_f32_32x32x16_bf16 v[16:31], a[144:147], a[244:247], v[16:31]
    v_exp_f32 v76, v76
    v_exp_f32 v77, v77
    v_exp_f32 v78, v78
    v_mfma_f32_32x32x16_bf16 v[48:63], a[16:19], a[244:247], v[48:63]
    s_waitcnt lgkmcnt(3)
    ds_read_b128 a[240:243], v10 offset:46080
    v_exp_f32 v79, v79
    v_add_f32 v76, 1.0, v76
    v_add_f32 v77, 1.0, v77
    v_add_f32 v78, 1.0, v78
    v_add_f32 v79, 1.0, v79
    v_mfma_f32_32x32x16_bf16 v[16:31], a[148:151], a[248:251], v[16:31]
    v_rcp_f32 v76, v76
    v_rcp_f32 v77, v77
    v_rcp_f32 v78, v78
    v_mfma_f32_32x32x16_bf16 v[48:63], a[20:23], a[248:251], v[48:63]
    s_waitcnt lgkmcnt(3)
    ds_read_b128 a[244:247], v10 offset:47104
    v_rcp_f32 v79, v79
    v_mul_f32 v72, v72, v76
    v_mul_f32 v73, v73, v77
    v_mul_f32 v74, v74, v78
    v_mul_f32 v75, v75, v79
    v_mfma_f32_32x32x16_bf16 v[16:31], a[152:155], a[228:231], v[16:31]
    v_cvt_pk_bf16_f32 v86, v72, v73
    v_cvt_pk_bf16_f32 v87, v74, v75
    buffer_store_dwordx4 v[84:87], v1, s[4:7], s28 offen sc1
    v_mul_f32 v72, v40, v252
    v_mul_f32 v73, v41, v252
    v_mfma_f32_32x32x16_bf16 v[48:63], a[24:27], a[228:231], v[48:63]
    s_waitcnt lgkmcnt(3)
    ds_read_b128 a[248:251], v10 offset:48128
    v_mul_f32 v74, v42, v252
    v_mul_f32 v75, v43, v252
    v_mul_f32 v76, v72, v72
    v_mul_f32 v77, v73, v73
    v_mul_f32 v78, v74, v74
    v_mul_f32 v79, v75, v75
    v_mfma_f32_32x32x16_bf16 v[16:31], a[156:159], a[232:235], v[16:31]
    v_fma_f32 v76, v76, s32, v4
    v_fma_f32 v77, v77, s32, v4
    v_fma_f32 v78, v78, s32, v4
    v_fma_f32 v79, v79, s32, v4
    v_mul_f32 v76, v76, v72
    v_mul_f32 v77, v77, v73
    v_mfma_f32_32x32x16_bf16 v[48:63], a[28:31], a[232:235], v[48:63]
    s_waitcnt lgkmcnt(3)
    ds_read_b128 a[228:231], v11 offset:32768
    v_mul_f32 v78, v78, v74
    v_mul_f32 v79, v79, v75
    v_exp_f32 v76, v76
    v_exp_f32 v77, v77
    v_mfma_f32_32x32x16_bf16 v[16:31], a[176:179], a[236:239], v[16:31]
    v_exp_f32 v78, v78
    v_exp_f32 v79, v79
    v_add_f32 v76, 1.0, v76
    v_add_f32 v77, 1.0, v77
    v_mfma_f32_32x32x16_bf16 v[48:63], a[48:51], a[236:239], v[48:63]
    s_waitcnt lgkmcnt(3)
    ds_read_b128 a[232:235], v11 offset:33792
    v_add_f32 v78, 1.0, v78
    v_add_f32 v79, 1.0, v79
    v_rcp_f32 v76, v76
    v_rcp_f32 v77, v77
    v_mfma_f32_32x32x16_bf16 v[16:31], a[180:183], a[240:243], v[16:31]
    v_rcp_f32 v78, v78
    v_rcp_f32 v79, v79
    v_mul_f32 v72, v72, v76
    v_mul_f32 v73, v73, v77
    v_mfma_f32_32x32x16_bf16 v[48:63], a[52:55], a[240:243], v[48:63]
    s_waitcnt lgkmcnt(3)
    ds_read_b128 a[236:239], v11 offset:34816
    v_mul_f32 v74, v74, v78
    v_mul_f32 v75, v75, v79
    v_cvt_pk_bf16_f32 v80, v72, v73
    v_cvt_pk_bf16_f32 v81, v74, v75
    v_mul_f32 v72, v44, v252
    v_mul_f32 v73, v45, v252
    v_mfma_f32_32x32x16_bf16 v[16:31], a[184:187], a[244:247], v[16:31]
    v_mul_f32 v74, v46, v252
    v_mul_f32 v75, v47, v252
    v_mul_f32 v76, v72, v72
    v_mul_f32 v77, v73, v73
    v_mul_f32 v78, v74, v74
    v_mul_f32 v79, v75, v75
    v_mfma_f32_32x32x16_bf16 v[48:63], a[56:59], a[244:247], v[48:63]
    s_waitcnt lgkmcnt(3)
    ds_read_b128 a[240:243], v11 offset:35840
    v_fma_f32 v76, v76, s32, v4
    v_fma_f32 v77, v77, s32, v4
    v_fma_f32 v78, v78, s32, v4
    v_fma_f32 v79, v79, s32, v4
    v_mul_f32 v76, v76, v72
    v_mul_f32 v77, v77, v73
    v_mfma_f32_32x32x16_bf16 v[16:31], a[188:191], a[248:251], v[16:31]
    v_mul_f32 v78, v78, v74
    v_mul_f32 v79, v79, v75
    v_exp_f32 v76, v76
    v_exp_f32 v77, v77
    v_mfma_f32_32x32x16_bf16 v[48:63], a[60:63], a[248:251], v[48:63]
    s_waitcnt lgkmcnt(3)
    ds_read_b128 a[244:247], v11 offset:40960
    v_exp_f32 v78, v78
    v_exp_f32 v79, v79
    v_add_f32 v76, 1.0, v76
    v_add_f32 v77, 1.0, v77
    v_mfma_f32_32x32x16_bf16 v[16:31], v[92:95], v[100:103], v[16:31]
    s_waitcnt lgkmcnt(4)
    v_add_f32 v78, 1.0, v78
    v_add_f32 v79, 1.0, v79
    v_rcp_f32 v76, v76
    v_rcp_f32 v77, v77
    v_mfma_f32_32x32x16_bf16 v[48:63], a[64:67], a[228:231], v[48:63]
    s_waitcnt lgkmcnt(3)
    ds_read_b128 a[248:251], v11 offset:41984
    v_rcp_f32 v78, v78
    v_rcp_f32 v79, v79
    v_mul_f32 v72, v72, v76
    v_mul_f32 v73, v73, v77
    v_mfma_f32_32x32x16_bf16 v[48:63], a[68:71], a[232:235], v[48:63]
    s_waitcnt lgkmcnt(3)
    ds_read_b128 a[228:231], v11 offset:43008
    v_mul_f32 v74, v74, v78
    v_mul_f32 v75, v75, v79
    v_cvt_pk_bf16_f32 v82, v72, v73
    v_cvt_pk_bf16_f32 v83, v74, v75
    buffer_store_dwordx4 v[80:83], v1, s[4:7], s28 offen offset:1024 sc1
    ds_write_b128 v12, v[24:27] offset:2048
    ds_write_b128 v12, v[28:31] offset:3072
    v_mfma_f32_32x32x16_bf16 v[48:63], a[72:75], a[236:239], v[48:63]
    s_waitcnt lgkmcnt(5)
    ds_read_b128 a[232:235], v11 offset:44032
    s_add_u32 s28, s28, 98304
    s_add_u32 s29, s29, 98304
    v_mfma_f32_32x32x16_bf16 v[48:63], a[76:79], a[240:243], v[48:63]
    s_waitcnt lgkmcnt(5)
    ds_read_b128 a[236:239], v11 offset:36864
    s_waitcnt lgkmcnt(2)
    s_barrier
    ds_read_b128 v[24:27], v3 offset:2048
    ds_read_b128 v[28:31], v3 offset:3072
    v_mfma_f32_32x32x16_bf16 v[48:63], a[96:99], a[244:247], v[48:63]
    s_waitcnt lgkmcnt(7)
    ds_read_b128 a[240:243], v11 offset:37888
    v_mfma_f32_32x32x16_bf16 v[48:63], a[100:103], a[248:251], v[48:63]
    s_waitcnt lgkmcnt(7)
    ds_read_b128 a[244:247], v11 offset:38912
    v_mfma_f32_32x32x16_bf16 v[48:63], a[104:107], a[228:231], v[48:63]
    s_waitcnt lgkmcnt(5)
    ds_read_b128 a[248:251], v11 offset:39936
    v_mfma_f32_32x32x16_bf16 v[48:63], a[108:111], a[232:235], v[48:63]
    s_waitcnt lgkmcnt(5)
    ds_read_b128 a[228:231], v11 offset:45056
    s_waitcnt lgkmcnt(4)
    v_add_f32 v64, v16, v24
    v_add_f32 v65, v17, v25
    v_add_f32 v66, v18, v26
    v_add_f32 v67, v19, v27
    v_add_f32 v68, v20, v28
    v_add_f32 v69, v21, v29
    v_mfma_f32_32x32x16_bf16 v[48:63], a[80:83], a[236:239], v[48:63]
    s_waitcnt lgkmcnt(3)
    ds_read_b128 a[232:235], v11 offset:46080
    v_add_f32 v70, v22, v30
    v_add_f32 v71, v23, v31
    v_mul_f32 v72, v64, v253
    v_mul_f32 v73, v65, v253
    v_mul_f32 v74, v66, v253
    v_mfma_f32_32x32x16_bf16 v[48:63], a[84:87], a[240:243], v[48:63]
    s_waitcnt lgkmcnt(3)
    ds_read_b128 a[236:239], v11 offset:47104
    v_mul_f32 v75, v67, v253
    v_mul_f32 v76, v72, v72
    v_mul_f32 v77, v73, v73
    v_mul_f32 v78, v74, v74
    v_mul_f32 v79, v75, v75
    v_fma_f32 v76, v76, s32, v4
    v_mfma_f32_32x32x16_bf16 v[48:63], a[88:91], a[244:247], v[48:63]
    s_waitcnt lgkmcnt(3)
    ds_read_b128 a[240:243], v11 offset:48128
    v_fma_f32 v77, v77, s32, v4
    v_fma_f32 v78, v78, s32, v4
    v_fma_f32 v79, v79, s32, v4
    v_mul_f32 v76, v76, v72
    v_mul_f32 v77, v77, v73
    v_mfma_f32_32x32x16_bf16 v[48:63], a[92:95], a[248:251], v[48:63]
    s_waitcnt lgkmcnt(3)
    v_mul_f32 v78, v78, v74
    v_mul_f32 v79, v79, v75
    v_exp_f32 v76, v76
    v_exp_f32 v77, v77
    v_mfma_f32_32x32x16_bf16 v[48:63], a[112:115], a[228:231], v[48:63]
    s_waitcnt lgkmcnt(2)
    v_exp_f32 v78, v78
    v_exp_f32 v79, v79
    v_add_f32 v76, 1.0, v76
    v_add_f32 v77, 1.0, v77
    v_add_f32 v78, 1.0, v78
    v_mfma_f32_32x32x16_bf16 v[48:63], a[116:119], a[232:235], v[48:63]
    s_waitcnt lgkmcnt(1)
    v_add_f32 v79, 1.0, v79
    v_rcp_f32 v76, v76
    v_rcp_f32 v77, v77
    v_rcp_f32 v78, v78
    v_mfma_f32_32x32x16_bf16 v[48:63], a[120:123], a[236:239], v[48:63]
    s_waitcnt lgkmcnt(0)
    v_rcp_f32 v79, v79
    v_mul_f32 v72, v72, v76
    v_mul_f32 v73, v73, v77
    v_mul_f32 v74, v74, v78
    v_mul_f32 v75, v75, v79
    v_mfma_f32_32x32x16_bf16 v[48:63], a[124:127], a[240:243], v[48:63]
    v_cvt_pk_bf16_f32 v84, v72, v73
    v_cvt_pk_bf16_f32 v85, v74, v75
    v_mul_f32 v72, v68, v253
    v_mul_f32 v73, v69, v253
    v_mul_f32 v74, v70, v253
    v_mul_f32 v75, v71, v253
    v_mfma_f32_32x32x16_bf16 v[48:63], v[88:91], v[100:103], v[48:63]
    v_mul_f32 v76, v72, v72
    v_mul_f32 v77, v73, v73
    v_mul_f32 v78, v74, v74
    v_mul_f32 v79, v75, v75
    v_fma_f32 v76, v76, s32, v4
    v_fma_f32 v77, v77, s32, v4
    v_fma_f32 v78, v78, s32, v4
    v_fma_f32 v79, v79, s32, v4
    v_mul_f32 v76, v76, v72
    v_mul_f32 v77, v77, v73
    v_mul_f32 v78, v78, v74
    v_mul_f32 v79, v79, v75
    v_exp_f32 v76, v76
    v_exp_f32 v77, v77
    v_exp_f32 v78, v78
    v_exp_f32 v79, v79
    v_add_f32 v76, 1.0, v76
    v_add_f32 v77, 1.0, v77
    v_add_f32 v78, 1.0, v78
    v_add_f32 v79, 1.0, v79
    v_rcp_f32 v76, v76
    v_rcp_f32 v77, v77
    v_rcp_f32 v78, v78
    v_rcp_f32 v79, v79
    v_mul_f32 v72, v72, v76
    v_mul_f32 v73, v73, v77
    v_mul_f32 v74, v74, v78
    v_mul_f32 v75, v75, v79
    v_cvt_pk_bf16_f32 v86, v72, v73
    v_cvt_pk_bf16_f32 v87, v74, v75
    buffer_store_dwordx4 v[84:87], v1, s[4:7], s29 offen sc1
    v_pk_mul_f32 v[48:49], v[48:49], v[252:253] op_sel:[0,1] op_sel_hi:[1,1]
    v_pk_mul_f32 v[50:51], v[50:51], v[252:253] op_sel:[0,1] op_sel_hi:[1,1]
    v_pk_mul_f32 v[52:53], v[52:53], v[252:253] op_sel:[0,1] op_sel_hi:[1,1]
    v_pk_mul_f32 v[54:55], v[54:55], v[252:253] op_sel:[0,1] op_sel_hi:[1,1]
    s_waitcnt vmcnt(1)
    s_barrier
    s_cmp_lg_u32 s8, 0
    s_cbranch_scc1 L_arr12
    s_atomic_add s36, s[14:15], 1152
L_arr12:
    s_mul_i32 s22, s9, 196608
    s_mul_i32 s23, s54, 44032
    s_add_u32 s22, s22, s23
    s_and_b32 s23, s8, 1
    s_mul_i32 s23, s23, 22528
    s_add_u32 s22, s22, s23
    s_lshl_b32 s23, s8, 15
    s_add_u32 s22, s22, s13
    s_add_u32 s22, s22, 12582912
    v_pk_mul_f32 v[56:57], v[56:57], v[252:253] op_sel:[0,1] op_sel_hi:[1,1]
    v_pk_mul_f32 v[58:59], v[58:59], v[252:253] op_sel:[0,1] op_sel_hi:[1,1]
    v_pk_mul_f32 v[60:61], v[60:61], v[252:253] op_sel:[0,1] op_sel_hi:[1,1]
    v_pk_mul_f32 v[62:63], v[62:63], v[252:253] op_sel:[0,1] op_sel_hi:[1,1]
    v_pk_mul_f32 v[32:33], v[48:49], v[48:49]
    v_pk_mul_f32 v[34:35], v[50:51], v[50:51]
    v_pk_mul_f32 v[36:37], v[52:53], v[52:53]
    v_pk_mul_f32 v[38:39], v[54:55], v[54:55]
    v_pk_mul_f32 v[40:41], v[56:57], v[56:57]
    v_pk_mul_f32 v[42:43], v[58:59], v[58:59]
    v_pk_mul_f32 v[44:45], v[60:61], v[60:61]
    v_pk_mul_f32 v[46:47], v[62:63], v[62:63]
    v_pk_fma_f32 v[32:33], v[32:33], v[4:5], v[4:5] op_sel:[0,1,0] op_sel_hi:[1,1,0]
    v_pk_fma_f32 v[34:35], v[34:35], v[4:5], v[4:5] op_sel:[0,1,0] op_sel_hi:[1,1,0]
    v_pk_fma_f32 v[36:37], v[36:37], v[4:5], v[4:5] op_sel:[0,1,0] op_sel_hi:[1,1,0]
    v_pk_fma_f32 v[38:39], v[38:39], v[4:5], v[4:5] op_sel:[0,1,0] op_sel_hi:[1,1,0]
    v_pk_fma_f32 v[40:41], v[40:41], v[4:5], v[4:5] op_sel:[0,1,0] op_sel_hi:[1,1,0]
    v_pk_fma_f32 v[42:43], v[42:43], v[4:5], v[4:5] op_sel:[0,1,0] op_sel_hi:[1,1,0]
    v_pk_fma_f32 v[44:45], v[44:45], v[4:5], v[4:5] op_sel:[0,1,0] op_sel_hi:[1,1,0]
    v_pk_fma_f32 v[46:47], v[46:47], v[4:5], v[4:5] op_sel:[0,1,0] op_sel_hi:[1,1,0]
    v_pk_mul_f32 v[32:33], v[32:33], v[48:49]
    v_pk_mul_f32 v[34:35], v[34:35], v[50:51]
    v_pk_mul_f32 v[36:37], v[36:37], v[52:53]
    v_pk_mul_f32 v[38:39], v[38:39], v[54:55]
    v_pk_mul_f32 v[40:41], v[40:41], v[56:57]
    v_pk_mul_f32 v[42:43], v[42:43], v[58:59]
    v_pk_mul_f32 v[44:45], v[44:45], v[60:61]
    v_pk_mul_f32 v[46:47], v[46:47], v[62:63]
    v_exp_f32 v32, v32
    v_exp_f32 v33, v33
    v_exp_f32 v34, v34
    v_exp_f32 v35, v35
    v_exp_f32 v36, v36
    v_exp_f32 v37, v37
    v_exp_f32 v38, v38
    v_exp_f32 v39, v39
    v_exp_f32 v40, v40
    v_exp_f32 v41, v41
    v_exp_f32 v42, v42
    v_exp_f32 v43, v43
    v_exp_f32 v44, v44
    v_exp_f32 v45, v45
    v_exp_f32 v46, v46
    v_exp_f32 v47, v47
    v_pk_add_f32 v[32:33], v[32:33], 1.0 op_sel_hi:[1,0]
    v_pk_add_f32 v[34:35], v[34:35], 1.0 op_sel_hi:[1,0]
    v_pk_add_f32 v[36:37], v[36:37], 1.0 op_sel_hi:[1,0]
    v_pk_add_f32 v[38:39], v[38:39], 1.0 op_sel_hi:[1,0]
    v_pk_add_f32 v[40:41], v[40:41], 1.0 op_sel_hi:[1,0]
    v_pk_add_f32 v[42:43], v[42:43], 1.0 op_sel_hi:[1,0]
    v_pk_add_f32 v[44:45], v[44:45], 1.0 op_sel_hi:[1,0]
    v_pk_add_f32 v[46:47], v[46:47], 1.0 op_sel_hi:[1,0]
    v_rcp_f32 v32, v32
    v_rcp_f32 v33, v33
    v_rcp_f32 v34, v34
    v_rcp_f32 v35, v35
    v_rcp_f32 v36, v36
    v_rcp_f32 v37, v37
    v_rcp_f32 v38, v38
    v_rcp_f32 v39, v39
    v_rcp_f32 v40, v40
    v_rcp_f32 v41, v41
    v_rcp_f32 v42, v42
    v_rcp_f32 v43, v43
    v_rcp_f32 v44, v44
    v_rcp_f32 v45, v45
    v_rcp_f32 v46, v46
    v_rcp_f32 v47, v47
    v_pk_mul_f32 v[48:49], v[48:49], v[32:33]
    v_pk_mul_f32 v[50:51], v[50:51], v[34:35]
    v_pk_mul_f32 v[52:53], v[52:53], v[36:37]
    v_pk_mul_f32 v[54:55], v[54:55], v[38:39]
    v_pk_mul_f32 v[56:57], v[56:57], v[40:41]
    v_pk_mul_f32 v[58:59], v[58:59], v[42:43]
    s_mov_b32 s101, -1
    s_cmp_lg_u32 s8, 1
    s_cbranch_scc1 L_pi13
    s_mov_b32 s101, 0
    s_atomic_add s101, s[14:15], 1152 glc
L_pi13:
    v_pk_mul_f32 v[60:61], v[60:61], v[44:45]
    v_pk_mul_f32 v[62:63], v[62:63], v[46:47]
    v_cvt_pk_bf16_f32 v80, v48, v49
    v_cvt_pk_bf16_f32 v81, v50, v51
    v_cvt_pk_bf16_f32 v82, v52, v53
    v_cvt_pk_bf16_f32 v83, v54, v55
    buffer_store_dwordx4 v[80:83], v1, s[4:7], s28 offen sc1
    v_cvt_pk_bf16_f32 v16, v56, v57
    v_cvt_pk_bf16_f32 v17, v58, v59
    v_cvt_pk_bf16_f32 v18, v60, v61
    v_cvt_pk_bf16_f32 v19, v62, v63
    buffer_store_dwordx4 v[16:19], v1, s[4:7], s28 offen offset:1024 sc1
    s_lshl_b32 s27, s54, 16
    v_add_u32 v11, s27, v1
    v_lshrrev_b32 v2, 5, v0
    v_and_b32 v7, 31, v0
    v_lshlrev_b32 v8, 3, v7
    v_lshl_add_u32 v8, v2, 2, v8
    v_lshlrev_b32 v7, 10, v7
    v_lshl_add_u32 v7, v2, 4, v7
    s_lshl_b32 s28, s8, 12
    s_add_u32 s28, s28, 131072
    v_add_u32 v12, s28, v1
    v_xor_b32 v10, 8192, v12
    s_add_u32 s25, s35, 19922944
    s_lshl_b32 s29, s9, 14
    s_lshl_b32 s30, s53, 10
    s_add_u32 s29, s29, s30
    s_lshl_b32 s30, s54, 9
    s_add_u32 s29, s29, s30
    s_add_u32 s29, s29, s13
    s_add_u32 s29, s29, 38797312
    s_cmp_eq_u32 s11, 0
    s_cselect_b32 s34, 0x10000000, s34
    s_cselect_b32 s25, s25, 0x10000000
    s_cselect_b32 s29, s29, 0x10000000
    v_accvgpr_read_b32 v72, a216
    v_accvgpr_read_b32 v73, a217
    v_accvgpr_read_b32 v74, a218
    v_accvgpr_read_b32 v75, a219
    v_accvgpr_read_b32 v76, a220
    v_accvgpr_read_b32 v77, a221
    v_accvgpr_read_b32 v78, a222
    v_accvgpr_read_b32 v79, a223
    v_accvgpr_read_b32 v80, a224
    v_accvgpr_read_b32 v81, a225
    v_accvgpr_read_b32 v82, a226
    s_waitcnt lgkmcnt(0)
    s_cmp_ge_u32 s101, 8
    s_cbranch_scc0 L_chk14_s
L_chk14:
    s_barrier
    s_add_u32 m0, s23, 0
    s_nop 0
    buffer_load_dwordx4 v1, s[4:7], s22 offen offset:0 sc1 lds
    buffer_load_dwordx4 v1, s[4:7], s22 offen offset:1024 sc1 lds
    buffer_load_dwordx4 v1, s[4:7], s22 offen offset:2048 sc1 lds
    buffer_load_dwordx4 v1, s[4:7], s22 offen offset:3072 sc1 lds
    s_add_u32 m0, s23, 4096
    s_add_u32 s22, s22, 4096
    buffer_load_dwordx4 v1, s[4:7], s22 offen offset:0 sc1 lds
    buffer_load_dwordx4 v1, s[4:7], s22 offen offset:1024 sc1 lds
    buffer_load_dwordx4 v1, s[4:7], s22 offen offset:2048 sc1 lds
    buffer_load_dwordx4 v1, s[4:7], s22 offen offset:3072 sc1 lds
    s_add_u32 m0, s23, 8192
    s_add_u32 s22, s22, 4096
    buffer_load_dwordx4 v1, s[4:7], s22 offen offset:0 sc1 lds
    buffer_load_dwordx4 v1, s[4:7], s22 offen offset:1024 sc1 lds
    buffer_load_dwordx4 v1, s[4:7], s22 offen offset:2048 sc1 lds
    buffer_load_dwordx4 v1, s[4:7], s22 offen offset:3072 sc1 lds
    v_accvgpr_read_b32 v83, a227
    v_lshlrev_b32 v100, 16, v80
    v_and_b32 v80, 0xffff0000, v80
    v_lshlrev_b32 v101, 16, v81
    v_and_b32 v81, 0xffff0000, v81
    v_lshlrev_b32 v102, 16, v82
    v_and_b32 v82, 0xffff0000, v82
    v_lshlrev_b32 v103, 16, v83
    v_and_b32 v83, 0xffff0000, v83
    v_lshlrev_b32 v84, 16, v72
    v_and_b32 v85, 0xffff0000, v72
    v_add_f32 v84, v84, v100
    v_add_f32 v85, v85, v80
    v_lshlrev_b32 v86, 16, v73
    v_and_b32 v87, 0xffff0000, v73
    v_add_f32 v86, v86, v101
    v_add_f32 v87, v87, v81
    v_lshlrev_b32 v88, 16, v74
    v_and_b32 v89, 0xffff0000, v74
    v_add_f32 v88, v88, v102
    v_add_f32 v89, v89, v82
    v_lshlrev_b32 v90, 16, v75
    v_and_b32 v91, 0xffff0000, v75
    v_add_f32 v90, v90, v103
    v_add_f32 v91, v91, v83
    v_lshlrev_b32 v92, 16, v76
    v_and_b32 v93, 0xffff0000, v76
    v_add_f32 v92, v92, v100
    v_add_f32 v93, v93, v80
    v_lshlrev_b32 v94, 16, v77
    v_and_b32 v95, 0xffff0000, v77
    v_add_f32 v94, v94, v101
    v_add_f32 v95, v95, v81
    v_lshlrev_b32 v96, 16, v78
    v_and_b32 v97, 0xffff0000, v78
    v_add_f32 v96, v96, v102
    v_add_f32 v97, v97, v82
    v_lshlrev_b32 v98, 16, v79
    v_and_b32 v99, 0xffff0000, v79
    v_add_f32 v98, v98, v103
    v_add_f32 v99, v99, v83
    s_waitcnt vmcnt(12)
    s_barrier
    s_cmp_lg_u32 s8, 0
    s_cbranch_scc1 L_arr15
    s_atomic_add s36, s[14:15], 1280
L_arr15:
    s_waitcnt vmcnt(8)
    s_barrier
    ds_read_b128 v[16:19], v11 offset:0
    ds_read_b128 v[20:23], v11 offset:1024
    ds_read_b128 v[24:27], v11 offset:2048
    ds_read_b128 v[28:31], v11 offset:3072
    ds_read_b128 v[32:35], v11 offset:32768
    s_waitcnt lgkmcnt(4)
    v_mfma_f32_32x32x16_bf16 v[40:55], v[104:107], v[16:19], 0
    s_waitcnt lgkmcnt(3)
    ds_read_b128 v[36:39], v11 offset:33792
    s_add_u32 m0, s23, 12288
    s_add_u32 s22, s22, 4096
    buffer_load_dwordx4 v1, s[4:7], s22 offen offset:0 sc1 lds
    v_mfma_f32_32x32x16_bf16 v[40:55], v[108:111], v[20:23], v[40:55]
    s_waitcnt lgkmcnt(3)
    ds_read_b128 v[16:19], v11 offset:34816
    buffer_load_dwordx4 v1, s[4:7], s22 offen offset:1024 sc1 lds
    v_mfma_f32_32x32x16_bf16 v[40:55], v[112:115], v[24:27], v[40:55]
    s_waitcnt lgkmcnt(3)
    ds_read_b128 v[20:23], v11 offset:35840
    buffer_load_dwordx4 v1, s[4:7], s22 offen offset:2048 sc1 lds
    v_mfma_f32_32x32x16_bf16 v[40:55], v[116:119], v[28:31], v[40:55]
    s_waitcnt lgkmcnt(3)
    s_waitcnt vmcnt(7)
    s_barrier
    ds_read_b128 v[24:27], v11 offset:4096
    buffer_load_dwordx4 v1, s[4:7], s22 offen offset:3072 sc1 lds
    v_mfma_f32_32x32x16_bf16 v[40:55], v[192:195], v[32:35], v[40:55]
    s_waitcnt lgkmcnt(3)
    ds_read_b128 v[28:31], v11 offset:5120
    s_add_u32 m0, s23, 16384
    s_add_u32 s22, s22, 4096
    buffer_load_dwordx4 v1, s[4:7], s22 offen offset:0 sc1 lds
    v_mfma_f32_32x32x16_bf16 v[40:55], v[196:199], v[36:39], v[40:55]
    s_waitcnt lgkmcnt(3)
    ds_read_b128 v[32:35], v11 offset:6144
    v_mfma_f32_32x32x16_bf16 v[40:55], v[200:203], v[16:19], v[40:55]
    s_waitcnt lgkmcnt(3)
    ds_read_b128 v[36:39], v11 offset:7168
    buffer_load_dwordx4 v1, s[4:7], s22 offen offset:1024 sc1 lds
    v_mfma_f32_32x32x16_bf16 v[40:55], v[204:207], v[20:23], v[40:55]
    s_waitcnt lgkmcnt(3)
    ds_read_b128 v[16:19], v11 offset:36864
    v_mfma_f32_32x32x16_bf16 v[40:55], v[120:123], v[24:27], v[40:55]
    s_waitcnt lgkmcnt(3)
    ds_read_b128 v[20:23], v11 offset:37888
    buffer_load_dwordx4 v1, s[4:7], s22 offen offset:2048 sc1 lds
    s_mov_b32 s101, -1
    s_cmp_lg_u32 s8, 1
    s_cbranch_scc1 L_pi16
    s_mov_b32 s101, 0
    s_atomic_add s101, s[14:15], 1280 glc
L_pi16:
    v_mfma_f32_32x32x16_bf16 v[40:55], v[124:127], v[28:31], v[40:55]
    s_waitcnt lgkmcnt(3)
    ds_read_b128 v[24:27], v11 offset:38912
    v_mfma_f32_32x32x16_bf16 v[40:55], v[128:131], v[32:35], v[40:55]
    s_waitcnt lgkmcnt(3)
    ds_read_b128 v[28:31], v11 offset:39936
    buffer_load_dwordx4 v1, s[4:7], s22 offen offset:3072 sc1 lds
    v_mfma_f32_32x32x16_bf16 v[40:55], v[132:135], v[36:39], v[40:55]
    s_waitcnt lgkmcnt(3)
    s_waitcnt vmcnt(8)
    s_barrier
    ds_read_b128 v[32:35], v11 offset:8192
    v_mfma_f32_32x32x16_bf16 v[40:55], v[208:211], v[16:19], v[40:55]
    s_waitcnt lgkmcnt(3)
    ds_read_b128 v[36:39], v11 offset:9216
    s_add_u32 m0, s23, 20480
    s_add_u32 s22, s22, 4096
    buffer_load_dwordx4 v1, s[4:7], s22 offen offset:0 sc1 lds
    v_mfma_f32_32x32x16_bf16 v[40:55], v[212:215], v[20:23], v[40:55]
    s_waitcnt lgkmcnt(3)
    ds_read_b128 v[16:19], v11 offset:10240
    v_mfma_f32_32x32x16_bf16 v[40:55], v[216:219], v[24:27], v[40:55]
    s_waitcnt lgkmcnt(3)
    ds_read_b128 v[20:23], v11 offset:11264
    buffer_load_dwordx4 v1, s[4:7], s22 offen offset:1024 sc1 lds
    v_mfma_f32_32x32x16_bf16 v[40:55], v[220:223], v[28:31], v[40:55]
    s_waitcnt lgkmcnt(3)
    ds_read_b128 v[24:27], v11 offset:40960
    v_mfma_f32_32x32x16_bf16 v[40:55], v[136:139], v[32:35], v[40:55]
    s_waitcnt lgkmcnt(3)
    ds_read_b128 v[28:31], v11 offset:41984
    v_mfma_f32_32x32x16_bf16 v[40:55], v[140:143], v[36:39], v[40:55]
    s_waitcnt lgkmcnt(3)
    ds_read_b128 v[32:35], v11 offset:43008
    v_mfma_f32_32x32x16_bf16 v[40:55], v[144:147], v[16:19], v[40:55]
    s_waitcnt lgkmcnt(3)
    ds_read_b128 v[36:39], v11 offset:44032
    v_mfma_f32_32x32x16_bf16 v[40:55], v[148:151], v[20:23], v[40:55]
    s_waitcnt lgkmcnt(3)
    s_waitcnt vmcnt(6)
    s_barrier
    ds_read_b128 v[16:19], v11 offset:12288
    v_mfma_f32_32x32x16_bf16 v[40:55], v[224:227], v[24:27], v[40:55]
    s_waitcnt lgkmcnt(3)
    ds_read_b128 v[20:23], v11 offset:13312
    v_mfma_f32_32x32x16_bf16 v[40:55], v[228:231], v[28:31], v[40:55]
    s_waitcnt lgkmcnt(3)
    ds_read_b128 v[24:27], v11 offset:14336
    v_mfma_f32_32x32x16_bf16 v[40:55], v[232:235], v[32:35], v[40:55]
    s_waitcnt lgkmcnt(3)
    ds_read_b128 v[28:31], v11 offset:15360
    s_waitcnt lgkmcnt(0)
    s_cmp_ge_u32 s101, 8
    s_cbranch_scc0 L_chk17_s
L_chk17:
    s_barrier
    v_mfma_f32_32x32x16_bf16 v[40:55], v[236:239], v[36:39], v[40:55]
    s_waitcnt lgkmcnt(3)
    ds_read_b128 v[32:35], v11 offset:45056
    s_add_u32 m0, s23, 24576
    s_add_u32 s22, s22, 77824
    buffer_load_dwordx4 v1, s[4:7], s22 offen offset:0 sc1 lds
    v_mfma_f32_32x32x16_bf16 v[40:55], v[152:155], v[16:19], v[40:55]
    s_waitcnt lgkmcnt(3)
    ds_read_b128 v[36:39], v11 offset:46080
    buffer_load_dwordx4 v1, s[4:7], s22 offen offset:1024 sc1 lds
    v_mfma_f32_32x32x16_bf16 v[40:55], v[156:159], v[20:23], v[40:55]
    s_waitcnt lgkmcnt(3)
    ds_read_b128 v[16:19], v11 offset:47104
    buffer_load_dwordx4 v1, s[4:7], s22 offen offset:2048 sc1 lds
    v_mfma_f32_32x32x16_bf16 v[40:55], v[160:163], v[24:27], v[40:55]
    s_waitcnt lgkmcnt(3)
    ds_read_b128 v[20:23], v11 offset:48128
    buffer_load_dwordx4 v1, s[4:7], s22 offen offset:3072 sc1 lds
    v_mfma_f32_32x32x16_bf16 v[40:55], v[164:167], v[28:31], v[40:55]
    s_waitcnt lgkmcnt(3)
    s_waitcnt vmcnt(6)
    s_barrier
    ds_read_b128 v[24:27], v11 offset:16384
    v_mfma_f32_32x32x16_bf16 v[40:55], v[240:243], v[32:35], v[40:55]
    s_waitcnt lgkmcnt(3)
    ds_read_b128 v[28:31], v11 offset:17408
    s_add_u32 m0, s23, 28672
    s_add_u32 s22, s22, 4096
    buffer_load_dwordx4 v1, s[4:7], s22 offen offset:0 sc1 lds
    v_mfma_f32_32x32x16_bf16 v[40:55], v[244:247], v[36:39], v[40:55]
    s_waitcnt lgkmcnt(3)
    ds_read_b128 v[32:35], v11 offset:18432
    v_mfma_f32_32x32x16_bf16 v[40:55], v[248:251], v[16:19], v[40:55]
    s_waitcnt lgkmcnt(3)
    ds_read_b128 v[36:39], v11 offset:19456
    buffer_load_dwordx4 v1, s[4:7], s22 offen offset:1024 sc1 lds
    v_mfma_f32_32x32x16_bf16 v[40:55], a[192:195], v[20:23], v[40:55]
    s_waitcnt lgkmcnt(3)
    ds_read_b128 v[16:19], v11 offset:49152
    v_mfma_f32_32x32x16_bf16 v[40:55], v[168:171], v[24:27], v[40:55]
    s_waitcnt lgkmcnt(3)
    ds_read_b128 v[20:23], v11 offset:50176
    buffer_load_dwordx4 v1, s[4:7], s22 offen offset:2048 sc1 lds
    v_mfma_f32_32x32x16_bf16 v[40:55], v[172:175], v[28:31], v[40:55]
    s_waitcnt lgkmcnt(3)
    ds_read_b128 v[24:27], v11 offset:51200
    v_mfma_f32_32x32x16_bf16 v[40:55], v[176:179], v[32:35], v[40:55]
    s_waitcnt lgkmcnt(3)
    ds_read_b128 v[28:31], v11 offset:52224
    buffer_load_dwordx4 v1, s[4:7], s22 offen offset:3072 sc1 lds
    v_mfma_f32_32x32x16_bf16 v[40:55], v[180:183], v[36:39], v[40:55]
    s_waitcnt lgkmcnt(3)
    s_waitcnt vmcnt(8)
    s_barrier
    ds_read_b128 v[32:35], v11 offset:20480
    v_mfma_f32_32x32x16_bf16 v[40:55], a[196:199], v[16:19], v[40:55]
    s_waitcnt lgkmcnt(3)
    ds_read_b128 v[36:39], v11 offset:21504
    s_add_u32 m0, s23, 0
    s_add_u32 s22, s22, 4096
    buffer_load_dwordx4 v1, s[4:7], s22 offen offset:0 sc1 lds
    v_mfma_f32_32x32x16_bf16 v[40:55], a[200:203], v[20:23], v[40:55]
    s_waitcnt lgkmcnt(3)
    ds_read_b128 v[16:19], v11 offset:53248
    v_mfma_f32_32x32x16_bf16 v[40:55], a[204:207], v[24:27], v[40:55]
    s_waitcnt lgkmcnt(3)
    buffer_load_dwordx4 v1, s[4:7], s22 offen offset:1024 sc1 lds
    v_mfma_f32_32x32x16_bf16 v[40:55], a[208:211], v[28:31], v[40:55]
    s_waitcnt lgkmcnt(2)
    v_mfma_f32_32x32x16_bf16 v[40:55], v[184:187], v[32:35], v[40:55]
    s_waitcnt lgkmcnt(1)
    buffer_load_dwordx4 v1, s[4:7], s22 offen offset:2048 sc1 lds
    v_mfma_f32_32x32x16_bf16 v[40:55], v[188:191], v[36:39], v[40:55]
    s_waitcnt lgkmcnt(0)
    v_mfma_f32_32x32x16_bf16 v[40:55], a[212:215], v[16:19], v[40:55]
    buffer_load_dwordx4 v1, s[4:7], s22 offen offset:3072 sc1 lds
    s_nop 10
    ds_write_b128 v12, v[48:51] offset:0
    ds_write_b128 v12, v[52:55] offset:1024
    s_add_u32 m0, s23, 4096
    s_add_u32 s22, s22, 4096
    buffer_load_dwordx4 v1, s[4:7], s22 offen offset:0 sc1 lds
    s_waitcnt lgkmcnt(0)
    s_barrier
    ds_read_b128 v[48:51], v10 offset:0
    ds_read_b128 v[52:55], v10 offset:1024
    v_pk_add_f32 v[40:41], v[40:41], v[84:85]
    v_pk_add_f32 v[42:43], v[42:43], v[86:87]
    v_pk_add_f32 v[44:45], v[44:45], v[88:89]
    v_pk_add_f32 v[46:47], v[46:47], v[90:91]
    buffer_load_dwordx4 v1, s[4:7], s22 offen offset:1024 sc1 lds
    s_waitcnt lgkmcnt(0)
    v_pk_add_f32 v[40:41], v[40:41], v[48:49]
    v_pk_add_f32 v[42:43], v[42:43], v[50:51]
    v_pk_add_f32 v[44:45], v[44:45], v[52:53]
    v_pk_add_f32 v[46:47], v[46:47], v[54:55]
    v_cvt_pk_bf16_f32 v72, v40, v41
    v_cvt_pk_bf16_f32 v73, v42, v43
    v_cvt_pk_bf16_f32 v74, v44, v45
    v_cvt_pk_bf16_f32 v75, v46, v47
    s_nop 0
    v_permlane32_swap_b32 v72, v74
    v_permlane32_swap_b32 v73, v75
    buffer_load_dwordx4 v1, s[4:7], s22 offen offset:2048 sc1 lds
    v_pk_add_f32 v[48:49], v[40:41], v[42:43]
    v_pk_mul_f32 v[50:51], v[40:41], v[40:41]
    v_pk_fma_f32 v[50:51], v[42:43], v[42:43], v[50:51]
    v_pk_add_f32 v[48:49], v[48:49], v[44:45]
    v_pk_fma_f32 v[50:51], v[44:45], v[44:45], v[50:51]
    v_pk_add_f32 v[48:49], v[48:49], v[46:47]
    v_pk_fma_f32 v[50:51], v[46:47], v[46:47], v[50:51]
    v_add_f32 v48, v48, v49
    v_add_f32 v50, v50, v51
    s_nop 1
    v_permlane32_swap_b32 v48, v50
    v_add_f32 v48, v48, v50
    buffer_load_dwordx4 v1, s[4:7], s22 offen offset:3072 sc1 lds
    s_waitcnt vmcnt(12)
    s_barrier
    ds_read_b128 v[20:23], v11 offset:24576
    ds_read_b128 v[24:27], v11 offset:25600
    ds_read_b128 v[28:31], v11 offset:26624
    ds_read_b128 v[32:35], v11 offset:27648
    ds_read_b128 v[36:39], v11 offset:57344
    s_waitcnt lgkmcnt(4)
    v_mfma_f32_32x32x16_bf16 v[56:71], v[104:107], v[20:23], 0
    s_waitcnt lgkmcnt(3)
    ds_read_b128 v[16:19], v11 offset:58368
    v_mfma_f32_32x32x16_bf16 v[56:71], v[108:111], v[24:27], v[56:71]
    s_waitcnt lgkmcnt(3)
    ds_read_b128 v[20:23], v11 offset:59392
    v_mfma_f32_32x32x16_bf16 v[56:71], v[112:115], v[28:31], v[56:71]
    s_waitcnt lgkmcnt(3)
    ds_read_b128 v[24:27], v11 offset:60416
    v_mfma_f32_32x32x16_bf16 v[56:71], v[116:119], v[32:35], v[56:71]
    s_waitcnt lgkmcnt(3)
    s_waitcnt vmcnt(8)
    s_barrier
    ds_read_b128 v[28:31], v11 offset:28672
    v_mfma_f32_32x32x16_bf16 v[56:71], v[192:195], v[36:39], v[56:71]
    s_waitcnt lgkmcnt(3)
    ds_read_b128 v[32:35], v11 offset:29696
    s_add_u32 m0, s23, 8192
    s_add_u32 s22, s22, 4096
    buffer_load_dwordx4 v1, s[4:7], s22 offen offset:0 sc1 lds
    v_mfma_f32_32x32x16_bf16 v[56:71], v[196:199], v[16:19], v[56:71]
    s_waitcnt lgkmcnt(3)
    ds_read_b128 v[36:39], v11 offset:30720
    v_mfma_f32_32x32x16_bf16 v[56:71], v[200:203], v[20:23], v[56:71]
    s_waitcnt lgkmcnt(3)
    ds_read_b128 v[16:19], v11 offset:31744
    buffer_load_dwordx4 v1, s[4:7], s22 offen offset:1024 sc1 lds
    v_mfma_f32_32x32x16_bf16 v[56:71], v[204:207], v[24:27], v[56:71]
    s_waitcnt lgkmcnt(3)
    ds_read_b128 v[20:23], v11 offset:61440
    v_mfma_f32_32x32x16_bf16 v[56:71], v[120:123], v[28:31], v[56:71]
    s_waitcnt lgkmcnt(3)
    ds_read_b128 v[24:27], v11 offset:62464
    buffer_load_dwordx4 v1, s[4:7], s22 offen offset:2048 sc1 lds
    v_mfma_f32_32x32x16_bf16 v[56:71], v[124:127], v[32:35], v[56:71]
    s_waitcnt lgkmcnt(3)
    ds_read_b128 v[28:31], v11 offset:63488
    v_mfma_f32_32x32x16_bf16 v[56:71], v[128:131], v[36:39], v[56:71]
    s_waitcnt lgkmcnt(3)
    ds_read_b128 v[32:35], v11 offset:64512
    buffer_load_dwordx4 v1, s[4:7], s22 offen offset:3072 sc1 lds
    v_mfma_f32_32x32x16_bf16 v[56:71], v[132:135], v[16:19], v[56:71]
    s_waitcnt lgkmcnt(3)
    s_waitcnt vmcnt(4)
    s_barrier
    ds_read_b128 v[36:39], v11 offset:0
    v_mfma_f32_32x32x16_bf16 v[56:71], v[208:211], v[20:23], v[56:71]
    s_waitcnt lgkmcnt(3)
    ds_read_b128 v[16:19], v11 offset:1024
    s_add_u32 m0, s23, 12288
    s_add_u32 s22, s22, 4096
    buffer_load_dwordx4 v1, s[4:7], s22 offen offset:0 sc1 lds
    v_mfma_f32_32x32x16_bf16 v[56:71], v[212:215], v[24:27], v[56:71]
    s_waitcnt lgkmcnt(3)
    ds_read_b128 v[20:23], v11 offset:2048
    v_mfma_f32_32x32x16_bf16 v[56:71], v[216:219], v[28:31], v[56:71]
    s_waitcnt lgkmcnt(3)
    ds_read_b128 v[24:27], v11 offset:3072
    buffer_load_dwordx4 v1, s[4:7], s22 offen offset:1024 sc1 lds
    v_mfma_f32_32x32x16_bf16 v[56:71], v[220:223], v[32:35], v[56:71]
    s_waitcnt lgkmcnt(3)
    ds_read_b128 v[28:31], v11 offset:32768
    buffer_store_dwordx4 v[72:75], v7, s[48:51], s34 offen
    v_mfma_f32_32x32x16_bf16 v[56:71], v[136:139], v[36:39], v[56:71]
    s_waitcnt lgkmcnt(3)
    ds_read_b128 v[32:35], v11 offset:33792
    buffer_store_dwordx4 v[72:75], v13, s[4:7], s25 offen sc1
    v_mfma_f32_32x32x16_bf16 v[56:71], v[140:143], v[16:19], v[56:71]
    s_waitcnt lgkmcnt(3)
    ds_read_b128 v[36:39], v11 offset:34816
    buffer_store_dword v48, v8, s[4:7], s29 offen offset:0 sc1
    v_mfma_f32_32x32x16_bf16 v[56:71], v[144:147], v[20:23], v[56:71]
    s_waitcnt lgkmcnt(3)
    ds_read_b128 v[16:19], v11 offset:35840
    s_add_u32 s25, s25, 32768
    s_add_u32 s34, s34, 32768
    v_mfma_f32_32x32x16_bf16 v[56:71], v[148:151], v[24:27], v[56:71]
    s_waitcnt lgkmcnt(3)
    ds_read_b128 v[20:23], v11 offset:4096
    v_mfma_f32_32x32x16_bf16 v[56:71], v[224:227], v[28:31], v[56:71]
    s_waitcnt lgkmcnt(3)
    ds_read_b128 v[24:27], v11 offset:5120
    v_mfma_f32_32x32x16_bf16 v[56:71], v[228:231], v[32:35], v[56:71]
    s_waitcnt lgkmcnt(3)
    ds_read_b128 v[28:31], v11 offset:6144
    v_mfma_f32_32x32x16_bf16 v[56:71], v[232:235], v[36:39], v[56:71]
    s_waitcnt lgkmcnt(3)
    ds_read_b128 v[32:35], v11 offset:7168
    v_mfma_f32_32x32x16_bf16 v[56:71], v[236:239], v[16:19], v[56:71]
    s_waitcnt lgkmcnt(3)
    ds_read_b128 v[36:39], v11 offset:36864
    v_mfma_f32_32x32x16_bf16 v[56:71], v[152:155], v[20:23], v[56:71]
    s_waitcnt lgkmcnt(3)
    ds_read_b128 v[16:19], v11 offset:37888
    v_mfma_f32_32x32x16_bf16 v[56:71], v[156:159], v[24:27], v[56:71]
    s_waitcnt lgkmcnt(3)
    ds_read_b128 v[20:23], v11 offset:38912
    v_mfma_f32_32x32x16_bf16 v[56:71], v[160:163], v[28:31], v[56:71]
    s_waitcnt lgkmcnt(3)
    ds_read_b128 v[24:27], v11 offset:39936
    v_mfma_f32_32x32x16_bf16 v[56:71], v[164:167], v[32:35], v[56:71]
    s_waitcnt lgkmcnt(3)
    s_waitcnt vmcnt(3)
    s_barrier
    ds_read_b128 v[28:31], v11 offset:8192
    v_mfma_f32_32x32x16_bf16 v[56:71], v[240:243], v[36:39], v[56:71]
    s_waitcnt lgkmcnt(3)
    ds_read_b128 v[32:35], v11 offset:9216
    s_mul_i32 s55, s52, 49152
    s_add_u32 s55, s55, 131072
    s_add_u32 s56, s55, 16384
    s_add_u32 s57, s55, 32768
    v_mfma_f32_32x32x16_bf16 v[56:71], v[244:247], v[16:19], v[56:71]
    s_waitcnt lgkmcnt(3)
    ds_read_b128 v[36:39], v11 offset:10240
    v_mfma_f32_32x32x16_bf16 v[56:71], v[248:251], v[20:23], v[56:71]
    s_waitcnt lgkmcnt(3)
    ds_read_b128 v[16:19], v11 offset:11264
    v_mfma_f32_32x32x16_bf16 v[56:71], a[192:195], v[24:27], v[56:71]
    s_waitcnt lgkmcnt(3)
    ds_read_b128 v[20:23], v11 offset:40960
    s_cmp_lg_u32 s11, 0
    s_cbranch_scc1 L_qe0
    buffer_load_dwordx4 a[64:67], v1, s[4:7], s56 offen offset:0
    buffer_load_dwordx4 a[128:131], v1, s[4:7], s57 offen offset:0
    buffer_load_dwordx4 a[68:71], v1, s[4:7], s56 offen offset:1024
    buffer_load_dwordx4 a[132:135], v1, s[4:7], s57 offen offset:1024
L_qe0:
    v_mfma_f32_32x32x16_bf16 v[56:71], v[168:171], v[28:31], v[56:71]
    s_waitcnt lgkmcnt(3)
    ds_read_b128 v[24:27], v11 offset:41984
    v_mfma_f32_32x32x16_bf16 v[56:71], v[172:175], v[32:35], v[56:71]
    s_waitcnt lgkmcnt(3)
    ds_read_b128 v[28:31], v11 offset:43008
    v_mfma_f32_32x32x16_bf16 v[56:71], v[176:179], v[36:39], v[56:71]
    s_waitcnt lgkmcnt(3)
    ds_read_b128 v[32:35], v11 offset:44032
    s_cmp_lg_u32 s11, 0
    s_cbranch_scc1 L_qe2
    buffer_load_dwordx4 a[72:75], v1, s[4:7], s56 offen offset:2048
    buffer_load_dwordx4 a[136:139], v1, s[4:7], s57 offen offset:2048
    buffer_load_dwordx4 a[76:79], v1, s[4:7], s56 offen offset:3072
    buffer_load_dwordx4 a[140:143], v1, s[4:7], s57 offen offset:3072
L_qe2:
    v_mfma_f32_32x32x16_bf16 v[56:71], v[180:183], v[16:19], v[56:71]
    s_waitcnt lgkmcnt(3)
    ds_read_b128 v[36:39], v11 offset:12288
    v_mfma_f32_32x32x16_bf16 v[56:71], a[196:199], v[20:23], v[56:71]
    s_waitcnt lgkmcnt(3)
    ds_read_b128 v[16:19], v11 offset:13312
    v_mfma_f32_32x32x16_bf16 v[56:71], a[200:203], v[24:27], v[56:71]
    s_waitcnt lgkmcnt(3)
    ds_read_b128 v[20:23], v11 offset:45056
    v_mfma_f32_32x32x16_bf16 v[56:71], a[204:207], v[28:31], v[56:71]
    s_waitcnt lgkmcnt(3)
    v_mfma_f32_32x32x16_bf16 v[56:71], a[208:211], v[32:35], v[56:71]
    s_waitcnt lgkmcnt(2)
    v_mfma_f32_32x32x16_bf16 v[56:71], v[184:187], v[36:39], v[56:71]
    s_waitcnt lgkmcnt(1)
    v_mfma_f32_32x32x16_bf16 v[56:71], v[188:191], v[16:19], v[56:71]
    s_waitcnt lgkmcnt(0)
    v_mfma_f32_32x32x16_bf16 v[56:71], a[212:215], v[20:23], v[56:71]
    s_nop 11
    ds_write_b128 v12, v[64:67] offset:2048
    ds_write_b128 v12, v[68:71] offset:3072
    s_waitcnt lgkmcnt(0)
    s_barrier
    ds_read_b128 v[64:67], v10 offset:2048
    ds_read_b128 v[68:71], v10 offset:3072
    v_pk_add_f32 v[56:57], v[56:57], v[92:93]
    v_pk_add_f32 v[58:59], v[58:59], v[94:95]
    v_pk_add_f32 v[60:61], v[60:61], v[96:97]
    v_pk_add_f32 v[62:63], v[62:63], v[98:99]
    s_waitcnt lgkmcnt(0)
    v_pk_add_f32 v[56:57], v[56:57], v[64:65]
    v_pk_add_f32 v[58:59], v[58:59], v[66:67]
    v_pk_add_f32 v[60:61], v[60:61], v[68:69]
    v_pk_add_f32 v[62:63], v[62:63], v[70:71]
    v_cvt_pk_bf16_f32 v76, v56, v57
    v_cvt_pk_bf16_f32 v77, v58, v59
    v_cvt_pk_bf16_f32 v78, v60, v61
    v_cvt_pk_bf16_f32 v79, v62, v63
    s_nop 0
    v_permlane32_swap_b32 v76, v78
    v_permlane32_swap_b32 v77, v79
    buffer_store_dwordx4 v[76:79], v7, s[48:51], s34 offen
    s_cmp_lg_u32 s11, 0
    s_cbranch_scc1 L_done
    buffer_store_dwordx4 v[76:79], v13, s[4:7], s25 offen sc1
    v_pk_add_f32 v[64:65], v[56:57], v[58:59]
    v_pk_mul_f32 v[66:67], v[56:57], v[56:57]
    v_pk_fma_f32 v[66:67], v[58:59], v[58:59], v[66:67]
    v_pk_add_f32 v[64:65], v[64:65], v[60:61]
    v_pk_fma_f32 v[66:67], v[60:61], v[60:61], v[66:67]
    v_pk_add_f32 v[64:65], v[64:65], v[62:63]
    v_pk_fma_f32 v[66:67], v[62:63], v[62:63], v[66:67]
    v_add_f32 v64, v64, v65
    v_add_f32 v66, v66, v67
    s_nop 1
    v_permlane32_swap_b32 v64, v66
    v_add_f32 v64, v64, v66
    buffer_store_dword v64, v8, s[4:7], s29 offen offset:256 sc1
    s_add_u32 s56, s56, 4096
    buffer_load_dwordx4 a[80:83], v1, s[4:7], s56 offen offset:0
    s_add_u32 s57, s57, 4096
    buffer_load_dwordx4 a[144:147], v1, s[4:7], s57 offen offset:0
    buffer_load_dwordx4 a[84:87], v1, s[4:7], s56 offen offset:1024
    buffer_load_dwordx4 a[148:151], v1, s[4:7], s57 offen offset:1024
    buffer_load_dwordx4 a[88:91], v1, s[4:7], s56 offen offset:2048
    buffer_load_dwordx4 a[152:155], v1, s[4:7], s57 offen offset:2048
    buffer_load_dwordx4 a[92:95], v1, s[4:7], s56 offen offset:3072
    buffer_load_dwordx4 a[156:159], v1, s[4:7], s57 offen offset:3072
    s_add_u32 s13, s13, 19922944
    v_lshrrev_b32 v2, 4, v0
    v_and_b32 v3, 15, v0
    v_and_b32 v6, 1, v2
    v_lshlrev_b32 v6, 9, v6
    v_lshrrev_b32 v7, 5, v0
    v_lshl_add_u32 v10, v7, 4, v3
    v_lshl_add_u32 v10, v10, 4, v6
    v_lshrrev_b32 v8, 2, v3
    v_lshlrev_b32 v8, 3, v8
    v_lshl_add_u32 v8, v7, 2, v8
    v_and_b32 v9, 3, v0
    v_add_u32 v8, v8, v9
    v_lshl_add_u32 v11, v8, 4, v6
    v_lshlrev_b32 v13, 4, v2
    v_add_u32 v13, 155648, v13
    v_lshlrev_b32 v12, 2, v3
    v_add_u32 v12, 155648, v12
    v_lshlrev_b32 v8, 12, v2
    v_lshl_add_u32 v8, v3, 3, v8
    s_lshl_b32 s25, s8, 6
    v_add_u32 v9, s25, v12
    s_lshl_b32 s24, s9, 14
    s_lshl_b32 s25, s8, 7
    s_add_u32 s24, s24, s25
    s_add_u32 s24, s24, s13
    s_add_u32 s24, s24, 18874368
    s_lshl_b32 s26, s9, 16
    s_lshl_b32 s27, s8, 14
    s_add_u32 s26, s26, s27
    s_add_u32 s26, s26, s13
    s_add_u32 s26, s26, 0
    s_lshl_b32 s28, s52, 16
    s_lshl_b32 s29, s9, 11
    s_add_u32 s28, s28, s29
    s_add_u32 s28, s28, s13
    s_add_u32 s29, s28, 6291456
    s_add_u32 s30, s28, 8388608
    s_add_u32 s28, s28, 4194304
    s_lshl_b32 s25, s8, 6
    s_add_u32 s25, s25, 155648
    v_lshrrev_b32 v8, 3, v0
    v_and_b32 v9, 7, v0
    v_lshlrev_b32 v8, 9, v8
    v_lshl_add_u32 v8, v9, 4, v8
    v_lshrrev_b32 v7, 5, v0
    v_lshl_add_u32 v9, v9, 1, v7
    v_lshl_add_u32 v9, v9, 2, s25
    v_mov_b32 v4, 0x3eb8aa3b
    s_lshl_b32 s20, s52, 8
    s_add_u32 s20, s20, 5210112
    v_lshlrev_b32 v28, 5, v2
    v_lshlrev_b32 v29, 2, v3
    buffer_load_dwordx4 v[80:83], v28, s[4:7], s20 offen offset:0
    buffer_load_dwordx4 v[84:87], v28, s[4:7], s20 offen offset:16
    buffer_load_dword v88, v29, s[4:7], s20 offen offset:128
    s_waitcnt vmcnt(11) lgkmcnt(0)
    s_barrier
    s_cmp_lg_u32 s8, 0
    s_cbranch_scc1 L_arr18
    s_atomic_add s36, s[14:15], 1408
L_arr18:
    s_mov_b32 s59, 32
    s_add_u32 s56, s56, 4096
    buffer_load_dwordx4 a[96:99], v1, s[4:7], s56 offen offset:0
    s_add_u32 s57, s57, 4096
    buffer_load_dwordx4 a[160:163], v1, s[4:7], s57 offen offset:0
    buffer_load_dwordx4 a[100:103], v1, s[4:7], s56 offen offset:1024
    buffer_load_dwordx4 a[164:167], v1, s[4:7], s57 offen offset:1024
    buffer_load_dwordx4 a[104:107], v1, s[4:7], s56 offen offset:2048
    buffer_load_dwordx4 a[168:171], v1, s[4:7], s57 offen offset:2048
    buffer_load_dwordx4 a[108:111], v1, s[4:7], s56 offen offset:3072
    buffer_load_dwordx4 a[172:175], v1, s[4:7], s57 offen offset:3072
    s_mov_b32 s101, -1
    s_cmp_lg_u32 s8, 1
    s_cbranch_scc1 L_pi19
    s_mov_b32 s101, 0
    s_atomic_add s101, s[14:15], 1408 glc
L_pi19:
    s_add_u32 s56, s56, 4096
    buffer_load_dwordx4 a[112:115], v1, s[4:7], s56 offen offset:0
    s_add_u32 s57, s57, 4096
    buffer_load_dwordx4 a[176:179], v1, s[4:7], s57 offen offset:0
    buffer_load_dwordx4 a[116:119], v1, s[4:7], s56 offen offset:1024
    buffer_load_dwordx4 a[180:183], v1, s[4:7], s57 offen offset:1024
    s_waitcnt lgkmcnt(0)
    s_cmp_ge_u32 s101, 8
    s_cbranch_scc0 L_chk20_s
L_chk20:
    s_barrier
    s_add_u32 m0, s27, 0
    s_nop 0
    buffer_load_dwordx4 v1, s[4:7], s26 offen offset:0 sc1 lds
    buffer_load_dwordx4 v1, s[4:7], s26 offen offset:1024 sc1 lds
    buffer_load_dwordx4 v1, s[4:7], s26 offen offset:2048 sc1 lds
    buffer_load_dwordx4 v1, s[4:7], s26 offen offset:3072 sc1 lds
    s_add_u32 m0, s27, 4096
    s_add_u32 s26, s26, 4096
    buffer_load_dwordx4 v1, s[4:7], s26 offen offset:0 sc1 lds
    buffer_load_dwordx4 v1, s[4:7], s26 offen offset:1024 sc1 lds
    buffer_load_dwordx4 v1, s[4:7], s26 offen offset:2048 sc1 lds
    buffer_load_dwordx4 v1, s[4:7], s26 offen offset:3072 sc1 lds
    s_waitcnt vmcnt(4)
    s_barrier
    ds_read_b128 a[192:195], v1 offset:0
    ds_read_b128 a[196:199], v1 offset:16384
    ds_read_b128 a[200:203], v1 offset:32768
    ds_read_b128 a[204:207], v1 offset:49152
    ds_read_b128 a[208:211], v1 offset:1024
    s_waitcnt lgkmcnt(4)
    v_mfma_f32_16x16x32_bf16 v[36:39], a[64:67], a[192:195], 0
    ds_read_b128 a[212:215], v1 offset:17408
    s_add_u32 m0, s27, 8192
    s_add_u32 s26, s26, 4096
    buffer_load_dwordx4 v1, s[4:7], s26 offen offset:0 sc1 lds
    v_mfma_f32_16x16x32_bf16 v[40:43], a[192:195], a[128:131], 0
    s_waitcnt lgkmcnt(4)
    v_mfma_f32_16x16x32_bf16 v[48:51], a[64:67], a[196:199], 0
    ds_read_b128 a[216:219], v1 offset:33792
    v_mfma_f32_16x16x32_bf16 v[52:55], a[196:199], a[128:131], 0
    s_waitcnt lgkmcnt(4)
    v_mfma_f32_16x16x32_bf16 v[60:63], a[64:67], a[200:203], 0
    ds_read_b128 a[220:223], v1 offset:50176
    buffer_load_dwordx4 v1, s[4:7], s26 offen offset:1024 sc1 lds
    v_mfma_f32_16x16x32_bf16 v[64:67], a[200:203], a[128:131], 0
    s_waitcnt lgkmcnt(4)
    v_mfma_f32_16x16x32_bf16 v[72:75], a[64:67], a[204:207], 0
    ds_read_b128 a[224:227], v1 offset:2048
    v_mfma_f32_16x16x32_bf16 v[76:79], a[204:207], a[128:131], 0
    s_waitcnt lgkmcnt(4)
    v_mfma_f32_16x16x32_bf16 v[36:39], a[68:71], a[208:211], v[36:39]
    ds_read_b128 a[228:231], v1 offset:18432
    buffer_load_dwordx4 v1, s[4:7], s26 offen offset:2048 sc1 lds
    v_mfma_f32_16x16x32_bf16 v[40:43], a[208:211], a[132:135], v[40:43]
    s_waitcnt lgkmcnt(4)
    v_mfma_f32_16x16x32_bf16 v[48:51], a[68:71], a[212:215], v[48:51]
    ds_read_b128 a[232:235], v1 offset:34816
    v_mfma_f32_16x16x32_bf16 v[52:55], a[212:215], a[132:135], v[52:55]
    s_waitcnt lgkmcnt(4)
    v_mfma_f32_16x16x32_bf16 v[60:63], a[68:71], a[216:219], v[60:63]
    ds_read_b128 a[236:239], v1 offset:51200
    buffer_load_dwordx4 v1, s[4:7], s26 offen offset:3072 sc1 lds
    v_mfma_f32_16x16x32_bf16 v[64:67], a[216:219], a[132:135], v[64:67]
    s_waitcnt lgkmcnt(4)
    v_mfma_f32_16x16x32_bf16 v[72:75], a[68:71], a[220:223], v[72:75]
    ds_read_b128 a[240:243], v1 offset:3072
    v_mfma_f32_16x16x32_bf16 v[76:79], a[220:223], a[132:135], v[76:79]
    s_waitcnt lgkmcnt(4)
    v_mfma_f32_16x16x32_bf16 v[36:39], a[72:75], a[224:227], v[36:39]
    ds_read_b128 a[244:247], v1 offset:19456
    s_add_u32 m0, s27, 12288
    s_add_u32 s26, s26, 4096
    buffer_load_dwordx4 v1, s[4:7], s26 offen offset:0 sc1 lds
    v_mfma_f32_16x16x32_bf16 v[40:43], a[224:227], a[136:139], v[40:43]
    s_waitcnt lgkmcnt(4)
    v_mfma_f32_16x16x32_bf16 v[48:51], a[72:75], a[228:231], v[48:51]
    ds_read_b128 a[248:251], v1 offset:35840
    v_mfma_f32_16x16x32_bf16 v[52:55], a[228:231], a[136:139], v[52:55]
    s_waitcnt lgkmcnt(4)
    v_mfma_f32_16x16x32_bf16 v[60:63], a[72:75], a[232:235], v[60:63]
    ds_read_b128 a[252:255], v1 offset:52224
    buffer_load_dwordx4 v1, s[4:7], s26 offen offset:1024 sc1 lds
    v_mfma_f32_16x16x32_bf16 v[64:67], a[232:235], a[136:139], v[64:67]
    s_waitcnt lgkmcnt(4)
    v_mfma_f32_16x16x32_bf16 v[72:75], a[72:75], a[236:239], v[72:75]
    s_waitcnt vmcnt(6)
    s_barrier
    ds_read_b128 a[192:195], v1 offset:4096
    v_mfma_f32_16x16x32_bf16 v[76:79], a[236:239], a[136:139], v[76:79]
    s_waitcnt lgkmcnt(4)
    v_mfma_f32_16x16x32_bf16 v[36:39], a[76:79], a[240:243], v[36:39]
    ds_read_b128 a[196:199], v1 offset:20480
    buffer_load_dwordx4 v1, s[4:7], s26 offen offset:2048 sc1 lds
    v_mfma_f32_16x16x32_bf16 v[40:43], a[240:243], a[140:143], v[40:43]
    s_waitcnt lgkmcnt(4)
    v_mfma_f32_16x16x32_bf16 v[48:51], a[76:79], a[244:247], v[48:51]
    ds_read_b128 a[200:203], v1 offset:36864
    v_mfma_f32_16x16x32_bf16 v[52:55], a[244:247], a[140:143], v[52:55]
    s_waitcnt lgkmcnt(4)
    v_mfma_f32_16x16x32_bf16 v[60:63], a[76:79], a[248:251], v[60:63]
    ds_read_b128 a[204:207], v1 offset:53248
    buffer_load_dwordx4 v1, s[4:7], s26 offen offset:3072 sc1 lds
    v_mfma_f32_16x16x32_bf16 v[64:67], a[248:251], a[140:143], v[64:67]
    s_waitcnt lgkmcnt(4)
    v_mfma_f32_16x16x32_bf16 v[72:75], a[76:79], a[252:255], v[72:75]
    ds_read_b128 a[208:211], v1 offset:5120
    v_mfma_f32_16x16x32_bf16 v[76:79], a[252:255], a[140:143], v[76:79]
    s_waitcnt lgkmcnt(4)
    v_mfma_f32_16x16x32_bf16 v[36:39], a[80:83], a[192:195], v[36:39]
    ds_read_b128 a[212:215], v1 offset:21504
    buffer_load_dwordx4 a[120:123], v1, s[4:7], s56 offen offset:2048
    v_mfma_f32_16x16x32_bf16 v[40:43], a[192:195], a[144:147], v[40:43]
    s_waitcnt lgkmcnt(4)
    v_mfma_f32_16x16x32_bf16 v[48:51], a[80:83], a[196:199], v[48:51]
    ds_read_b128 a[216:219], v1 offset:37888
    v_mfma_f32_16x16x32_bf16 v[52:55], a[196:199], a[144:147], v[52:55]
    s_waitcnt lgkmcnt(4)
    v_mfma_f32_16x16x32_bf16 v[60:63], a[80:83], a[200:203], v[60:63]
    ds_read_b128 a[220:223], v1 offset:54272
    buffer_load_dwordx4 a[184:187], v1, s[4:7], s57 offen offset:2048
    v_mfma_f32_16x16x32_bf16 v[64:67], a[200:203], a[144:147], v[64:67]
    s_waitcnt lgkmcnt(4)
    v_mfma_f32_16x16x32_bf16 v[72:75], a[80:83], a[204:207], v[72:75]
    ds_read_b128 a[224:227], v1 offset:6144
    v_mfma_f32_16x16x32_bf16 v[76:79], a[204:207], a[144:147], v[76:79]
    s_waitcnt lgkmcnt(4)
    v_mfma_f32_16x16x32_bf16 v[36:39], a[84:87], a[208:211], v[36:39]
    ds_read_b128 a[228:231], v1 offset:22528
    buffer_load_dwordx4 a[124:127], v1, s[4:7], s56 offen offset:3072
    v_mfma_f32_16x16x32_bf16 v[40:43], a[208:211], a[148:151], v[40:43]
    s_waitcnt lgkmcnt(4)
    v_mfma_f32_16x16x32_bf16 v[48:51], a[84:87], a[212:215], v[48:51]
    ds_read_b128 a[232:235], v1 offset:38912
    v_mfma_f32_16x16x32_bf16 v[52:55], a[212:215], a[148:151], v[52:55]
    s_waitcnt lgkmcnt(4)
    v_mfma_f32_16x16x32_bf16 v[60:63], a[84:87], a[216:219], v[60:63]
    ds_read_b128 a[236:239], v1 offset:55296
    buffer_load_dwordx4 a[188:191], v1, s[4:7], s57 offen offset:3072
    v_mfma_f32_16x16x32_bf16 v[64:67], a[216:219], a[148:151], v[64:67]
    s_waitcnt lgkmcnt(4)
    v_mfma_f32_16x16x32_bf16 v[72:75], a[84:87], a[220:223], v[72:75]
    ds_read_b128 a[240:243], v1 offset:7168
    v_mfma_f32_16x16x32_bf16 v[76:79], a[220:223], a[148:151], v[76:79]
    s_waitcnt lgkmcnt(4)
    v_mfma_f32_16x16x32_bf16 v[36:39], a[88:91], a[224:227], v[36:39]
    ds_read_b128 a[244:247], v1 offset:23552
    buffer_load_dwordx4 v[16:19], v8, s[4:7], s24 offen sc1
    v_mfma_f32_16x16x32_bf16 v[40:43], a[224:227], a[152:155], v[40:43]
    s_waitcnt lgkmcnt(4)
    v_mfma_f32_16x16x32_bf16 v[48:51], a[88:91], a[228:231], v[48:51]
    ds_read_b128 a[248:251], v1 offset:39936
    v_mfma_f32_16x16x32_bf16 v[52:55], a[228:231], a[152:155], v[52:55]
    s_waitcnt lgkmcnt(4)
    v_mfma_f32_16x16x32_bf16 v[60:63], a[88:91], a[232:235], v[60:63]
    ds_read_b128 a[252:255], v1 offset:56320
    s_add_u32 s24, s24, 4096
    buffer_load_dwordx4 v[20:23], v8, s[4:7], s24 offen sc1
    v_mfma_f32_16x16x32_bf16 v[64:67], a[232:235], a[152:155], v[64:67]
    s_waitcnt lgkmcnt(4)
    v_mfma_f32_16x16x32_bf16 v[72:75], a[88:91], a[236:239], v[72:75]
    s_waitcnt vmcnt(10)
    s_barrier
    ds_read_b128 a[192:195], v1 offset:8192
    v_mfma_f32_16x16x32_bf16 v[76:79], a[236:239], a[152:155], v[76:79]
    s_waitcnt lgkmcnt(4)
    v_mfma_f32_16x16x32_bf16 v[36:39], a[92:95], a[240:243], v[36:39]
    ds_read_b128 a[196:199], v1 offset:24576
    s_add_u32 s24, s24, 4096
    buffer_load_dwordx4 v[24:27], v8, s[4:7], s24 offen sc1
    v_mfma_f32_16x16x32_bf16 v[40:43], a[240:243], a[156:159], v[40:43]
    s_waitcnt lgkmcnt(4)
    v_mfma_f32_16x16x32_bf16 v[48:51], a[92:95], a[244:247], v[48:51]
    ds_read_b128 a[200:203], v1 offset:40960
    v_mfma_f32_16x16x32_bf16 v[52:55], a[244:247], a[156:159], v[52:55]
    s_waitcnt lgkmcnt(4)
    v_mfma_f32_16x16x32_bf16 v[60:63], a[92:95], a[248:251], v[60:63]
    ds_read_b128 a[204:207], v1 offset:57344
    s_add_u32 s24, s24, 4096
    buffer_load_dwordx4 v[28:31], v8, s[4:7], s24 offen sc1
    v_mfma_f32_16x16x32_bf16 v[64:67], a[248:251], a[156:159], v[64:67]
    s_waitcnt lgkmcnt(4)
    v_mfma_f32_16x16x32_bf16 v[72:75], a[92:95], a[252:255], v[72:75]
    ds_read_b128 a[208:211], v1 offset:9216
    v_mfma_f32_16x16x32_bf16 v[76:79], a[252:255], a[156:159], v[76:79]
    s_waitcnt lgkmcnt(4)
    v_mfma_f32_16x16x32_bf16 v[36:39], a[96:99], a[192:195], v[36:39]
    ds_read_b128 a[212:215], v1 offset:25600
    buffer_load_dwordx4 a[0:3], v1, s[4:7], s55 offen offset:0
    v_mfma_f32_16x16x32_bf16 v[40:43], a[192:195], a[160:163], v[40:43]
    s_waitcnt lgkmcnt(4)
    v_mfma_f32_16x16x32_bf16 v[48:51], a[96:99], a[196:199], v[48:51]
    ds_read_b128 a[216:219], v1 offset:41984
    v_mfma_f32_16x16x32_bf16 v[52:55], a[196:199], a[160:163], v[52:55]
    s_waitcnt lgkmcnt(4)
    v_mfma_f32_16x16x32_bf16 v[60:63], a[96:99], a[200:203], v[60:63]
    ds_read_b128 a[220:223], v1 offset:58368
    buffer_load_dwordx4 a[4:7], v1, s[4:7], s55 offen offset:1024
    v_mfma_f32_16x16x32_bf16 v[64:67], a[200:203], a[160:163], v[64:67]
    s_waitcnt lgkmcnt(4)
    v_mfma_f32_16x16x32_bf16 v[72:75], a[96:99], a[204:207], v[72:75]
    ds_read_b128 a[224:227], v1 offset:10240
    v_mfma_f32_16x16x32_bf16 v[76:79], a[204:207], a[160:163], v[76:79]
    s_waitcnt lgkmcnt(4)
    v_mfma_f32_16x16x32_bf16 v[36:39], a[100:103], a[208:211], v[36:39]
    ds_read_b128 a[228:231], v1 offset:26624
    buffer_load_dwordx4 a[8:11], v1, s[4:7], s55 offen offset:2048
    v_mfma_f32_16x16x32_bf16 v[40:43], a[208:211], a[164:167], v[40:43]
    s_waitcnt lgkmcnt(4)
    v_mfma_f32_16x16x32_bf16 v[48:51], a[100:103], a[212:215], v[48:51]
    ds_read_b128 a[232:235], v1 offset:43008
    v_mfma_f32_16x16x32_bf16 v[52:55], a[212:215], a[164:167], v[52:55]
    s_waitcnt lgkmcnt(4)
    v_mfma_f32_16x16x32_bf16 v[60:63], a[100:103], a[216:219], v[60:63]
    ds_read_b128 a[236:239], v1 offset:59392
    buffer_load_dwordx4 a[12:15], v1, s[4:7], s55 offen offset:3072
    v_mfma_f32_16x16x32_bf16 v[64:67], a[216:219], a[164:167], v[64:67]
    s_waitcnt lgkmcnt(4)
    v_mfma_f32_16x16x32_bf16 v[72:75], a[100:103], a[220:223], v[72:75]
    ds_read_b128 a[240:243], v1 offset:11264
    v_mfma_f32_16x16x32_bf16 v[76:79], a[220:223], a[164:167], v[76:79]
    s_waitcnt lgkmcnt(4)
    v_mfma_f32_16x16x32_bf16 v[36:39], a[104:107], a[224:227], v[36:39]
    ds_read_b128 a[244:247], v1 offset:27648
    s_add_u32 s55, s55, 4096
    buffer_load_dwordx4 a[16:19], v1, s[4:7], s55 offen offset:0
    v_mfma_f32_16x16x32_bf16 v[40:43], a[224:227], a[168:171], v[40:43]
    s_waitcnt lgkmcnt(4)
    v_mfma_f32_16x16x32_bf16 v[48:51], a[104:107], a[228:231], v[48:51]
    ds_read_b128 a[248:251], v1 offset:44032
    v_mfma_f32_16x16x32_bf16 v[52:55], a[228:231], a[168:171], v[52:55]
    s_waitcnt lgkmcnt(4)
    v_mfma_f32_16x16x32_bf16 v[60:63], a[104:107], a[232:235], v[60:63]
    ds_read_b128 a[252:255], v1 offset:60416
    buffer_load_dwordx4 a[20:23], v1, s[4:7], s55 offen offset:1024
    v_mfma_f32_16x16x32_bf16 v[64:67], a[232:235], a[168:171], v[64:67]
    s_waitcnt lgkmcnt(4)
    v_mfma_f32_16x16x32_bf16 v[72:75], a[104:107], a[236:239], v[72:75]
    s_waitcnt vmcnt(14)
    s_barrier
    ds_read_b128 a[192:195], v1 offset:12288
    v_mfma_f32_16x16x32_bf16 v[76:79], a[236:239], a[168:171], v[76:79]
    s_waitcnt lgkmcnt(4)
    v_mfma_f32_16x16x32_bf16 v[36:39], a[108:111], a[240:243], v[36:39]
    ds_read_b128 a[196:199], v1 offset:28672
    buffer_load_dwordx4 a[24:27], v1, s[4:7], s55 offen offset:2048
    v_mfma_f32_16x16x32_bf16 v[40:43], a[240:243], a[172:175], v[40:43]
    s_waitcnt lgkmcnt(4)
    v_mfma_f32_16x16x32_bf16 v[48:51], a[108:111], a[244:247], v[48:51]
    ds_read_b128 a[200:203], v1 offset:45056
    v_mfma_f32_16x16x32_bf16 v[52:55], a[244:247], a[172:175], v[52:55]
    s_waitcnt lgkmcnt(4)
    s_waitcnt vmcnt(7)
    v_add_f32 v16, v16, v20
    v_mfma_f32_16x16x32_bf16 v[60:63], a[108:111], a[248:251], v[60:63]
    ds_read_b128 a[204:207], v1 offset:61440
    buffer_load_dwordx4 a[28:31], v1, s[4:7], s55 offen offset:3072
    v_mfma_f32_16x16x32_bf16 v[64:67], a[248:251], a[172:175], v[64:67]
    s_waitcnt lgkmcnt(4)
    v_mfma_f32_16x16x32_bf16 v[72:75], a[108:111], a[252:255], v[72:75]
    ds_read_b128 a[208:211], v1 offset:13312
    v_mfma_f32_16x16x32_bf16 v[76:79], a[252:255], a[172:175], v[76:79]
    s_waitcnt lgkmcnt(4)
    v_add_f32 v17, v17, v21
    v_mfma_f32_16x16x32_bf16 v[36:39], a[112:115], a[192:195], v[36:39]
    ds_read_b128 a[212:215], v1 offset:29696
    s_add_u32 s55, s55, 4096
    buffer_load_dwordx4 a[32:35], v1, s[4:7], s55 offen offset:0
    v_mfma_f32_16x16x32_bf16 v[40:43], a[192:195], a[176:179], v[40:43]
    s_waitcnt lgkmcnt(4)
    v_mfma_f32_16x16x32_bf16 v[48:51], a[112:115], a[196:199], v[48:51]
    ds_read_b128 a[216:219], v1 offset:46080
    v_mfma_f32_16x16x32_bf16 v[52:55], a[196:199], a[176:179], v[52:55]
    s_waitcnt lgkmcnt(4)
    v_add_f32 v18, v18, v22
    v_add_f32 v19, v19, v23
    v_mfma_f32_16x16x32_bf16 v[60:63], a[112:115], a[200:203], v[60:63]
    ds_read_b128 a[220:223], v1 offset:62464
    buffer_load_dwordx4 a[36:39], v1, s[4:7], s55 offen offset:1024
    v_mfma_f32_16x16x32_bf16 v[64:67], a[200:203], a[176:179], v[64:67]
    s_waitcnt lgkmcnt(4)
    v_mfma_f32_16x16x32_bf16 v[72:75], a[112:115], a[204:207], v[72:75]
    ds_read_b128 a[224:227], v1 offset:14336
    v_add_f32 v16, v16, v24
    v_mfma_f32_16x16x32_bf16 v[76:79], a[204:207], a[176:179], v[76:79]
    s_waitcnt lgkmcnt(4)
    v_add_f32 v17, v17, v25
    v_add_f32 v18, v18, v26
    v_mfma_f32_16x16x32_bf16 v[36:39], a[116:119], a[208:211], v[36:39]
    ds_read_b128 a[228:231], v1 offset:30720
    buffer_load_dwordx4 a[40:43], v1, s[4:7], s55 offen offset:2048
    v_mfma_f32_16x16x32_bf16 v[40:43], a[208:211], a[180:183], v[40:43]
    s_waitcnt lgkmcnt(4)
    v_add_f32 v19, v19, v27
    v_mfma_f32_16x16x32_bf16 v[48:51], a[116:119], a[212:215], v[48:51]
    ds_read_b128 a[232:235], v1 offset:47104
    v_add_f32 v16, v16, v28
    v_mfma_f32_16x16x32_bf16 v[52:55], a[212:215], a[180:183], v[52:55]
    s_waitcnt lgkmcnt(4)
    v_add_f32 v17, v17, v29
    v_add_f32 v18, v18, v30
    v_mfma_f32_16x16x32_bf16 v[60:63], a[116:119], a[216:219], v[60:63]
    ds_read_b128 a[236:239], v1 offset:63488
    buffer_load_dwordx4 a[44:47], v1, s[4:7], s55 offen offset:3072
    v_mfma_f32_16x16x32_bf16 v[64:67], a[216:219], a[180:183], v[64:67]
    s_waitcnt lgkmcnt(4)
    v_add_f32 v19, v19, v31
    v_permlane32_swap_b32 v16, v18
    v_mfma_f32_16x16x32_bf16 v[72:75], a[116:119], a[220:223], v[72:75]
    ds_read_b128 a[240:243], v1 offset:15360
    v_permlane32_swap_b32 v17, v19
    v_mfma_f32_16x16x32_bf16 v[76:79], a[220:223], a[180:183], v[76:79]
    s_waitcnt lgkmcnt(4)
    v_add_f32 v16, v16, v18
    v_add_f32 v17, v17, v19
    v_mov_b32 v18, v16
    s_waitcnt vmcnt(18)
    v_mfma_f32_16x16x32_bf16 v[36:39], a[120:123], a[224:227], v[36:39]
    ds_read_b128 a[244:247], v1 offset:31744
    s_add_u32 s55, s55, 4096
    buffer_load_dwordx4 a[48:51], v1, s[4:7], s55 offen offset:0
    v_mfma_f32_16x16x32_bf16 v[40:43], a[224:227], a[184:187], v[40:43]
    s_waitcnt lgkmcnt(4)
    v_mov_b32 v19, v17
    v_permlane16_swap_b32 v16, v18
    s_nop 0
    v_permlane16_swap_b32 v17, v19
    v_mfma_f32_16x16x32_bf16 v[48:51], a[120:123], a[228:231], v[48:51]
    ds_read_b128 a[248:251], v1 offset:48128
    v_add_f32 v16, v16, v18
    v_mfma_f32_16x16x32_bf16 v[52:55], a[228:231], a[184:187], v[52:55]
    s_waitcnt lgkmcnt(4)
    v_add_f32 v17, v17, v19
    v_add_f32_dpp v16, v16, v16 row_ror:8 row_mask:0xf bank_mask:0xf
    s_nop 0
    v_add_f32_dpp v17, v17, v17 row_ror:8 row_mask:0xf bank_mask:0xf
    v_mfma_f32_16x16x32_bf16 v[60:63], a[120:123], a[232:235], v[60:63]
    ds_read_b128 a[252:255], v1 offset:64512
    buffer_load_dwordx4 a[52:55], v1, s[4:7], s55 offen offset:1024
    v_mul_f32 v16, 0x3b000000, v16
    v_mul_f32 v17, 0x3b000000, v17
    v_mfma_f32_16x16x32_bf16 v[64:67], a[232:235], a[184:187], v[64:67]
    s_waitcnt lgkmcnt(4)
    ds_read_b128 a[192:195], v1 offset:0
    v_fma_f32 v17, -v16, v16, v17
    v_max_f32 v17, 0, v17
    v_add_f32 v18, 0x3727c5ac, v17
    v_rsq_f32 v18, v18
    s_nop 0
    v_mul_f32_e64 v19, -v16, v18
    ds_write2_b32 v9, v18, v19 offset0:0 offset1:64
    v_mfma_f32_16x16x32_bf16 v[72:75], a[120:123], a[236:239], v[72:75]
    ds_read_b128 a[196:199], v1 offset:16384
    v_mfma_f32_16x16x32_bf16 v[76:79], a[236:239], a[184:187], v[76:79]
    s_waitcnt lgkmcnt(6)
    ds_read_b128 a[200:203], v1 offset:32768
    s_waitcnt lgkmcnt(2)
    s_barrier
    ds_read2_b32 v[28:29], v12 offset0:0 offset1:64
    ds_read_b128 v[96:99], v13 offset:0
    ds_read_b128 v[100:103], v13 offset:256
    s_waitcnt vmcnt(18)
    v_mfma_f32_16x16x32_bf16 v[36:39], a[124:127], a[240:243], v[36:39]
    ds_read_b128 a[204:207], v1 offset:49152
    buffer_load_dwordx4 a[56:59], v1, s[4:7], s55 offen offset:2048
    v_mfma_f32_16x16x32_bf16 v[40:43], a[240:243], a[188:191], v[40:43]
    s_waitcnt lgkmcnt(10)
    ds_read_b128 a[208:211], v1 offset:1024
    v_mfma_f32_16x16x32_bf16 v[48:51], a[124:127], a[244:247], v[48:51]
    ds_read_b128 a[212:215], v1 offset:17408
    v_mfma_f32_16x16x32_bf16 v[52:55], a[244:247], a[188:191], v[52:55]
    s_waitcnt lgkmcnt(11)
    ds_read_b128 a[216:219], v1 offset:33792
    v_mfma_f32_16x16x32_bf16 v[60:63], a[124:127], a[248:251], v[60:63]
    ds_read_b128 a[220:223], v1 offset:50176
    buffer_load_dwordx4 a[60:63], v1, s[4:7], s55 offen offset:3072
    v_mfma_f32_16x16x32_bf16 v[64:67], a[248:251], a[188:191], v[64:67]
    s_waitcnt lgkmcnt(12)
    ds_read_b128 a[224:227], v1 offset:2048
    v_mfma_f32_16x16x32_bf16 v[72:75], a[124:127], a[252:255], v[72:75]
    ds_read_b128 a[228:231], v1 offset:18432
    v_mfma_f32_16x16x32_bf16 v[76:79], a[252:255], a[188:191], v[76:79]
    s_waitcnt lgkmcnt(13)
    ds_read2_b32 v[30:31], v12 offset0:16 offset1:80
    ds_read_b128 v[16:19], v13 offset:64
    ds_read_b128 v[92:95], v13 offset:320
    s_waitcnt lgkmcnt(10)
    v_pk_mul_f32 v[40:41], v[40:41], v[96:97]
    v_pk_mul_f32 v[42:43], v[42:43], v[98:99]
    v_pk_fma_f32 v[40:41], v[100:101], v[88:89], v[40:41] op_sel_hi:[1,0,1]
    v_pk_fma_f32 v[42:43], v[102:103], v[88:89], v[42:43] op_sel_hi:[1,0,1]
    v_pk_mul_f32 v[36:37], v[36:37], v[28:29] op_sel_hi:[1,0]
    v_pk_mul_f32 v[38:39], v[38:39], v[28:29] op_sel_hi:[1,0]
    v_pk_fma_f32 v[36:37], v[84:85], v[28:29], v[36:37] op_sel:[0,1,0] op_sel_hi:[1,1,1]
    v_pk_fma_f32 v[38:39], v[86:87], v[28:29], v[38:39] op_sel:[0,1,0] op_sel_hi:[1,1,1]
    v_cvt_pk_bf16_f32 v24, v40, v41
    v_cvt_pk_bf16_f32 v25, v42, v43
    v_cvt_pk_bf16_f32 v20, v36, v37
    v_cvt_pk_bf16_f32 v21, v38, v39
    v_pk_mul_f32 v[36:37], v[28:29], v[4:5] op_sel_hi:[1,0]
    ds_read2_b32 v[28:29], v12 offset0:32 offset1:96
    ds_read_b128 v[96:99], v13 offset:128
    ds_read_b128 v[100:103], v13 offset:384
    s_waitcnt lgkmcnt(3)
    v_pk_mul_f32 v[52:53], v[52:53], v[16:17]
    v_pk_mul_f32 v[54:55], v[54:55], v[18:19]
    v_pk_fma_f32 v[52:53], v[92:93], v[88:89], v[52:53] op_sel_hi:[1,0,1]
    v_pk_fma_f32 v[54:55], v[94:95], v[88:89], v[54:55] op_sel_hi:[1,0,1]
    v_pk_mul_f32 v[48:49], v[48:49], v[30:31] op_sel_hi:[1,0]
    v_pk_mul_f32 v[50:51], v[50:51], v[30:31] op_sel_hi:[1,0]
    v_pk_fma_f32 v[48:49], v[84:85], v[30:31], v[48:49] op_sel:[0,1,0] op_sel_hi:[1,1,1]
    v_pk_fma_f32 v[50:51], v[86:87], v[30:31], v[50:51] op_sel:[0,1,0] op_sel_hi:[1,1,1]
    v_cvt_pk_bf16_f32 v26, v52, v53
    v_cvt_pk_bf16_f32 v27, v54, v55
    v_cvt_pk_bf16_f32 v22, v48, v49
    v_cvt_pk_bf16_f32 v23, v50, v51
    v_pk_mul_f32 v[48:49], v[30:31], v[4:5] op_sel_hi:[1,0]
    buffer_store_dwordx4 v[24:27], v1, s[4:7], s30 offen offset:0 sc1
    v_permlane32_swap_b32 v20, v22
    v_permlane32_swap_b32 v21, v23
    buffer_store_dwordx4 v[20:23], v11, s[4:7], s29 offen offset:0 sc1
    ds_read2_b32 v[30:31], v12 offset0:48 offset1:112
    ds_read_b128 v[16:19], v13 offset:192
    ds_read_b128 v[92:95], v13 offset:448
    s_waitcnt lgkmcnt(3)
    v_pk_mul_f32 v[64:65], v[64:65], v[96:97]
    v_pk_mul_f32 v[66:67], v[66:67], v[98:99]
    v_pk_fma_f32 v[64:65], v[100:101], v[88:89], v[64:65] op_sel_hi:[1,0,1]
    v_pk_fma_f32 v[66:67], v[102:103], v[88:89], v[66:67] op_sel_hi:[1,0,1]
    v_pk_mul_f32 v[60:61], v[60:61], v[28:29] op_sel_hi:[1,0]
    v_pk_mul_f32 v[62:63], v[62:63], v[28:29] op_sel_hi:[1,0]
    v_pk_fma_f32 v[60:61], v[84:85], v[28:29], v[60:61] op_sel:[0,1,0] op_sel_hi:[1,1,1]
    v_pk_fma_f32 v[62:63], v[86:87], v[28:29], v[62:63] op_sel:[0,1,0] op_sel_hi:[1,1,1]
    v_cvt_pk_bf16_f32 v24, v64, v65
    v_cvt_pk_bf16_f32 v25, v66, v67
    v_cvt_pk_bf16_f32 v20, v60, v61
    v_cvt_pk_bf16_f32 v21, v62, v63
    v_pk_mul_f32 v[60:61], v[28:29], v[4:5] op_sel_hi:[1,0]
    s_waitcnt lgkmcnt(0)
    v_pk_mul_f32 v[76:77], v[76:77], v[16:17]
    v_pk_mul_f32 v[78:79], v[78:79], v[18:19]
    v_pk_fma_f32 v[76:77], v[92:93], v[88:89], v[76:77] op_sel_hi:[1,0,1]
    v_pk_fma_f32 v[78:79], v[94:95], v[88:89], v[78:79] op_sel_hi:[1,0,1]
    v_pk_mul_f32 v[72:73], v[72:73], v[30:31] op_sel_hi:[1,0]
    v_pk_mul_f32 v[74:75], v[74:75], v[30:31] op_sel_hi:[1,0]
    v_pk_fma_f32 v[72:73], v[84:85], v[30:31], v[72:73] op_sel:[0,1,0] op_sel_hi:[1,1,1]
    v_pk_fma_f32 v[74:75], v[86:87], v[30:31], v[74:75] op_sel:[0,1,0] op_sel_hi:[1,1,1]
    v_cvt_pk_bf16_f32 v26, v76, v77
    v_cvt_pk_bf16_f32 v27, v78, v79
    v_cvt_pk_bf16_f32 v22, v72, v73
    v_cvt_pk_bf16_f32 v23, v74, v75
    v_pk_mul_f32 v[72:73], v[30:31], v[4:5] op_sel_hi:[1,0]
    buffer_store_dwordx4 v[24:27], v1, s[4:7], s30 offen offset:1024 sc1
    v_permlane32_swap_b32 v20, v22
    v_permlane32_swap_b32 v21, v23
    buffer_store_dwordx4 v[20:23], v11, s[4:7], s29 offen offset:1024 sc1
    s_waitcnt vmcnt(19)
    v_mfma_f32_16x16x32_bf16 v[32:35], a[0:3], a[192:195], 0
    s_waitcnt lgkmcnt(15)
    ds_read_b128 a[232:235], v1 offset:34816
    v_mfma_f32_16x16x32_bf16 v[44:47], a[0:3], a[196:199], 0
    s_waitcnt lgkmcnt(15)
    ds_read_b128 a[236:239], v1 offset:51200
    v_mfma_f32_16x16x32_bf16 v[56:59], a[0:3], a[200:203], 0
    s_waitcnt lgkmcnt(15)
    ds_read_b128 a[240:243], v1 offset:3072
    v_mfma_f32_16x16x32_bf16 v[68:71], a[0:3], a[204:207], 0
    s_waitcnt lgkmcnt(15)
    ds_read_b128 a[244:247], v1 offset:19456
    s_waitcnt vmcnt(18)
    v_mfma_f32_16x16x32_bf16 v[32:35], a[4:7], a[208:211], v[32:35]
    s_waitcnt lgkmcnt(15)
    ds_read_b128 a[248:251], v1 offset:35840
    v_mfma_f32_16x16x32_bf16 v[44:47], a[4:7], a[212:215], v[44:47]
    s_waitcnt lgkmcnt(15)
    ds_read_b128 a[252:255], v1 offset:52224
    v_mfma_f32_16x16x32_bf16 v[56:59], a[4:7], a[216:219], v[56:59]
    s_waitcnt lgkmcnt(15)
    ds_read_b128 a[192:195], v1 offset:4096
    v_mfma_f32_16x16x32_bf16 v[68:71], a[4:7], a[220:223], v[68:71]
    s_waitcnt lgkmcnt(15)
    ds_read_b128 a[196:199], v1 offset:20480
    s_waitcnt vmcnt(17)
    v_mfma_f32_16x16x32_bf16 v[32:35], a[8:11], a[224:227], v[32:35]
    s_waitcnt lgkmcnt(15)
    ds_read_b128 a[200:203], v1 offset:36864
    v_mfma_f32_16x16x32_bf16 v[44:47], a[8:11], a[228:231], v[44:47]
    s_waitcnt lgkmcnt(8)
    ds_read_b128 a[204:207], v1 offset:53248
    v_mfma_f32_16x16x32_bf16 v[56:59], a[8:11], a[232:235], v[56:59]
    s_waitcnt lgkmcnt(8)
    ds_read_b128 a[208:211], v1 offset:5120
    v_mfma_f32_16x16x32_bf16 v[68:71], a[8:11], a[236:239], v[68:71]
    s_waitcnt lgkmcnt(8)
    ds_read_b128 a[212:215], v1 offset:21504
    s_waitcnt vmcnt(16)
    v_mfma_f32_16x16x32_bf16 v[32:35], a[12:15], a[240:243], v[32:35]
    s_waitcnt lgkmcnt(8)
    ds_read_b128 a[216:219], v1 offset:37888
    v_mfma_f32_16x16x32_bf16 v[44:47], a[12:15], a[244:247], v[44:47]
    s_waitcnt lgkmcnt(8)
    ds_read_b128 a[220:223], v1 offset:54272
    v_mfma_f32_16x16x32_bf16 v[56:59], a[12:15], a[248:251], v[56:59]
    s_waitcnt lgkmcnt(8)
    ds_read_b128 a[224:227], v1 offset:6144
    v_mfma_f32_16x16x32_bf16 v[68:71], a[12:15], a[252:255], v[68:71]
    s_waitcnt lgkmcnt(8)
    ds_read_b128 a[228:231], v1 offset:22528
    s_waitcnt vmcnt(15)
    v_mfma_f32_16x16x32_bf16 v[32:35], a[16:19], a[192:195], v[32:35]
    s_waitcnt lgkmcnt(8)
    ds_read_b128 a[232:235], v1 offset:38912
    v_mfma_f32_16x16x32_bf16 v[44:47], a[16:19], a[196:199], v[44:47]
    s_waitcnt lgkmcnt(8)
    ds_read_b128 a[236:239], v1 offset:55296
    v_mfma_f32_16x16x32_bf16 v[56:59], a[16:19], a[200:203], v[56:59]
    s_waitcnt lgkmcnt(8)
    ds_read_b128 a[240:243], v1 offset:7168
    v_mfma_f32_16x16x32_bf16 v[68:71], a[16:19], a[204:207], v[68:71]
    s_waitcnt lgkmcnt(8)
    ds_read_b128 a[244:247], v1 offset:23552
    s_waitcnt vmcnt(14)
    v_mfma_f32_16x16x32_bf16 v[32:35], a[20:23], a[208:211], v[32:35]
    s_waitcnt lgkmcnt(8)
    ds_read_b128 a[248:251], v1 offset:39936
    v_mfma_f32_16x16x32_bf16 v[44:47], a[20:23], a[212:215], v[44:47]
    s_waitcnt lgkmcnt(8)
    ds_read_b128 a[252:255], v1 offset:56320
    v_mfma_f32_16x16x32_bf16 v[56:59], a[20:23], a[216:219], v[56:59]
    s_waitcnt lgkmcnt(8)
    ds_read_b128 a[192:195], v1 offset:8192
    v_mfma_f32_16x16x32_bf16 v[68:71], a[20:23], a[220:223], v[68:71]
    s_waitcnt lgkmcnt(8)
    ds_read_b128 a[196:199], v1 offset:24576
    s_waitcnt vmcnt(13)
    v_mfma_f32_16x16x32_bf16 v[32:35], a[24:27], a[224:227], v[32:35]
    s_waitcnt lgkmcnt(8)
    ds_read_b128 a[200:203], v1 offset:40960
    v_mfma_f32_16x16x32_bf16 v[44:47], a[24:27], a[228:231], v[44:47]
    s_waitcnt lgkmcnt(8)
    ds_read_b128 a[204:207], v1 offset:57344
    v_mfma_f32_16x16x32_bf16 v[56:59], a[24:27], a[232:235], v[56:59]
    s_waitcnt lgkmcnt(8)
    ds_read_b128 a[208:211], v1 offset:9216
    v_mfma_f32_16x16x32_bf16 v[68:71], a[24:27], a[236:239], v[68:71]
    s_waitcnt lgkmcnt(8)
    ds_read_b128 a[212:215], v1 offset:25600
    s_waitcnt vmcnt(12)
    v_mfma_f32_16x16x32_bf16 v[32:35], a[28:31], a[240:243], v[32:35]
    s_waitcnt lgkmcnt(8)
    ds_read_b128 a[216:219], v1 offset:41984
    v_mfma_f32_16x16x32_bf16 v[44:47], a[28:31], a[244:247], v[44:47]
    s_waitcnt lgkmcnt(8)
    ds_read_b128 a[220:223], v1 offset:58368
    v_mfma_f32_16x16x32_bf16 v[56:59], a[28:31], a[248:251], v[56:59]
    s_waitcnt lgkmcnt(8)
    ds_read_b128 a[224:227], v1 offset:10240
    v_mfma_f32_16x16x32_bf16 v[68:71], a[28:31], a[252:255], v[68:71]
    s_waitcnt lgkmcnt(8)
    ds_read_b128 a[228:231], v1 offset:26624
    s_waitcnt vmcnt(11)
    v_mfma_f32_16x16x32_bf16 v[32:35], a[32:35], a[192:195], v[32:35]
    s_waitcnt lgkmcnt(8)
    ds_read_b128 a[232:235], v1 offset:43008
    v_mfma_f32_16x16x32_bf16 v[44:47], a[32:35], a[196:199], v[44:47]
    s_waitcnt lgkmcnt(8)
    ds_read_b128 a[236:239], v1 offset:59392
    v_mfma_f32_16x16x32_bf16 v[56:59], a[32:35], a[200:203], v[56:59]
    s_waitcnt lgkmcnt(8)
    ds_read_b128 a[240:243], v1 offset:11264
    v_mfma_f32_16x16x32_bf16 v[68:71], a[32:35], a[204:207], v[68:71]
    s_waitcnt lgkmcnt(8)
    ds_read_b128 a[244:247], v1 offset:27648
    s_waitcnt vmcnt(10)
    v_mfma_f32_16x16x32_bf16 v[32:35], a[36:39], a[208:211], v[32:35]
    s_waitcnt lgkmcnt(8)
    ds_read_b128 a[248:251], v1 offset:44032
    v_mfma_f32_16x16x32_bf16 v[44:47], a[36:39], a[212:215], v[44:47]
    s_waitcnt lgkmcnt(8)
    ds_read_b128 a[252:255], v1 offset:60416
    v_mfma_f32_16x16x32_bf16 v[56:59], a[36:39], a[216:219], v[56:59]
    s_waitcnt lgkmcnt(8)
    ds_read_b128 a[192:195], v1 offset:12288
    v_mfma_f32_16x16x32_bf16 v[68:71], a[36:39], a[220:223], v[68:71]
    s_waitcnt lgkmcnt(8)
    ds_read_b128 a[196:199], v1 offset:28672
    s_waitcnt vmcnt(9)
    v_mfma_f32_16x16x32_bf16 v[32:35], a[40:43], a[224:227], v[32:35]
    s_waitcnt lgkmcnt(8)
    ds_read_b128 a[200:203], v1 offset:45056
    v_mfma_f32_16x16x32_bf16 v[44:47], a[40:43], a[228:231], v[44:47]
    s_waitcnt lgkmcnt(8)
    ds_read_b128 a[204:207], v1 offset:61440
    v_mfma_f32_16x16x32_bf16 v[56:59], a[40:43], a[232:235], v[56:59]
    s_waitcnt lgkmcnt(8)
    ds_read_b128 a[208:211], v1 offset:13312
    v_mfma_f32_16x16x32_bf16 v[68:71], a[40:43], a[236:239], v[68:71]
    s_waitcnt lgkmcnt(8)
    ds_read_b128 a[212:215], v1 offset:29696
    s_waitcnt vmcnt(8)
    v_mfma_f32_16x16x32_bf16 v[32:35], a[44:47], a[240:243], v[32:35]
    s_waitcnt lgkmcnt(8)
    ds_read_b128 a[216:219], v1 offset:46080
    v_mfma_f32_16x16x32_bf16 v[44:47], a[44:47], a[244:247], v[44:47]
    s_waitcnt lgkmcnt(8)
    ds_read_b128 a[220:223], v1 offset:62464
    v_mfma_f32_16x16x32_bf16 v[56:59], a[44:47], a[248:251], v[56:59]
    s_waitcnt lgkmcnt(8)
    ds_read_b128 a[224:227], v1 offset:14336
    v_mfma_f32_16x16x32_bf16 v[68:71], a[44:47], a[252:255], v[68:71]
    s_waitcnt lgkmcnt(8)
    ds_read_b128 a[228:231], v1 offset:30720
    s_waitcnt vmcnt(7)
    v_mfma_f32_16x16x32_bf16 v[32:35], a[48:51], a[192:195], v[32:35]
    s_waitcnt lgkmcnt(8)
    ds_read_b128 a[232:235], v1 offset:47104
    v_mfma_f32_16x16x32_bf16 v[44:47], a[48:51], a[196:199], v[44:47]
    s_waitcnt lgkmcnt(8)
    ds_read_b128 a[236:239], v1 offset:63488
    v_mfma_f32_16x16x32_bf16 v[56:59], a[48:51], a[200:203], v[56:59]
    s_waitcnt lgkmcnt(8)
    ds_read_b128 a[240:243], v1 offset:15360
    v_mfma_f32_16x16x32_bf16 v[68:71], a[48:51], a[204:207], v[68:71]
    s_waitcnt lgkmcnt(8)
    ds_read_b128 a[244:247], v1 offset:31744
    s_waitcnt vmcnt(6)
    v_mfma_f32_16x16x32_bf16 v[32:35], a[52:55], a[208:211], v[32:35]
    s_waitcnt lgkmcnt(8)
    ds_read_b128 a[248:251], v1 offset:48128
    v_mfma_f32_16x16x32_bf16 v[44:47], a[52:55], a[212:215], v[44:47]
    s_waitcnt lgkmcnt(8)
    ds_read_b128 a[252:255], v1 offset:64512
    v_mfma_f32_16x16x32_bf16 v[56:59], a[52:55], a[216:219], v[56:59]
    s_waitcnt lgkmcnt(8)
    v_mfma_f32_16x16x32_bf16 v[68:71], a[52:55], a[220:223], v[68:71]
    s_waitcnt lgkmcnt(7)
    s_add_u32 s14, s14, 1536
    s_addc_u32 s15, s15, 0
    s_add_u32 s38, s38, 1536
    s_addc_u32 s39, s39, 0
    s_add_u32 s60, s60, 1536
    s_addc_u32 s61, s61, 0
    s_add_u32 s66, s66, 1536
    s_addc_u32 s67, s67, 0
    s_add_u32 s86, s86, 1536
    s_addc_u32 s87, s87, 0
    s_waitcnt vmcnt(0)
    s_barrier
    s_cmp_lg_u32 s8, 0
    s_cbranch_scc1 L_arr21
    s_atomic_add s36, s[38:39], 0
    s_atomic_add s36, s[38:39], 128
    s_atomic_add s36, s[38:39], 256
    s_atomic_add s36, s[38:39], 384
L_arr21:
    s_waitcnt vmcnt(5)
    v_mfma_f32_16x16x32_bf16 v[32:35], a[56:59], a[224:227], v[32:35]
    s_waitcnt lgkmcnt(6)
    v_mfma_f32_16x16x32_bf16 v[44:47], a[56:59], a[228:231], v[44:47]
    s_waitcnt lgkmcnt(5)
    v_mfma_f32_16x16x32_bf16 v[56:59], a[56:59], a[232:235], v[56:59]
    s_waitcnt lgkmcnt(4)
    v_mfma_f32_16x16x32_bf16 v[68:71], a[56:59], a[236:239], v[68:71]
    s_waitcnt lgkmcnt(3)
    s_waitcnt vmcnt(4)
    v_mfma_f32_16x16x32_bf16 v[32:35], a[60:63], a[240:243], v[32:35]
    s_waitcnt lgkmcnt(2)
    v_mfma_f32_16x16x32_bf16 v[44:47], a[60:63], a[244:247], v[44:47]
    s_waitcnt lgkmcnt(1)
    v_mfma_f32_16x16x32_bf16 v[56:59], a[60:63], a[248:251], v[56:59]
    s_waitcnt lgkmcnt(0)
    v_mfma_f32_16x16x32_bf16 v[68:71], a[60:63], a[252:255], v[68:71]
    s_nop 1
    v_pk_mul_f32 v[32:33], v[32:33], v[36:37] op_sel_hi:[1,0]
    v_pk_mul_f32 v[34:35], v[34:35], v[36:37] op_sel_hi:[1,0]
    v_pk_fma_f32 v[32:33], v[80:81], v[36:37], v[32:33] op_sel:[0,1,0] op_sel_hi:[1,1,1]
    v_pk_fma_f32 v[34:35], v[82:83], v[36:37], v[34:35] op_sel:[0,1,0] op_sel_hi:[1,1,1]
    v_cvt_pk_bf16_f32 v16, v32, v33
    v_cvt_pk_bf16_f32 v17, v34, v35
    v_pk_mul_f32 v[44:45], v[44:45], v[48:49] op_sel_hi:[1,0]
    v_pk_mul_f32 v[46:47], v[46:47], v[48:49] op_sel_hi:[1,0]
    v_pk_fma_f32 v[44:45], v[80:81], v[48:49], v[44:45] op_sel:[0,1,0] op_sel_hi:[1,1,1]
    v_pk_fma_f32 v[46:47], v[82:83], v[48:49], v[46:47] op_sel:[0,1,0] op_sel_hi:[1,1,1]
    v_cvt_pk_bf16_f32 v18, v44, v45
    v_cvt_pk_bf16_f32 v19, v46, v47
    s_nop 0
    v_permlane32_swap_b32 v16, v18
    v_permlane32_swap_b32 v17, v19
    buffer_store_dwordx4 v[16:19], v10, s[4:7], s28 offen offset:0 sc1
    v_pk_mul_f32 v[56:57], v[56:57], v[60:61] op_sel_hi:[1,0]
    v_pk_mul_f32 v[58:59], v[58:59], v[60:61] op_sel_hi:[1,0]
    v_pk_fma_f32 v[56:57], v[80:81], v[60:61], v[56:57] op_sel:[0,1,0] op_sel_hi:[1,1,1]
    v_pk_fma_f32 v[58:59], v[82:83], v[60:61], v[58:59] op_sel:[0,1,0] op_sel_hi:[1,1,1]
    v_cvt_pk_bf16_f32 v20, v56, v57
    v_cvt_pk_bf16_f32 v21, v58, v59
    v_pk_mul_f32 v[68:69], v[68:69], v[72:73] op_sel_hi:[1,0]
    v_pk_mul_f32 v[70:71], v[70:71], v[72:73] op_sel_hi:[1,0]
    v_pk_fma_f32 v[68:69], v[80:81], v[72:73], v[68:69] op_sel:[0,1,0] op_sel_hi:[1,1,1]
    v_pk_fma_f32 v[70:71], v[82:83], v[72:73], v[70:71] op_sel:[0,1,0] op_sel_hi:[1,1,1]
    v_cvt_pk_bf16_f32 v22, v68, v69
    v_cvt_pk_bf16_f32 v23, v70, v71
    s_nop 0
    v_permlane32_swap_b32 v20, v22
    v_permlane32_swap_b32 v21, v23
    buffer_store_dwordx4 v[20:23], v10, s[4:7], s28 offen offset:1024 sc1
    s_mov_b32 s11, 1
    s_mov_b32 s78, 0x10000000
    s_mov_b32 s82, 0x10000000
    s_mov_b32 s83, 0x10000000
    s_mov_b32 s84, 0x10000000
    s_mov_b32 s85, 0x10000000
    s_mov_b32 s91, 0x10000000
    s_lshl_b32 s20, s9, 16
    s_add_u32 s20, s20, s13
    s_lshl_b32 s21, s10, 13
    s_lshl_b32 s22, s8, 11
    s_add_u32 s21, s21, s22
    s_add_u32 s21, s21, s20
    s_add_u32 s21, s21, 4194304
    s_and_b32 s22, s8, 1
    s_lshl_b32 s22, s22, 12
    s_lshl_b32 s24, s54, 16
    s_add_u32 s24, s24, s22
    s_mul_i32 s23, s54, 2097152
    s_add_u32 s23, s23, s22
    s_add_u32 s23, s23, s20
    s_add_u32 s23, s23, 6291456
    v_mov_b32 v8, 0xdddddddd
    v_and_b32 v9, 7, v0
    v_lshlrev_b32 v9, 12, v9
    v_mov_b32 v44, 0x3f803f80
    v_mov_b32 v45, 0x3f803f80
    v_mov_b32 v46, 0x3f803f80
    v_mov_b32 v47, 0x3f803f80
    s_lshl_b32 s25, s8, 10
    s_add_u32 s25, s25, 131072
    v_add_u32 v43, s25, v1
    v_and_b32 v40, 15, v0
    v_lshrrev_b32 v41, 5, v0
    v_lshlrev_b32 v41, 8, v41
    v_lshl_add_u32 v40, v40, 4, v41
    v_add_u32 v40, 65536, v40
    v_and_b32 v41, 4, v0
    v_lshlrev_b32 v41, 4, v41
    v_add_u32 v41, 131072, v41
    v_and_b32 v42, 11, v0
    v_cmp_eq_u32 vcc, 0, v42
    v_mov_b32 v42, 0x30000
    s_nop 0
    v_cndmask_b32 v41, v42, v41, vcc
    v_and_b32 v42, 16, v0
    v_cmp_eq_u32 vcc, 0, v42
    v_mov_b32 v42, 4096
    s_nop 0
    v_cndmask_b32 v3, v41, v40, vcc
    v_cndmask_b32 v2, 0, v42, vcc
    v_mov_b32 v64, 0
    v_mov_b32 v65, 0
    v_mov_b32 v66, 0
    v_mov_b32 v67, 0
    v_mov_b32 v68, 0
    v_mov_b32 v69, 0
    v_mov_b32 v70, 0
    v_mov_b32 v71, 0
    v_mov_b32 v72, 0
    v_mov_b32 v73, 0
    v_mov_b32 v74, 0
    v_mov_b32 v75, 0
    v_mov_b32 v76, 0
    v_mov_b32 v77, 0
    v_mov_b32 v78, 0
    v_mov_b32 v79, 0
    v_mov_b32 v80, 0
    v_mov_b32 v81, 0
    v_mov_b32 v82, 0
    v_mov_b32 v83, 0
    v_mov_b32 v84, 0
    v_mov_b32 v85, 0
    v_mov_b32 v86, 0
    v_mov_b32 v87, 0
    v_mov_b32 v88, 0
    v_mov_b32 v89, 0
    v_mov_b32 v90, 0
    v_mov_b32 v91, 0
    v_mov_b32 v92, 0
    v_mov_b32 v93, 0
    v_mov_b32 v94, 0
    v_mov_b32 v95, 0
    s_lshl_b32 s25, s10, 18
    s_lshl_b32 s22, s8, 16
    s_add_u32 s25, s25, s22
    s_lshl_b32 s22, s9, 10
    s_add_u32 s25, s25, s22
    s_add_u32 s25, s25, s13
    s_add_u32 s25, s25, 10485760
    s_waitcnt vmcnt(0) lgkmcnt(0)
    s_barrier
    s_cmp_lg_u32 s8, 0
    s_cbranch_scc1 L_arr22
    s_atomic_add s36, s[66:67], 0
L_arr22:
    s_branch L_att
L_done:
L_end:
    s_endpgm
L_att_nold:
    v_exp_f32 v32, v32
    v_exp_f32 v33, v33
    v_smfmac_f32_32x32x32_bf16 v[80:95], v[4:7], v[56:63], v8
    ds_read_b128 v[24:27], v1 offset:45056
    v_exp_f32 v34, v34
    v_exp_f32 v35, v35
    v_exp_f32 v36, v36
    v_exp_f32 v37, v37
    v_mfma_f32_32x32x16_bf16 v[48:63], v[96:99], v[20:23], 0
    v_add_u32 v3, v2, v3
    ds_read_b128 v[28:31], v3 offset:0
    v_exp_f32 v38, v38
    v_exp_f32 v39, v39
    v_exp_f32 v40, v40
    v_exp_f32 v41, v41
    v_smfmac_f32_32x32x32_bf16 v[64:79], v[10:13], v[32:39], v8
    ds_read_b128 v[4:7], v3 offset:512
    v_exp_f32 v42, v42
    v_exp_f32 v43, v43
    v_exp_f32 v44, v44
    v_exp_f32 v45, v45
    v_exp_f32 v46, v46
    v_exp_f32 v47, v47
    v_exp_f32 v48, v48
    v_exp_f32 v49, v49
    v_smfmac_f32_32x32x32_bf16 v[64:79], v[100:103], v[40:47], v8
    s_waitcnt lgkmcnt(2)
    v_exp_f32 v50, v50
    v_exp_f32 v51, v51
    v_exp_f32 v52, v52
    v_exp_f32 v53, v53
    v_mfma_f32_32x32x16_bf16 v[32:47], v[24:27], v[16:19], 0
    v_exp_f32 v54, v54
    v_exp_f32 v55, v55
    v_exp_f32 v56, v56
    v_exp_f32 v57, v57
    v_smfmac_f32_32x32x32_bf16 v[80:95], v[10:13], v[48:55], v8
    s_waitcnt lgkmcnt(0)
    v_exp_f32 v58, v58
    v_exp_f32 v59, v59
    v_exp_f32 v60, v60
    v_exp_f32 v61, v61
    v_exp_f32 v62, v62
    v_exp_f32 v63, v63
    v_exp_f32 v32, v32
    v_exp_f32 v33, v33
    v_smfmac_f32_32x32x32_bf16 v[80:95], v[100:103], v[56:63], v8
    ds_read_b128 v[96:99], v1 offset:46080
    v_exp_f32 v34, v34
    v_exp_f32 v35, v35
    v_exp_f32 v36, v36
    v_exp_f32 v37, v37
    v_mfma_f32_32x32x16_bf16 v[48:63], v[24:27], v[20:23], 0
    ds_read_b128 v[10:13], v3 offset:1024
    v_exp_f32 v38, v38
    v_exp_f32 v39, v39
    v_exp_f32 v40, v40
    v_exp_f32 v41, v41
    v_smfmac_f32_32x32x32_bf16 v[64:79], v[28:31], v[32:39], v8
    ds_read_b128 v[100:103], v3 offset:1536
    v_exp_f32 v42, v42
    v_exp_f32 v43, v43
    v_exp_f32 v44, v44
    v_exp_f32 v45, v45
    v_exp_f32 v46, v46
    v_exp_f32 v47, v47
    v_exp_f32 v48, v48
    v_exp_f32 v49, v49
    v_smfmac_f32_32x32x32_bf16 v[64:79], v[4:7], v[40:47], v8
    s_waitcnt lgkmcnt(2)
    v_exp_f32 v50, v50
    v_exp_f32 v51, v51
    v_exp_f32 v52, v52
    v_exp_f32 v53, v53
    v_mfma_f32_32x32x16_bf16 v[32:47], v[96:99], v[16:19], 0
    v_exp_f32 v54, v54
    v_exp_f32 v55, v55
    v_exp_f32 v56, v56
    v_exp_f32 v57, v57
    v_smfmac_f32_32x32x32_bf16 v[80:95], v[28:31], v[48:55], v8
    s_waitcnt lgkmcnt(0)
    v_exp_f32 v58, v58
    v_exp_f32 v59, v59
    v_exp_f32 v60, v60
    v_exp_f32 v61, v61
    v_exp_f32 v62, v62
    v_exp_f32 v63, v63
    v_exp_f32 v32, v32
    v_exp_f32 v33, v33
    v_smfmac_f32_32x32x32_bf16 v[80:95], v[4:7], v[56:63], v8
    ds_read_b128 v[24:27], v1 offset:47104
    v_exp_f32 v34, v34
    v_exp_f32 v35, v35
    v_exp_f32 v36, v36
    v_exp_f32 v37, v37
    v_mfma_f32_32x32x16_bf16 v[48:63], v[96:99], v[20:23], 0
    ds_read_b128 v[28:31], v3 offset:2048
    v_exp_f32 v38, v38
    v_exp_f32 v39, v39
    v_exp_f32 v40, v40
    v_exp_f32 v41, v41
    v_smfmac_f32_32x32x32_bf16 v[64:79], v[10:13], v[32:39], v8
    ds_read_b128 v[4:7], v3 offset:2560
    v_exp_f32 v42, v42
    v_exp_f32 v43, v43
    v_exp_f32 v44, v44
    v_exp_f32 v45, v45
    v_exp_f32 v46, v46
    v_exp_f32 v47, v47
    v_exp_f32 v48, v48
    v_exp_f32 v49, v49
    v_smfmac_f32_32x32x32_bf16 v[64:79], v[100:103], v[40:47], v8
    s_waitcnt lgkmcnt(2)
    v_exp_f32 v50, v50
    v_exp_f32 v51, v51
    v_exp_f32 v52, v52
    v_exp_f32 v53, v53
    v_mfma_f32_32x32x16_bf16 v[32:47], v[24:27], v[16:19], 0
    v_exp_f32 v54, v54
    v_exp_f32 v55, v55
    v_exp_f32 v56, v56
    v_exp_f32 v57, v57
    v_smfmac_f32_32x32x32_bf16 v[80:95], v[10:13], v[48:55], v8
    s_waitcnt lgkmcnt(0)
    v_exp_f32 v58, v58
    v_exp_f32 v59, v59
    v_exp_f32 v60, v60
    v_exp_f32 v61, v61
    v_exp_f32 v62, v62
    v_exp_f32 v63, v63
    v_exp_f32 v32, v32
    v_exp_f32 v33, v33
    v_smfmac_f32_32x32x32_bf16 v[80:95], v[100:103], v[56:63], v8
    ds_read_b128 v[96:99], v1 offset:48128
    v_exp_f32 v34, v34
    v_exp_f32 v35, v35
    v_exp_f32 v36, v36
    v_exp_f32 v37, v37
    v_mfma_f32_32x32x16_bf16 v[48:63], v[24:27], v[20:23], 0
    ds_read_b128 v[10:13], v3 offset:3072
    v_exp_f32 v38, v38
    v_exp_f32 v39, v39
    v_exp_f32 v40, v40
    v_exp_f32 v41, v41
    v_smfmac_f32_32x32x32_bf16 v[64:79], v[28:31], v[32:39], v8
    ds_read_b128 v[100:103], v3 offset:3584
    v_exp_f32 v42, v42
    v_exp_f32 v43, v43
    v_exp_f32 v44, v44
    v_exp_f32 v45, v45
    v_exp_f32 v46, v46
    v_exp_f32 v47, v47
    v_exp_f32 v48, v48
    v_exp_f32 v49, v49
    v_smfmac_f32_32x32x32_bf16 v[64:79], v[4:7], v[40:47], v8
    s_waitcnt lgkmcnt(2)
    v_exp_f32 v50, v50
    v_exp_f32 v51, v51
    v_exp_f32 v52, v52
    v_exp_f32 v53, v53
    v_mfma_f32_32x32x16_bf16 v[32:47], v[96:99], v[16:19], 0
    v_exp_f32 v54, v54
    v_exp_f32 v55, v55
    v_exp_f32 v56, v56
    v_exp_f32 v57, v57
    v_smfmac_f32_32x32x32_bf16 v[80:95], v[28:31], v[48:55], v8
    s_waitcnt lgkmcnt(0)
    v_exp_f32 v58, v58
    v_exp_f32 v59, v59
    v_exp_f32 v60, v60
    v_exp_f32 v61, v61
    v_exp_f32 v62, v62
    v_exp_f32 v63, v63
    v_exp_f32 v32, v32
    v_exp_f32 v33, v33
    v_smfmac_f32_32x32x32_bf16 v[80:95], v[4:7], v[56:63], v8
    ds_read_b128 v[24:27], v1 offset:49152
    v_exp_f32 v34, v34
    v_exp_f32 v35, v35
    v_exp_f32 v36, v36
    v_exp_f32 v37, v37
    v_mfma_f32_32x32x16_bf16 v[48:63], v[96:99], v[20:23], 0
    v_add_u32 v3, v2, v3
    ds_read_b128 v[28:31], v3 offset:0
    v_exp_f32 v38, v38
    v_exp_f32 v39, v39
    v_exp_f32 v40, v40
    v_exp_f32 v41, v41
    v_smfmac_f32_32x32x32_bf16 v[64:79], v[10:13], v[32:39], v8
    ds_read_b128 v[4:7], v3 offset:512
    v_exp_f32 v42, v42
    v_exp_f32 v43, v43
    v_exp_f32 v44, v44
    v_exp_f32 v45, v45
    v_exp_f32 v46, v46
    v_exp_f32 v47, v47
    v_exp_f32 v48, v48
    v_exp_f32 v49, v49
    v_smfmac_f32_32x32x32_bf16 v[64:79], v[100:103], v[40:47], v8
    s_waitcnt lgkmcnt(2)
    v_exp_f32 v50, v50
    v_exp_f32 v51, v51
    v_exp_f32 v52, v52
    v_exp_f32 v53, v53
    v_mfma_f32_32x32x16_bf16 v[32:47], v[24:27], v[16:19], 0
    v_exp_f32 v54, v54
    v_exp_f32 v55, v55
    v_exp_f32 v56, v56
    v_exp_f32 v57, v57
    v_smfmac_f32_32x32x32_bf16 v[80:95], v[10:13], v[48:55], v8
    s_waitcnt lgkmcnt(0)
    v_exp_f32 v58, v58
    v_exp_f32 v59, v59
    v_exp_f32 v60, v60
    v_exp_f32 v61, v61
    v_exp_f32 v62, v62
    v_exp_f32 v63, v63
    v_exp_f32 v32, v32
    v_exp_f32 v33, v33
    v_smfmac_f32_32x32x32_bf16 v[80:95], v[100:103], v[56:63], v8
    ds_read_b128 v[96:99], v1 offset:50176
    v_exp_f32 v34, v34
    v_exp_f32 v35, v35
    v_exp_f32 v36, v36
    v_exp_f32 v37, v37
    v_mfma_f32_32x32x16_bf16 v[48:63], v[24:27], v[20:23], 0
    ds_read_b128 v[10:13], v3 offset:1024
    v_exp_f32 v38, v38
    v_exp_f32 v39, v39
    v_exp_f32 v40, v40
    v_exp_f32 v41, v41
    v_smfmac_f32_32x32x32_bf16 v[64:79], v[28:31], v[32:39], v8
    ds_read_b128 v[100:103], v3 offset:1536
    v_exp_f32 v42, v42
    v_exp_f32 v43, v43
    v_exp_f32 v44, v44
    v_exp_f32 v45, v45
    v_exp_f32 v46, v46
    v_exp_f32 v47, v47
    v_exp_f32 v48, v48
    v_exp_f32 v49, v49
    v_smfmac_f32_32x32x32_bf16 v[64:79], v[4:7], v[40:47], v8
    s_waitcnt lgkmcnt(2)
    v_exp_f32 v50, v50
    v_exp_f32 v51, v51
    v_exp_f32 v52, v52
    v_exp_f32 v53, v53
    v_mfma_f32_32x32x16_bf16 v[32:47], v[96:99], v[16:19], 0
    v_exp_f32 v54, v54
    v_exp_f32 v55, v55
    v_exp_f32 v56, v56
    v_exp_f32 v57, v57
    v_smfmac_f32_32x32x32_bf16 v[80:95], v[28:31], v[48:55], v8
    s_waitcnt lgkmcnt(0)
    v_exp_f32 v58, v58
    v_exp_f32 v59, v59
    v_exp_f32 v60, v60
    v_exp_f32 v61, v61
    v_exp_f32 v62, v62
    v_exp_f32 v63, v63
    v_exp_f32 v32, v32
    v_exp_f32 v33, v33
    v_smfmac_f32_32x32x32_bf16 v[80:95], v[4:7], v[56:63], v8
    ds_read_b128 v[24:27], v1 offset:51200
    v_exp_f32 v34, v34
    v_exp_f32 v35, v35
    v_exp_f32 v36, v36
    v_exp_f32 v37, v37
    v_mfma_f32_32x32x16_bf16 v[48:63], v[96:99], v[20:23], 0
    ds_read_b128 v[28:31], v3 offset:2048
    v_exp_f32 v38, v38
    v_exp_f32 v39, v39
    v_exp_f32 v40, v40
    v_exp_f32 v41, v41
    v_smfmac_f32_32x32x32_bf16 v[64:79], v[10:13], v[32:39], v8
    ds_read_b128 v[4:7], v3 offset:2560
    v_exp_f32 v42, v42
    v_exp_f32 v43, v43
    v_exp_f32 v44, v44
    v_exp_f32 v45, v45
    v_exp_f32 v46, v46
    v_exp_f32 v47, v47
    v_exp_f32 v48, v48
    v_exp_f32 v49, v49
    v_smfmac_f32_32x32x32_bf16 v[64:79], v[100:103], v[40:47], v8
    s_waitcnt lgkmcnt(2)
    v_exp_f32 v50, v50
    v_exp_f32 v51, v51
    v_exp_f32 v52, v52
    v_exp_f32 v53, v53
    v_mfma_f32_32x32x16_bf16 v[32:47], v[24:27], v[16:19], 0
    v_exp_f32 v54, v54
    v_exp_f32 v55, v55
    v_exp_f32 v56, v56
    v_exp_f32 v57, v57
    v_smfmac_f32_32x32x32_bf16 v[80:95], v[10:13], v[48:55], v8
    s_waitcnt lgkmcnt(0)
    v_exp_f32 v58, v58
    v_exp_f32 v59, v59
    v_exp_f32 v60, v60
    v_exp_f32 v61, v61
    v_exp_f32 v62, v62
    v_exp_f32 v63, v63
    v_exp_f32 v32, v32
    v_exp_f32 v33, v33
    v_smfmac_f32_32x32x32_bf16 v[80:95], v[100:103], v[56:63], v8
    ds_read_b128 v[96:99], v1 offset:52224
    v_exp_f32 v34, v34
    v_exp_f32 v35, v35
    v_exp_f32 v36, v36
    v_exp_f32 v37, v37
    v_mfma_f32_32x32x16_bf16 v[48:63], v[24:27], v[20:23], 0
    ds_read_b128 v[10:13], v3 offset:3072
    v_exp_f32 v38, v38
    v_exp_f32 v39, v39
    v_exp_f32 v40, v40
    v_exp_f32 v41, v41
    v_smfmac_f32_32x32x32_bf16 v[64:79], v[28:31], v[32:39], v8
    ds_read_b128 v[100:103], v3 offset:3584
    v_exp_f32 v42, v42
    v_exp_f32 v43, v43
    v_exp_f32 v44, v44
    v_exp_f32 v45, v45
    v_exp_f32 v46, v46
    v_exp_f32 v47, v47
    v_exp_f32 v48, v48
    v_exp_f32 v49, v49
    v_smfmac_f32_32x32x32_bf16 v[64:79], v[4:7], v[40:47], v8
    s_waitcnt lgkmcnt(2)
    v_exp_f32 v50, v50
    v_exp_f32 v51, v51
    v_exp_f32 v52, v52
    v_exp_f32 v53, v53
    v_mfma_f32_32x32x16_bf16 v[32:47], v[96:99], v[16:19], 0
    v_exp_f32 v54, v54
    v_exp_f32 v55, v55
    v_exp_f32 v56, v56
    v_exp_f32 v57, v57
    v_smfmac_f32_32x32x32_bf16 v[80:95], v[28:31], v[48:55], v8
    s_waitcnt lgkmcnt(0)
    v_exp_f32 v58, v58
    v_exp_f32 v59, v59
    v_exp_f32 v60, v60
    v_exp_f32 v61, v61
    v_exp_f32 v62, v62
    v_exp_f32 v63, v63
    v_exp_f32 v32, v32
    v_exp_f32 v33, v33
    v_smfmac_f32_32x32x32_bf16 v[80:95], v[4:7], v[56:63], v8
    ds_read_b128 v[24:27], v1 offset:53248
    v_exp_f32 v34, v34
    v_exp_f32 v35, v35
    v_exp_f32 v36, v36
    v_exp_f32 v37, v37
    v_mfma_f32_32x32x16_bf16 v[48:63], v[96:99], v[20:23], 0
    v_add_u32 v3, v2, v3
    ds_read_b128 v[28:31], v3 offset:0
    v_exp_f32 v38, v38
    v_exp_f32 v39, v39
    v_exp_f32 v40, v40
    v_exp_f32 v41, v41
    v_smfmac_f32_32x32x32_bf16 v[64:79], v[10:13], v[32:39], v8
    ds_read_b128 v[4:7], v3 offset:512
    v_exp_f32 v42, v42
    v_exp_f32 v43, v43
    v_exp_f32 v44, v44
    v_exp_f32 v45, v45
    v_exp_f32 v46, v46
    v_exp_f32 v47, v47
    v_exp_f32 v48, v48
    v_exp_f32 v49, v49
    v_smfmac_f32_32x32x32_bf16 v[64:79], v[100:103], v[40:47], v8
    s_waitcnt lgkmcnt(2)
    v_exp_f32 v50, v50
    v_exp_f32 v51, v51
    v_exp_f32 v52, v52
    v_exp_f32 v53, v53
    v_mfma_f32_32x32x16_bf16 v[32:47], v[24:27], v[16:19], 0
    v_exp_f32 v54, v54
    v_exp_f32 v55, v55
    v_exp_f32 v56, v56
    v_exp_f32 v57, v57
    v_smfmac_f32_32x32x32_bf16 v[80:95], v[10:13], v[48:55], v8
    s_waitcnt lgkmcnt(0)
    v_exp_f32 v58, v58
    v_exp_f32 v59, v59
    v_exp_f32 v60, v60
    v_exp_f32 v61, v61
    v_exp_f32 v62, v62
    v_exp_f32 v63, v63
    v_exp_f32 v32, v32
    v_exp_f32 v33, v33
    v_smfmac_f32_32x32x32_bf16 v[80:95], v[100:103], v[56:63], v8
    ds_read_b128 v[96:99], v1 offset:54272
    v_exp_f32 v34, v34
    v_exp_f32 v35, v35
    v_exp_f32 v36, v36
    v_exp_f32 v37, v37
    v_mfma_f32_32x32x16_bf16 v[48:63], v[24:27], v[20:23], 0
    ds_read_b128 v[10:13], v3 offset:1024
    v_exp_f32 v38, v38
    v_exp_f32 v39, v39
    v_exp_f32 v40, v40
    v_exp_f32 v41, v41
    v_smfmac_f32_32x32x32_bf16 v[64:79], v[28:31], v[32:39], v8
    ds_read_b128 v[100:103], v3 offset:1536
    v_exp_f32 v42, v42
    v_exp_f32 v43, v43
    v_exp_f32 v44, v44
    v_exp_f32 v45, v45
    v_exp_f32 v46, v46
    v_exp_f32 v47, v47
    v_exp_f32 v48, v48
    v_exp_f32 v49, v49
    v_smfmac_f32_32x32x32_bf16 v[64:79], v[4:7], v[40:47], v8
    s_waitcnt lgkmcnt(2)
    v_exp_f32 v50, v50
    v_exp_f32 v51, v51
    v_exp_f32 v52, v52
    v_exp_f32 v53, v53
    v_mfma_f32_32x32x16_bf16 v[32:47], v[96:99], v[16:19], 0
    v_exp_f32 v54, v54
    v_exp_f32 v55, v55
    v_exp_f32 v56, v56
    v_exp_f32 v57, v57
    v_smfmac_f32_32x32x32_bf16 v[80:95], v[28:31], v[48:55], v8
    s_waitcnt lgkmcnt(0)
    v_exp_f32 v58, v58
    v_exp_f32 v59, v59
    v_exp_f32 v60, v60
    v_exp_f32 v61, v61
    v_exp_f32 v62, v62
    v_exp_f32 v63, v63
    v_exp_f32 v32, v32
    v_exp_f32 v33, v33
    v_smfmac_f32_32x32x32_bf16 v[80:95], v[4:7], v[56:63], v8
    ds_read_b128 v[24:27], v1 offset:55296
    v_exp_f32 v34, v34
    v_exp_f32 v35, v35
    v_exp_f32 v36, v36
    v_exp_f32 v37, v37
    v_mfma_f32_32x32x16_bf16 v[48:63], v[96:99], v[20:23], 0
    ds_read_b128 v[28:31], v3 offset:2048
    v_exp_f32 v38, v38
    v_exp_f32 v39, v39
    v_exp_f32 v40, v40
    v_exp_f32 v41, v41
    v_smfmac_f32_32x32x32_bf16 v[64:79], v[10:13], v[32:39], v8
    ds_read_b128 v[4:7], v3 offset:2560
    v_exp_f32 v42, v42
    v_exp_f32 v43, v43
    v_exp_f32 v44, v44
    v_exp_f32 v45, v45
    v_exp_f32 v46, v46
    v_exp_f32 v47, v47
    v_exp_f32 v48, v48
    v_exp_f32 v49, v49
    v_smfmac_f32_32x32x32_bf16 v[64:79], v[100:103], v[40:47], v8
    s_waitcnt lgkmcnt(2)
    v_exp_f32 v50, v50
    v_exp_f32 v51, v51
    v_exp_f32 v52, v52
    v_exp_f32 v53, v53
    v_mfma_f32_32x32x16_bf16 v[32:47], v[24:27], v[16:19], 0
    v_exp_f32 v54, v54
    v_exp_f32 v55, v55
    v_exp_f32 v56, v56
    v_exp_f32 v57, v57
    v_smfmac_f32_32x32x32_bf16 v[80:95], v[10:13], v[48:55], v8
    s_waitcnt lgkmcnt(0)
    v_exp_f32 v58, v58
    v_exp_f32 v59, v59
    v_exp_f32 v60, v60
    v_exp_f32 v61, v61
    v_exp_f32 v62, v62
    v_exp_f32 v63, v63
    v_exp_f32 v32, v32
    v_exp_f32 v33, v33
    v_smfmac_f32_32x32x32_bf16 v[80:95], v[100:103], v[56:63], v8
    ds_read_b128 v[96:99], v1 offset:56320
    v_exp_f32 v34, v34
    v_exp_f32 v35, v35
    v_exp_f32 v36, v36
    v_exp_f32 v37, v37
    v_mfma_f32_32x32x16_bf16 v[48:63], v[24:27], v[20:23], 0
    ds_read_b128 v[10:13], v3 offset:3072
    v_exp_f32 v38, v38
    v_exp_f32 v39, v39
    v_exp_f32 v40, v40
    v_exp_f32 v41, v41
    v_smfmac_f32_32x32x32_bf16 v[64:79], v[28:31], v[32:39], v8
    ds_read_b128 v[100:103], v3 offset:3584
    v_exp_f32 v42, v42
    v_exp_f32 v43, v43
    v_exp_f32 v44, v44
    v_exp_f32 v45, v45
    v_exp_f32 v46, v46
    v_exp_f32 v47, v47
    v_exp_f32 v48, v48
    v_exp_f32 v49, v49
    v_smfmac_f32_32x32x32_bf16 v[64:79], v[4:7], v[40:47], v8
    s_waitcnt lgkmcnt(2)
    v_exp_f32 v50, v50
    v_exp_f32 v51, v51
    v_exp_f32 v52, v52
    v_exp_f32 v53, v53
    v_mfma_f32_32x32x16_bf16 v[32:47], v[96:99], v[16:19], 0
    v_exp_f32 v54, v54
    v_exp_f32 v55, v55
    v_exp_f32 v56, v56
    v_exp_f32 v57, v57
    v_smfmac_f32_32x32x32_bf16 v[80:95], v[28:31], v[48:55], v8
    s_waitcnt lgkmcnt(0)
    v_exp_f32 v58, v58
    v_exp_f32 v59, v59
    v_exp_f32 v60, v60
    v_exp_f32 v61, v61
    v_exp_f32 v62, v62
    v_exp_f32 v63, v63
    v_exp_f32 v32, v32
    v_exp_f32 v33, v33
    v_smfmac_f32_32x32x32_bf16 v[80:95], v[4:7], v[56:63], v8
    ds_read_b128 v[24:27], v1 offset:57344
    v_exp_f32 v34, v34
    v_exp_f32 v35, v35
    v_exp_f32 v36, v36
    v_exp_f32 v37, v37
    v_mfma_f32_32x32x16_bf16 v[48:63], v[96:99], v[20:23], 0
    v_add_u32 v3, v2, v3
    ds_read_b128 v[28:31], v3 offset:0
    v_exp_f32 v38, v38
    v_exp_f32 v39, v39
    v_exp_f32 v40, v40
    v_exp_f32 v41, v41
    v_smfmac_f32_32x32x32_bf16 v[64:79], v[10:13], v[32:39], v8
    ds_read_b128 v[4:7], v3 offset:512
    v_exp_f32 v42, v42
    v_exp_f32 v43, v43
    v_exp_f32 v44, v44
    v_exp_f32 v45, v45
    v_exp_f32 v46, v46
    v_exp_f32 v47, v47
    v_exp_f32 v48, v48
    v_exp_f32 v49, v49
    v_smfmac_f32_32x32x32_bf16 v[64:79], v[100:103], v[40:47], v8
    s_waitcnt lgkmcnt(2)
    v_exp_f32 v50, v50
    v_exp_f32 v51, v51
    v_exp_f32 v52, v52
    v_exp_f32 v53, v53
    v_mfma_f32_32x32x16_bf16 v[32:47], v[24:27], v[16:19], 0
    v_exp_f32 v54, v54
    v_exp_f32 v55, v55
    v_exp_f32 v56, v56
    v_exp_f32 v57, v57
    v_smfmac_f32_32x32x32_bf16 v[80:95], v[10:13], v[48:55], v8
    s_waitcnt lgkmcnt(0)
    v_exp_f32 v58, v58
    v_exp_f32 v59, v59
    v_exp_f32 v60, v60
    v_exp_f32 v61, v61
    v_exp_f32 v62, v62
    v_exp_f32 v63, v63
    v_exp_f32 v32, v32
    v_exp_f32 v33, v33
    v_smfmac_f32_32x32x32_bf16 v[80:95], v[100:103], v[56:63], v8
    ds_read_b128 v[96:99], v1 offset:58368
    v_exp_f32 v34, v34
    v_exp_f32 v35, v35
    v_exp_f32 v36, v36
    v_exp_f32 v37, v37
    v_mfma_f32_32x32x16_bf16 v[48:63], v[24:27], v[20:23], 0
    ds_read_b128 v[10:13], v3 offset:1024
    v_exp_f32 v38, v38
    v_exp_f32 v39, v39
    v_exp_f32 v40, v40
    v_exp_f32 v41, v41
    v_smfmac_f32_32x32x32_bf16 v[64:79], v[28:31], v[32:39], v8
    ds_read_b128 v[100:103], v3 offset:1536
    v_exp_f32 v42, v42
    v_exp_f32 v43, v43
    v_exp_f32 v44, v44
    v_exp_f32 v45, v45
    v_exp_f32 v46, v46
    v_exp_f32 v47, v47
    v_exp_f32 v48, v48
    v_exp_f32 v49, v49
    v_smfmac_f32_32x32x32_bf16 v[64:79], v[4:7], v[40:47], v8
    s_waitcnt lgkmcnt(2)
    v_exp_f32 v50, v50
    v_exp_f32 v51, v51
    v_exp_f32 v52, v52
    v_exp_f32 v53, v53
    v_mfma_f32_32x32x16_bf16 v[32:47], v[96:99], v[16:19], 0
    v_exp_f32 v54, v54
    v_exp_f32 v55, v55
    v_exp_f32 v56, v56
    v_exp_f32 v57, v57
    v_smfmac_f32_32x32x32_bf16 v[80:95], v[28:31], v[48:55], v8
    s_waitcnt lgkmcnt(0)
    v_exp_f32 v58, v58
    v_exp_f32 v59, v59
    v_exp_f32 v60, v60
    v_exp_f32 v61, v61
    v_exp_f32 v62, v62
    v_exp_f32 v63, v63
    s_branch L_att_join
L_notready:
    s_mov_b32 s58, 0x40000
L_notready_l:
    s_sleep 32
    buffer_load_dword v255, v9, s[4:7], s37 offen sc1
    s_sub_u32 s58, s58, 1
    s_waitcnt vmcnt(0)
    s_cbranch_scc1 L_ready
    v_cmp_gt_u32 vcc, 32, v255
    s_nop 0
    s_cbranch_vccnz L_notready_l
    s_branch L_ready
L_slow0:
    s_waitcnt lgkmcnt(0)
    v_mov_b32 v96, 0xff800000
    v_mov_b32 v97, v1
    s_mov_b32 s28, 64
L_smax_0:
    ds_read_b128 v[24:27], v97
    v_add_u32 v97, 1024, v97
    s_waitcnt lgkmcnt(0)
    v_mfma_f32_32x32x16_bf16 v[32:47], v[24:27], v[16:19], 0
    s_nop 11
    v_max3_f32 v96, v32, v33, v96
    v_max3_f32 v96, v34, v35, v96
    v_max3_f32 v96, v36, v37, v96
    v_max3_f32 v96, v38, v39, v96
    v_max3_f32 v96, v40, v41, v96
    v_max3_f32 v96, v42, v43, v96
    v_max3_f32 v96, v44, v45, v96
    v_max3_f32 v96, v46, v47, v96
    s_sub_u32 s28, s28, 1
    s_cmp_lg_u32 s28, 0
    s_cbranch_scc1 L_smax_0
    v_mov_b32 v97, v96
    s_nop 1
    v_permlane32_swap_b32 v96, v97
    v_max_f32 v96, v96, v97
    v_sub_f32 v48, 0, v96
    v_mov_b32 v64, 0
    v_sub_f32 v49, 0, v96
    v_mov_b32 v65, 0
    v_sub_f32 v50, 0, v96
    v_mov_b32 v66, 0
    v_sub_f32 v51, 0, v96
    v_mov_b32 v67, 0
    v_sub_f32 v52, 0, v96
    v_mov_b32 v68, 0
    v_sub_f32 v53, 0, v96
    v_mov_b32 v69, 0
    v_sub_f32 v54, 0, v96
    v_mov_b32 v70, 0
    v_sub_f32 v55, 0, v96
    v_mov_b32 v71, 0
    v_sub_f32 v56, 0, v96
    v_mov_b32 v72, 0
    v_sub_f32 v57, 0, v96
    v_mov_b32 v73, 0
    v_sub_f32 v58, 0, v96
    v_mov_b32 v74, 0
    v_sub_f32 v59, 0, v96
    v_mov_b32 v75, 0
    v_sub_f32 v60, 0, v96
    v_mov_b32 v76, 0
    v_sub_f32 v61, 0, v96
    v_mov_b32 v77, 0
    v_sub_f32 v62, 0, v96
    v_mov_b32 v78, 0
    v_sub_f32 v63, 0, v96
    v_mov_b32 v79, 0
    v_mov_b32 v97, v1
    v_mul_u32_u24 v96, 15, v2
    v_sub_u32 v96, v3, v96
    v_lshrrev_b32 v98, 2, v2
    s_mov_b32 s28, 64
L_ssum_0:
    ds_read_b128 v[24:27], v97
    ds_read_b128 v[28:31], v96
    ds_read_b128 v[4:7], v96 offset:512
    v_add_u32 v97, 1024, v97
    v_add_u32 v96, v98, v96
    s_waitcnt lgkmcnt(0)
    v_mfma_f32_32x32x16_bf16 v[32:47], v[24:27], v[16:19], v[48:63]
    s_nop 11
    v_exp_f32 v32, v32
    v_exp_f32 v33, v33
    v_exp_f32 v34, v34
    v_exp_f32 v35, v35
    v_exp_f32 v36, v36
    v_exp_f32 v37, v37
    v_exp_f32 v38, v38
    v_exp_f32 v39, v39
    v_exp_f32 v40, v40
    v_exp_f32 v41, v41
    v_exp_f32 v42, v42
    v_exp_f32 v43, v43
    v_exp_f32 v44, v44
    v_exp_f32 v45, v45
    v_exp_f32 v46, v46
    v_exp_f32 v47, v47
    v_smfmac_f32_32x32x32_bf16 v[64:79], v[28:31], v[32:39], v8
    s_nop 0
    v_smfmac_f32_32x32x32_bf16 v[64:79], v[4:7], v[40:47], v8
    s_sub_u32 s28, s28, 1
    s_cmp_lg_u32 s28, 0
    s_cbranch_scc1 L_ssum_0
    s_nop 15
    s_branch L_fin0
L_slow1:
    s_waitcnt lgkmcnt(0)
    v_mov_b32 v96, 0xff800000
    v_mov_b32 v97, v1
    s_mov_b32 s28, 64
L_smax_1:
    ds_read_b128 v[24:27], v97
    v_add_u32 v97, 1024, v97
    s_waitcnt lgkmcnt(0)
    v_mfma_f32_32x32x16_bf16 v[32:47], v[24:27], v[20:23], 0
    s_nop 11
    v_max3_f32 v96, v32, v33, v96
    v_max3_f32 v96, v34, v35, v96
    v_max3_f32 v96, v36, v37, v96
    v_max3_f32 v96, v38, v39, v96
    v_max3_f32 v96, v40, v41, v96
    v_max3_f32 v96, v42, v43, v96
    v_max3_f32 v96, v44, v45, v96
    v_max3_f32 v96, v46, v47, v96
    s_sub_u32 s28, s28, 1
    s_cmp_lg_u32 s28, 0
    s_cbranch_scc1 L_smax_1
    v_mov_b32 v97, v96
    s_nop 1
    v_permlane32_swap_b32 v96, v97
    v_max_f32 v96, v96, v97
    v_sub_f32 v48, 0, v96
    v_mov_b32 v80, 0
    v_sub_f32 v49, 0, v96
    v_mov_b32 v81, 0
    v_sub_f32 v50, 0, v96
    v_mov_b32 v82, 0
    v_sub_f32 v51, 0, v96
    v_mov_b32 v83, 0
    v_sub_f32 v52, 0, v96
    v_mov_b32 v84, 0
    v_sub_f32 v53, 0, v96
    v_mov_b32 v85, 0
    v_sub_f32 v54, 0, v96
    v_mov_b32 v86, 0
    v_sub_f32 v55, 0, v96
    v_mov_b32 v87, 0
    v_sub_f32 v56, 0, v96
    v_mov_b32 v88, 0
    v_sub_f32 v57, 0, v96
    v_mov_b32 v89, 0
    v_sub_f32 v58, 0, v96
    v_mov_b32 v90, 0
    v_sub_f32 v59, 0, v96
    v_mov_b32 v91, 0
    v_sub_f32 v60, 0, v96
    v_mov_b32 v92, 0
    v_sub_f32 v61, 0, v96
    v_mov_b32 v93, 0
    v_sub_f32 v62, 0, v96
    v_mov_b32 v94, 0
    v_sub_f32 v63, 0, v96
    v_mov_b32 v95, 0
    v_mov_b32 v97, v1
    v_mul_u32_u24 v96, 15, v2
    v_sub_u32 v96, v3, v96
    v_lshrrev_b32 v98, 2, v2
    s_mov_b32 s28, 64
L_ssum_1:
    ds_read_b128 v[24:27], v97
    ds_read_b128 v[28:31], v96
    ds_read_b128 v[4:7], v96 offset:512
    v_add_u32 v97, 1024, v97
    v_add_u32 v96, v98, v96
    s_waitcnt lgkmcnt(0)
    v_mfma_f32_32x32x16_bf16 v[32:47], v[24:27], v[20:23], v[48:63]
    s_nop 11
    v_exp_f32 v32, v32
    v_exp_f32 v33, v33
    v_exp_f32 v34, v34
    v_exp_f32 v35, v35
    v_exp_f32 v36, v36
    v_exp_f32 v37, v37
    v_exp_f32 v38, v38
    v_exp_f32 v39, v39
    v_exp_f32 v40, v40
    v_exp_f32 v41, v41
    v_exp_f32 v42, v42
    v_exp_f32 v43, v43
    v_exp_f32 v44, v44
    v_exp_f32 v45, v45
    v_exp_f32 v46, v46
    v_exp_f32 v47, v47
    v_smfmac_f32_32x32x32_bf16 v[80:95], v[28:31], v[32:39], v8
    s_nop 0
    v_smfmac_f32_32x32x32_bf16 v[80:95], v[4:7], v[40:47], v8
    s_sub_u32 s28, s28, 1
    s_cmp_lg_u32 s28, 0
    s_cbranch_scc1 L_ssum_1
    s_nop 15
    s_branch L_fin1
L_chk14_s:
    s_mov_b32 s58, 0x40000
L_poll23:
    s_mov_b32 s101, 0
    s_atomic_add s101, s[14:15], 1152 glc
    s_sub_u32 s58, s58, 1
    s_waitcnt lgkmcnt(0)
    s_cbranch_scc1 L_poll23_x
    s_cmp_lt_u32 s101, 8
    s_sleep 1
    s_cbranch_scc1 L_poll23
L_poll23_x:
    s_branch L_chk14
L_chk17_s:
    s_mov_b32 s58, 0x40000
L_poll24:
    s_mov_b32 s101, 0
    s_atomic_add s101, s[14:15], 1280 glc
    s_sub_u32 s58, s58, 1
    s_waitcnt lgkmcnt(0)
    s_cbranch_scc1 L_poll24_x
    s_cmp_lt_u32 s101, 8
    s_sleep 1
    s_cbranch_scc1 L_poll24
L_poll24_x:
    s_branch L_chk17
L_chk20_s:
    s_mov_b32 s58, 0x40000
L_poll25:
    s_mov_b32 s101, 0
    s_atomic_add s101, s[14:15], 1408 glc
    s_sub_u32 s58, s58, 1
    s_waitcnt lgkmcnt(0)
    s_cbranch_scc1 L_poll25_x
    s_cmp_lt_u32 s101, 8
    s_sleep 1
    s_cbranch_scc1 L_poll25
L_poll25_x:
    s_branch L_chk20
L_codeend:

.section .rodata,"a"
.p2align 6
.amdhsa_kernel interleave_layers__softmax_full_mha__mixer_channel_mlp__prompt_kernel
  .amdhsa_next_free_vgpr 512
  .amdhsa_next_free_sgpr 102
  .amdhsa_accum_offset 256
  .amdhsa_group_segment_fixed_size 0
  .amdhsa_kernarg_size 88
  .amdhsa_user_sgpr_count 2
  .amdhsa_user_sgpr_kernarg_segment_ptr 1
  .amdhsa_system_sgpr_workgroup_id_x 1
  .amdhsa_float_denorm_mode_32 3
.end_amdhsa_kernel
```
